```python
import torch

def _softmax(x, axis=-1):
    return torch.softmax(x, dim=axis)
def _gelu(x):
    return torch.nn.functional.gelu(x, approximate="tanh")
def _silu(x):
    return torch.nn.functional.silu(x)
def _sigmoid(x):
    return torch.sigmoid(x)
def _layernorm(x, axis=-1, eps=1e-5):
    m = x.mean(dim=axis, keepdim=True)
    v = x.var(dim=axis, keepdim=True, unbiased=False)
    return (x - m) / torch.sqrt(v + eps)
def _scatter_add(tgt, idx, src, axis=0):
    return tgt.clone().index_add_(axis, idx, src)
def _segment_sum(src, seg, n):
    out = torch.zeros((n,) + src.shape[1:], dtype=src.dtype)
    return out.index_add_(0, seg, src)
def _pad(x, pw):
    flat = tuple(v for pair in reversed(pw) for v in pair)
    return torch.nn.functional.pad(x, flat)

kernel_name = 'gated_mix__linear_attn_block__glu_gated_glu__prompt'

def setup_inputs():

    _w = (lambda a: (lambda t: t.to(torch.bfloat16) if t.is_floating_point() else t)(torch.as_tensor(a)))
    def _A_setup():
        B, S, D = 1, 2048, 640
        return {
            "x": _w((lambda *s: torch.randn(*s, dtype=torch.bfloat16) * 0.05)(B, S, D)),
            "wqkv": _w((lambda *s: torch.randn(*s, dtype=torch.bfloat16) * 0.8)(D, 3 * D)),
            "wo": _w((lambda *s: torch.randn(*s, dtype=torch.bfloat16) * 0.2)(D, D)),
        }
    _A_in = _A_setup()

    def _B_setup():
        B, S, D, F = 1, 2048, 640, 1536
        return {
            "x": _w((lambda *s: torch.randn(*s, dtype=torch.bfloat16) * 0.05)(B, S, D)),
            "w_gate": _w((lambda *s: torch.randn(*s, dtype=torch.bfloat16) * 0.4)(D, F)),
            "w_up": _w((lambda *s: torch.randn(*s, dtype=torch.bfloat16) * 0.05)(D, F)),
            "w_down": _w((lambda *s: torch.randn(*s, dtype=torch.bfloat16) * 0.05)(F, D)),
        }
    _B_in = _B_setup()

    return {
        "A_x": _A_in["x"],
        "A_wqkv": _A_in["wqkv"],
        "A_wo": _A_in["wo"],
        "B_x": _B_in["x"],
        "B_w_gate": _B_in["w_gate"],
        "B_w_up": _B_in["w_up"],
        "B_w_down": _B_in["w_down"],
        "gate_w": _w((lambda *s: torch.randn(*s, dtype=torch.bfloat16) * 0.05)(640) * 16.0),
    }

def reference(A_x, A_wqkv, A_wo, B_x, B_w_gate, B_w_up, B_w_down, gate_w):
    def _A_ref(x, wqkv, wo):
        B, S, D = x.shape
        H = 32; Dh = D // H
        qkv = (lambda x, *d: x.permute(*d))((x @ wqkv).reshape(B, S, 3, H, Dh), 2, 0, 3, 1, 4)
        q, k, v = qkv[0], qkv[1], qkv[2]
        phi = lambda t: torch.where(t > 0, t + 1, torch.exp(t)) + 1e-6
        pq, pk = phi(q), phi(k)
        kv = torch.einsum("bhsd,bhse->bhde", pk, v)
        z = torch.einsum("bhsd->bhd", pk)
        num = torch.einsum("bhqd,bhde->bhqe", pq, kv)
        den = torch.einsum("bhqd,bhd->bhq", pq, z)[..., None] + 1e-6
        o = num / den
        return (lambda x, *d: x.permute(*d))(o, 0, 2, 1, 3).reshape(B, S, D) @ wo

    def _B_ref(x, w_gate, w_up, w_down):
        g = torch.einsum("bsd,df->bsf", x, w_gate)
        u = torch.einsum("bsd,df->bsf", x, w_up)
        h = _sigmoid(g) * u
        return torch.einsum("bsf,fd->bsd", h, w_down)

    x = A_x
    g = _sigmoid((x * gate_w).sum(-1, keepdims=True))
    a = _A_ref(x, A_wqkv, A_wo)
    b = _B_ref(x, B_w_gate, B_w_up, B_w_down)
    return g * a + (1 - g) * b
```

```asm
; @launch grid=(256,1,1) block=(256,1,1) lds=163840
.amdgcn_target "amdgcn-amd-amdhsa--gfx950"
.text
.globl gated_mix__linear_attn_block__glu_gated_glu__prompt_kernel
.p2align 8
.type gated_mix__linear_attn_block__glu_gated_glu__prompt_kernel,@function
gated_mix__linear_attn_block__glu_gated_glu__prompt_kernel:
  s_load_dwordx16 s[24:39], s[0:1], 0
  s_load_dwordx4 s[96:99], s[0:1], 64
  s_load_dwordx2 s[40:41], s[0:1], 80
  s_cmp_ge_u32 s2, 256
  s_cbranch_scc1 L_end
  s_lshr_b32 s5, s2, 3
  s_getpc_b64 s[76:77]
  s_lshl_b32 s53, s5, 7
  v_lshl_add_u32 v240, v0, 12, s53
  v_cmp_gt_u32 vcc, L_end-gated_mix__linear_attn_block__glu_gated_glu__prompt_kernel-128, v240
  s_nop 0
  s_and_saveexec_b64 s[78:79], vcc
  s_cbranch_execz L_cpf_skip
  global_load_dword v241, v240, s[76:77]
L_cpf_skip:
  s_mov_b64 exec, s[78:79]
  v_and_b32 v164, 63, v0
  v_lshrrev_b32 v200, 6, v0
  s_and_b32 s3, s2, 3
  v_readfirstlane_b32 s42, v200
  s_bfe_u32 s4, s2, 0x10002
  v_lshlrev_b32 v195, 4, v164
  s_lshl_b32 s53, s4, 2
  s_lshr_b32 s6, s5, 1
  s_sub_u32 s54, s5, 8
  s_cmp_lt_u32 s5, 8
  s_cselect_b32 s6, s6, s54
  s_cselect_b32 s57, 0, s3
  s_cselect_b32 s59, 0, 0
  s_and_b32 s58, s6, 3
  s_mul_i32 s58, s58, 2
  s_lshr_b32 s58, s58, 1
  s_add_u32 s58, s58, s59
  s_lshl_b32 s57, s57, 1
  s_add_u32 s6, s6, s53
  s_lshl_b32 s55, s6, 8
  s_movk_i32 s56, 64
  s_add_u32 s48, s2, 160
  s_cmp_lt_u32 s5, 12
  s_cbranch_scc1 L_dec_done
  s_sub_u32 s6, s5, 12
  s_mul_i32 s7, s6, 43
  s_lshr_b32 s7, s7, 7
  s_mul_i32 s49, s7, 3
  s_sub_u32 s49, s6, s49
  s_mul_i32 s6, s4, 7
  s_add_u32 s6, s6, s7
  s_cmp_lt_u32 s5, 30
  s_cbranch_scc1 L_gu_dec
  s_mov_b32 s6, 6
  s_sub_u32 s49, s5, 30
  s_lshl_b32 s7, s4, 1
  s_add_u32 s49, s49, s7
  s_cmp_eq_u32 s49, 3
  s_cbranch_scc1 L_sideonly
L_gu_dec:
  s_mul_i32 s7, s3, 3
  s_add_u32 s7, s7, s49
  s_mul_i32 s48, s6, 12
  s_add_u32 s48, s48, s7
  s_mul_i32 s55, s6, 160
  s_movk_i32 s56, 40
  s_mov_b32 s57, 0
  s_and_b32 s58, s6, 3
  s_mul_i32 s58, s58, 1
  s_mul_i32 s59, s49, 0
  s_add_u32 s58, s58, s59
L_dec_done:
  s_mul_i32 s59, s3, 3
  s_add_u32 s58, s58, s59
  s_mul_i32 s59, s4, 5
  s_add_u32 s58, s58, s59
  s_mul_i32 s59, s58, 6554
  s_lshr_b32 s59, s59, 16
  s_mul_i32 s59, s59, 10
  s_sub_u32 s58, s58, s59
  s_lshl_b32 s44, s58, 7
  s_mul_i32 s53, s42, s56
  v_lshrrev_b32 v200, 3, v164
  v_add_u32 v200, s53, v200
  v_bfe_u32 v201, v200, 1, 3
  v_and_b32 v202, 7, v164
  v_xor_b32 v201, v201, v202
  v_add_u32 v200, s55, v200
  v_mul_u32_u24 v200, 1280, v200
  v_lshl_add_u32 v200, v201, 4, v200
  v_xor_b32 v201, 64, v200
  s_lshl_b32 s50, s53, 7
  s_xor_b32 s54, s57, 0
  s_mul_i32 s54, s54, 10240
  v_add_u32 v165, s54, v200
  s_xor_b32 s54, s57, 1
  s_mul_i32 s54, s54, 10240
  v_add_u32 v166, s54, v201
  s_xor_b32 s54, s57, 2
  s_mul_i32 s54, s54, 10240
  v_add_u32 v167, s54, v200
  s_xor_b32 s54, s57, 3
  s_mul_i32 s54, s54, 10240
  v_add_u32 v168, s54, v201
  s_xor_b32 s54, s57, 4
  s_mul_i32 s54, s54, 10240
  v_add_u32 v169, s54, v200
  s_xor_b32 s54, s57, 5
  s_mul_i32 s54, s54, 10240
  v_add_u32 v170, s54, v201
  s_xor_b32 s54, s57, 6
  s_mul_i32 s54, s54, 10240
  v_add_u32 v171, s54, v200
  s_xor_b32 s54, s57, 7
  s_mul_i32 s54, s54, 10240
  v_add_u32 v172, s54, v201
  s_mov_b32 m0, s50
  s_waitcnt lgkmcnt(0)
  s_mov_b32 s8, s24
  s_mov_b32 s9, s25
  s_mov_b32 s10, 2621440
  s_mov_b32 s11, 0x00020000
  s_nop 0
  buffer_load_dwordx4 v165, s[8:11], s44 offen lds
  s_addk_i32 m0, 0x400
  s_nop 0
  buffer_load_dwordx4 v166, s[8:11], s44 offen lds
  s_addk_i32 m0, 0x400
  s_nop 0
  buffer_load_dwordx4 v167, s[8:11], s44 offen lds
  s_addk_i32 m0, 0x400
  s_nop 0
  buffer_load_dwordx4 v168, s[8:11], s44 offen lds
  s_addk_i32 m0, 0x400
  s_nop 0
  buffer_load_dwordx4 v169, s[8:11], s44 offen lds
  s_mov_b32 s20, s40
  s_mov_b32 s21, s41
  s_mov_b32 s22, 19398656
  s_mov_b32 s23, 0x00020000
  s_mov_b32 s53, 14688256
  s_load_dword s100, s[40:41], s53
  s_mov_b32 s46, 0
  s_cmp_ge_u32 s5, 12
  s_cbranch_scc1 L_gu
  s_addk_i32 m0, 0x400
  s_nop 0
  buffer_load_dwordx4 v170, s[8:11], s44 offen lds
  s_addk_i32 m0, 0x400
  s_nop 0
  buffer_load_dwordx4 v171, s[8:11], s44 offen lds
  s_addk_i32 m0, 0x400
  s_nop 0
  buffer_load_dwordx4 v172, s[8:11], s44 offen lds
  s_mov_b32 s12, s26
  s_mov_b32 s13, s27
  s_mov_b32 s14, 2457600
  s_mov_b32 s15, 0x00020000
  s_mul_i32 s45, s58, 245760
  s_mul_i32 s51, s42, 5120
  s_add_u32 s51, s51, 32768
  s_mul_i32 s53, s42, 320
  s_movk_i32 s54, 3840
  s_cmp_ge_u32 s5, 8
  s_cbranch_scc1 L_q
  s_and_b32 s7, s5, 1
  s_lshl_b32 s49, s3, 1
  s_add_u32 s7, s7, s49
  s_mul_i32 s57, s7, 160
  s_add_u32 s57, s57, 1280
  v_add_u32 v200, s53, v164
  v_mul_u32_u24 v201, 3277, v200
  v_lshrrev_b32 v201, 16, v201
  v_mul_u32_u24 v202, 20, v201
  v_sub_u32 v202, v200, v202
  v_bfe_u32 v203, v201, 3, 1
  v_lshlrev_b32 v203, 1, v203
  v_xor_b32 v202, v202, v203
  v_mul_u32_u24 v203, 52, v202
  v_lshrrev_b32 v203, 8, v203
  v_lshlrev_b32 v202, 4, v202
  v_and_b32 v204, 1, v203
  v_mul_u32_u24 v204, 1200, v204
  v_lshrrev_b32 v203, 1, v203
  v_mul_u32_u24 v203, 80, v203
  v_sub_u32 v202, v202, v203
  v_mul_lo_u32 v201, v201, s54
  v_add3_u32 v201, v201, v202, v204
  s_add_u32 m0, s46, s51
  v_add_u32 v173, s57, v201
  buffer_load_dwordx4 v173, s[12:15], s45 offen lds
  v_add_u32 v200, s53, v164
  v_add_u32 v200, 64, v200
  v_mul_u32_u24 v201, 3277, v200
  v_lshrrev_b32 v201, 16, v201
  v_mul_u32_u24 v202, 20, v201
  v_sub_u32 v202, v200, v202
  v_bfe_u32 v203, v201, 3, 1
  v_lshlrev_b32 v203, 1, v203
  v_xor_b32 v202, v202, v203
  v_mul_u32_u24 v203, 52, v202
  v_lshrrev_b32 v203, 8, v203
  v_lshlrev_b32 v202, 4, v202
  v_and_b32 v204, 1, v203
  v_mul_u32_u24 v204, 1200, v204
  v_lshrrev_b32 v203, 1, v203
  v_mul_u32_u24 v203, 80, v203
  v_sub_u32 v202, v202, v203
  v_mul_lo_u32 v201, v201, s54
  v_add3_u32 v201, v201, v202, v204
  s_addk_i32 m0, 0x400
  v_add_u32 v174, s57, v201
  buffer_load_dwordx4 v174, s[12:15], s45 offen lds
  v_add_u32 v200, s53, v164
  v_add_u32 v200, 128, v200
  v_mul_u32_u24 v201, 3277, v200
  v_lshrrev_b32 v201, 16, v201
  v_mul_u32_u24 v202, 20, v201
  v_sub_u32 v202, v200, v202
  v_bfe_u32 v203, v201, 3, 1
  v_lshlrev_b32 v203, 1, v203
  v_xor_b32 v202, v202, v203
  v_mul_u32_u24 v203, 52, v202
  v_lshrrev_b32 v203, 8, v203
  v_lshlrev_b32 v202, 4, v202
  v_and_b32 v204, 1, v203
  v_mul_u32_u24 v204, 1200, v204
  v_lshrrev_b32 v203, 1, v203
  v_mul_u32_u24 v203, 80, v203
  v_sub_u32 v202, v202, v203
  v_mul_lo_u32 v201, v201, s54
  v_add3_u32 v201, v201, v202, v204
  s_addk_i32 m0, 0x400
  v_add_u32 v175, s57, v201
  buffer_load_dwordx4 v175, s[12:15], s45 offen lds
  v_add_u32 v200, s53, v164
  v_add_u32 v200, 192, v200
  v_mul_u32_u24 v201, 3277, v200
  v_lshrrev_b32 v201, 16, v201
  v_mul_u32_u24 v202, 20, v201
  v_sub_u32 v202, v200, v202
  v_bfe_u32 v203, v201, 3, 1
  v_lshlrev_b32 v203, 1, v203
  v_xor_b32 v202, v202, v203
  v_mul_u32_u24 v203, 52, v202
  v_lshrrev_b32 v203, 8, v203
  v_lshlrev_b32 v202, 4, v202
  v_and_b32 v204, 1, v203
  v_mul_u32_u24 v204, 1200, v204
  v_lshrrev_b32 v203, 1, v203
  v_mul_u32_u24 v203, 80, v203
  v_sub_u32 v202, v202, v203
  v_mul_lo_u32 v201, v201, s54
  v_add3_u32 v201, v201, v202, v204
  s_addk_i32 m0, 0x400
  v_add_u32 v176, s57, v201
  buffer_load_dwordx4 v176, s[12:15], s45 offen lds
  v_add_u32 v200, s53, v164
  v_add_u32 v200, 256, v200
  v_mul_u32_u24 v201, 3277, v200
  v_lshrrev_b32 v201, 16, v201
  v_mul_u32_u24 v202, 20, v201
  v_sub_u32 v202, v200, v202
  v_bfe_u32 v203, v201, 3, 1
  v_lshlrev_b32 v203, 1, v203
  v_xor_b32 v202, v202, v203
  v_mul_u32_u24 v203, 52, v202
  v_lshrrev_b32 v203, 8, v203
  v_lshlrev_b32 v202, 4, v202
  v_and_b32 v204, 1, v203
  v_mul_u32_u24 v204, 1200, v204
  v_lshrrev_b32 v203, 1, v203
  v_mul_u32_u24 v203, 80, v203
  v_sub_u32 v202, v202, v203
  v_mul_lo_u32 v201, v201, s54
  v_add3_u32 v201, v201, v202, v204
  s_addk_i32 m0, 0x400
  v_add_u32 v177, s57, v201
  buffer_load_dwordx4 v177, s[12:15], s45 offen lds
  s_branch L_kv2
L_q:
  s_mul_i32 s57, s3, 320
  v_add_u32 v200, s53, v164
  v_mul_u32_u24 v201, 3277, v200
  v_lshrrev_b32 v201, 16, v201
  v_mul_u32_u24 v202, 20, v201
  v_sub_u32 v202, v200, v202
  v_bfe_u32 v203, v201, 3, 1
  v_xor_b32 v202, v202, v203
  v_lshrrev_b32 v203, 2, v202
  v_and_b32 v202, 3, v202
  v_mul_u32_u24 v202, 80, v202
  v_lshl_add_u32 v202, v203, 4, v202
  v_mul_lo_u32 v201, v201, s54
  s_add_u32 m0, s46, s51
  v_add3_u32 v173, v201, v202, s57
  buffer_load_dwordx4 v173, s[12:15], s45 offen lds
  v_add_u32 v200, s53, v164
  v_add_u32 v200, 64, v200
  v_mul_u32_u24 v201, 3277, v200
  v_lshrrev_b32 v201, 16, v201
  v_mul_u32_u24 v202, 20, v201
  v_sub_u32 v202, v200, v202
  v_bfe_u32 v203, v201, 3, 1
  v_xor_b32 v202, v202, v203
  v_lshrrev_b32 v203, 2, v202
  v_and_b32 v202, 3, v202
  v_mul_u32_u24 v202, 80, v202
  v_lshl_add_u32 v202, v203, 4, v202
  v_mul_lo_u32 v201, v201, s54
  s_addk_i32 m0, 0x400
  v_add3_u32 v174, v201, v202, s57
  buffer_load_dwordx4 v174, s[12:15], s45 offen lds
  v_add_u32 v200, s53, v164
  v_add_u32 v200, 128, v200
  v_mul_u32_u24 v201, 3277, v200
  v_lshrrev_b32 v201, 16, v201
  v_mul_u32_u24 v202, 20, v201
  v_sub_u32 v202, v200, v202
  v_bfe_u32 v203, v201, 3, 1
  v_xor_b32 v202, v202, v203
  v_lshrrev_b32 v203, 2, v202
  v_and_b32 v202, 3, v202
  v_mul_u32_u24 v202, 80, v202
  v_lshl_add_u32 v202, v203, 4, v202
  v_mul_lo_u32 v201, v201, s54
  s_addk_i32 m0, 0x400
  v_add3_u32 v175, v201, v202, s57
  buffer_load_dwordx4 v175, s[12:15], s45 offen lds
  v_add_u32 v200, s53, v164
  v_add_u32 v200, 192, v200
  v_mul_u32_u24 v201, 3277, v200
  v_lshrrev_b32 v201, 16, v201
  v_mul_u32_u24 v202, 20, v201
  v_sub_u32 v202, v200, v202
  v_bfe_u32 v203, v201, 3, 1
  v_xor_b32 v202, v202, v203
  v_lshrrev_b32 v203, 2, v202
  v_and_b32 v202, 3, v202
  v_mul_u32_u24 v202, 80, v202
  v_lshl_add_u32 v202, v203, 4, v202
  v_mul_lo_u32 v201, v201, s54
  s_addk_i32 m0, 0x400
  v_add3_u32 v176, v201, v202, s57
  buffer_load_dwordx4 v176, s[12:15], s45 offen lds
  v_add_u32 v200, s53, v164
  v_add_u32 v200, 256, v200
  v_mul_u32_u24 v201, 3277, v200
  v_lshrrev_b32 v201, 16, v201
  v_mul_u32_u24 v202, 20, v201
  v_sub_u32 v202, v200, v202
  v_bfe_u32 v203, v201, 3, 1
  v_xor_b32 v202, v202, v203
  v_lshrrev_b32 v203, 2, v202
  v_and_b32 v202, 3, v202
  v_mul_u32_u24 v202, 80, v202
  v_lshl_add_u32 v202, v203, 4, v202
  v_mul_lo_u32 v201, v201, s54
  s_addk_i32 m0, 0x400
  v_add3_u32 v177, v201, v202, s57
  buffer_load_dwordx4 v177, s[12:15], s45 offen lds
  s_mov_b32 s16, s38
  s_mov_b32 s17, s39
  s_mov_b32 s18, 1280
  s_mov_b32 s19, 0x00020000
  s_mov_b32 m0, 159744
  s_nop 0
  buffer_load_dwordx4 v195, s[16:19], 0 offen lds
  buffer_load_dwordx4 v195, s[16:19], 0 offen offset:1024 lds
  s_branch L_q2
L_gu:
  s_mov_b32 s12, s32
  s_mov_b32 s13, s33
  s_mov_b32 s14, 1966080
  s_mov_b32 s15, 0x00020000
  s_mov_b32 s16, s34
  s_mov_b32 s17, s35
  s_mov_b32 s18, 1966080
  s_mov_b32 s19, 0x00020000
  s_mul_i32 s45, s58, 196608
  v_lshrrev_b32 v200, 4, v164
  v_bfe_u32 v201, v164, 1, 3
  v_xor_b32 v201, v201, v200
  v_and_b32 v202, 16, v195
  s_lshl_b32 s53, s42, 4
  v_add_u32 v200, s53, v200
  v_mul_u32_u24 v200, 3072, v200
  s_lshl_b32 s53, s7, 8
  v_add3_u32 v200, v200, v202, s53
  v_lshl_add_u32 v173, v201, 5, v200
  v_add_u32 v174, 12288, v173
  v_xor_b32 v200, 128, v173
  v_add_u32 v175, 24576, v200
  v_add_u32 v176, 36864, v200
  s_lshl_b32 s51, s42, 12
  s_add_u32 s52, s51, 36864
  s_add_u32 s51, s51, 20480
  s_add_u32 m0, s46, s51
  s_nop 0
  buffer_load_dwordx4 v173, s[12:15], s45 offen lds
  s_addk_i32 m0, 0x400
  s_nop 0
  buffer_load_dwordx4 v174, s[12:15], s45 offen lds
  s_addk_i32 m0, 0x400
  s_nop 0
  buffer_load_dwordx4 v175, s[12:15], s45 offen lds
  s_addk_i32 m0, 0x400
  s_nop 0
  buffer_load_dwordx4 v176, s[12:15], s45 offen lds
  s_add_u32 m0, s46, s52
  s_nop 0
  buffer_load_dwordx4 v173, s[16:19], s45 offen lds
  s_addk_i32 m0, 0x400
  s_nop 0
  buffer_load_dwordx4 v174, s[16:19], s45 offen lds
  s_addk_i32 m0, 0x400
  s_nop 0
  buffer_load_dwordx4 v175, s[16:19], s45 offen lds
  s_addk_i32 m0, 0x400
  s_nop 0
  buffer_load_dwordx4 v176, s[16:19], s45 offen lds
  s_lshr_b32 s56, s42, 1
  s_and_b32 s55, s42, 1
  s_mul_i32 s53, s56, 10240
  v_and_b32 v200, 15, v164
  v_lshrrev_b32 v201, 4, v164
  v_lshrrev_b32 v202, 1, v200
  v_xor_b32 v202, v202, v201
  v_lshlrev_b32 v203, 7, v200
  v_add_u32 v203, s53, v203
  v_lshl_add_u32 v178, v202, 4, v203
  v_xor_b32 v179, 64, v178
  v_lshrrev_b32 v208, 4, v164
  v_bfe_u32 v209, v164, 2, 2
  v_and_b32 v210, 3, v164
  v_lshl_add_u32 v211, v208, 3, v209
  v_and_b32 v200, 1, v208
  v_lshl_or_b32 v200, v200, 2, v209
  v_lshlrev_b32 v201, 8, v211
  v_lshl_add_u32 v201, v210, 3, v201
  v_add_u32 v201, 20480, v201
  s_lshl_b32 s53, s55, 2
  s_add_u32 s54, s53, 0
  v_xor_b32 v202, s54, v200
  v_lshl_add_u32 v180, v202, 5, v201
  s_add_u32 s54, s53, 1
  v_xor_b32 v202, s54, v200
  v_lshl_add_u32 v181, v202, 5, v201
  s_add_u32 s54, s53, 2
  v_xor_b32 v202, s54, v200
  v_lshl_add_u32 v182, v202, 5, v201
  s_add_u32 s54, s53, 3
  v_xor_b32 v202, s54, v200
  v_lshl_add_u32 v183, v202, 5, v201
  v_mov_b64 v[0:1], 0
  v_mov_b64 v[2:3], 0
  v_mov_b64 v[4:5], 0
  v_mov_b64 v[6:7], 0
  v_mov_b64 v[8:9], 0
  v_mov_b64 v[10:11], 0
  v_mov_b64 v[12:13], 0
  v_mov_b64 v[14:15], 0
  v_mov_b64 v[16:17], 0
  v_mov_b64 v[18:19], 0
  v_mov_b64 v[20:21], 0
  v_mov_b64 v[22:23], 0
  v_mov_b64 v[24:25], 0
  v_mov_b64 v[26:27], 0
  v_mov_b64 v[28:29], 0
  v_mov_b64 v[30:31], 0
  v_mov_b64 v[32:33], 0
  v_mov_b64 v[34:35], 0
  v_mov_b64 v[36:37], 0
  v_mov_b64 v[38:39], 0
  v_mov_b64 v[40:41], 0
  v_mov_b64 v[42:43], 0
  v_mov_b64 v[44:45], 0
  v_mov_b64 v[46:47], 0
  v_mov_b64 v[48:49], 0
  v_mov_b64 v[50:51], 0
  v_mov_b64 v[52:53], 0
  v_mov_b64 v[54:55], 0
  v_mov_b64 v[56:57], 0
  v_mov_b64 v[58:59], 0
  v_mov_b64 v[60:61], 0
  v_mov_b64 v[62:63], 0
  v_mov_b64 v[64:65], 0
  v_mov_b64 v[66:67], 0
  v_mov_b64 v[68:69], 0
  v_mov_b64 v[70:71], 0
  v_mov_b64 v[72:73], 0
  v_mov_b64 v[74:75], 0
  v_mov_b64 v[76:77], 0
  v_mov_b64 v[78:79], 0
  v_mov_b64 v[80:81], 0
  v_mov_b64 v[82:83], 0
  v_mov_b64 v[84:85], 0
  v_mov_b64 v[86:87], 0
  v_mov_b64 v[88:89], 0
  v_mov_b64 v[90:91], 0
  v_mov_b64 v[92:93], 0
  v_mov_b64 v[94:95], 0
  v_mov_b64 v[96:97], 0
  v_mov_b64 v[98:99], 0
  v_mov_b64 v[100:101], 0
  v_mov_b64 v[102:103], 0
  v_mov_b64 v[104:105], 0
  v_mov_b64 v[106:107], 0
  v_mov_b64 v[108:109], 0
  v_mov_b64 v[110:111], 0
  v_mov_b64 v[112:113], 0
  v_mov_b64 v[114:115], 0
  v_mov_b64 v[116:117], 0
  v_mov_b64 v[118:119], 0
  v_mov_b64 v[120:121], 0
  v_mov_b64 v[122:123], 0
  v_mov_b64 v[124:125], 0
  v_mov_b64 v[126:127], 0
  v_mov_b64 v[128:129], 0
  v_mov_b64 v[130:131], 0
  v_mov_b64 v[132:133], 0
  v_mov_b64 v[134:135], 0
  v_mov_b64 v[136:137], 0
  v_mov_b64 v[138:139], 0
  v_mov_b64 v[140:141], 0
  v_mov_b64 v[142:143], 0
  v_mov_b64 v[144:145], 0
  v_mov_b64 v[146:147], 0
  v_mov_b64 v[148:149], 0
  v_mov_b64 v[150:151], 0
  v_mov_b64 v[152:153], 0
  v_mov_b64 v[154:155], 0
  v_mov_b64 v[156:157], 0
  v_mov_b64 v[158:159], 0
  s_add_u32 s44, s44, 128
  s_add_u32 s45, s45, 196608
  s_cmp_eq_u32 s44, 1280
  s_cselect_b32 s44, 0, s44
  s_cselect_b32 s45, 0, s45
  s_mov_b32 s46, 53248
  s_add_u32 m0, s46, s51
  s_nop 0
  buffer_load_dwordx4 v173, s[12:15], s45 offen lds
  s_addk_i32 m0, 0x400
  s_nop 0
  buffer_load_dwordx4 v174, s[12:15], s45 offen lds
  s_addk_i32 m0, 0x400
  s_nop 0
  buffer_load_dwordx4 v175, s[12:15], s45 offen lds
  s_addk_i32 m0, 0x400
  s_nop 0
  buffer_load_dwordx4 v176, s[12:15], s45 offen lds
  s_add_u32 m0, s46, s52
  s_nop 0
  buffer_load_dwordx4 v173, s[16:19], s45 offen lds
  s_addk_i32 m0, 0x400
  s_nop 0
  buffer_load_dwordx4 v174, s[16:19], s45 offen lds
  s_addk_i32 m0, 0x400
  s_nop 0
  buffer_load_dwordx4 v175, s[16:19], s45 offen lds
  s_addk_i32 m0, 0x400
  s_nop 0
  buffer_load_dwordx4 v176, s[16:19], s45 offen lds
  s_add_u32 m0, s46, s50
  s_nop 0
  buffer_load_dwordx4 v165, s[8:11], s44 offen lds
  s_addk_i32 m0, 0x400
  s_nop 0
  buffer_load_dwordx4 v166, s[8:11], s44 offen lds
  s_addk_i32 m0, 0x400
  s_nop 0
  buffer_load_dwordx4 v167, s[8:11], s44 offen lds
  s_addk_i32 m0, 0x400
  s_nop 0
  buffer_load_dwordx4 v168, s[8:11], s44 offen lds
  s_addk_i32 m0, 0x400
  s_nop 0
  buffer_load_dwordx4 v169, s[8:11], s44 offen lds
  s_add_u32 s44, s44, 128
  s_add_u32 s45, s45, 196608
  s_cmp_eq_u32 s44, 1280
  s_cselect_b32 s44, 0, s44
  s_cselect_b32 s45, 0, s45
  s_mov_b32 s86, 819200
  s_cmp_lt_u32 s48, 96
  s_cselect_b32 s84, s36, s28
  s_cselect_b32 s85, s37, s29
  s_cselect_b32 s86, 1966080, s86
  s_mov_b32 s87, 0x00020000
  s_cselect_b32 s91, 0, 96
  s_cselect_b32 s92, 32, 20
  s_cselect_b64 s[94:95], -1, 0
  s_sub_u32 s91, s48, s91
  s_and_b32 s93, s91, 1
  s_lshr_b32 s91, s91, 1
  s_lshl_b32 s93, s93, 2
  s_add_u32 s93, s93, s42
  s_mov_b32 s88, s91
  s_mul_i32 s88, s88, s92
  s_mul_i32 s88, s88, 1280
  s_mul_i32 s53, s93, 160
  s_add_u32 s88, s88, s53
  s_mul_i32 s53, s93, 48
  s_add_u32 s53, s53, s91
  s_mul_i32 s53, s53, 5120
  s_add_u32 s53, s53, 9437184
  s_lshl_b32 s54, s91, 3
  s_add_u32 s54, s54, s93
  s_mul_i32 s54, s54, 5120
  s_add_u32 s54, s54, 12386304
  s_cmp_lt_u32 s48, 96
  s_cselect_b32 s89, s53, s54
  s_add_u32 s90, s89, 4096
  s_movk_i32 s54, 1280
  v_mov_b32 v207, 2147418112
  v_add_u32 v200, 0, v164
  v_mul_u32_u24 v201, 6554, v200
  v_lshrrev_b32 v201, 16, v201
  v_mul_u32_u24 v202, 10, v201
  v_sub_u32 v202, v200, v202
  v_bfe_u32 v203, v201, 2, 1
  v_lshlrev_b32 v203, 4, v203
  v_lshrrev_b32 v204, 3, v201
  v_lshl_add_u32 v203, v204, 2, v203
  v_and_b32 v204, 3, v201
  v_add_u32 v203, v203, v204
  v_cndmask_b32 v203, v201, v203, s[94:95]
  v_cmp_gt_u32 vcc, s92, v203
  v_mul_lo_u32 v203, v203, s54
  v_lshl_add_u32 v203, v202, 4, v203
  v_cndmask_b32 v185, v207, v203, vcc
  v_add_u32 v200, 64, v164
  v_mul_u32_u24 v201, 6554, v200
  v_lshrrev_b32 v201, 16, v201
  v_mul_u32_u24 v202, 10, v201
  v_sub_u32 v202, v200, v202
  v_bfe_u32 v203, v201, 2, 1
  v_lshlrev_b32 v203, 4, v203
  v_lshrrev_b32 v204, 3, v201
  v_lshl_add_u32 v203, v204, 2, v203
  v_and_b32 v204, 3, v201
  v_add_u32 v203, v203, v204
  v_cndmask_b32 v203, v201, v203, s[94:95]
  v_cmp_gt_u32 vcc, s92, v203
  v_mul_lo_u32 v203, v203, s54
  v_lshl_add_u32 v203, v202, 4, v203
  v_cndmask_b32 v186, v207, v203, vcc
  v_add_u32 v200, 128, v164
  v_mul_u32_u24 v201, 6554, v200
  v_lshrrev_b32 v201, 16, v201
  v_mul_u32_u24 v202, 10, v201
  v_sub_u32 v202, v200, v202
  v_bfe_u32 v203, v201, 2, 1
  v_lshlrev_b32 v203, 4, v203
  v_lshrrev_b32 v204, 3, v201
  v_lshl_add_u32 v203, v204, 2, v203
  v_and_b32 v204, 3, v201
  v_add_u32 v203, v203, v204
  v_cndmask_b32 v203, v201, v203, s[94:95]
  v_cmp_gt_u32 vcc, s92, v203
  v_mul_lo_u32 v203, v203, s54
  v_lshl_add_u32 v203, v202, 4, v203
  v_cndmask_b32 v187, v207, v203, vcc
  v_add_u32 v200, 192, v164
  v_mul_u32_u24 v201, 6554, v200
  v_lshrrev_b32 v201, 16, v201
  v_mul_u32_u24 v202, 10, v201
  v_sub_u32 v202, v200, v202
  v_bfe_u32 v203, v201, 2, 1
  v_lshlrev_b32 v203, 4, v203
  v_lshrrev_b32 v204, 3, v201
  v_lshl_add_u32 v203, v204, 2, v203
  v_and_b32 v204, 3, v201
  v_add_u32 v203, v203, v204
  v_cndmask_b32 v203, v201, v203, s[94:95]
  v_cmp_gt_u32 vcc, s92, v203
  v_mul_lo_u32 v203, v203, s54
  v_lshl_add_u32 v203, v202, 4, v203
  v_cndmask_b32 v188, v207, v203, vcc
  v_add_u32 v200, 256, v164
  v_mul_u32_u24 v201, 6554, v200
  v_lshrrev_b32 v201, 16, v201
  v_mul_u32_u24 v202, 10, v201
  v_sub_u32 v202, v200, v202
  v_bfe_u32 v203, v201, 2, 1
  v_lshlrev_b32 v203, 4, v203
  v_lshrrev_b32 v204, 3, v201
  v_lshl_add_u32 v203, v204, 2, v203
  v_and_b32 v204, 3, v201
  v_add_u32 v203, v203, v204
  v_cndmask_b32 v203, v201, v203, s[94:95]
  v_cmp_gt_u32 vcc, s92, v203
  v_mul_lo_u32 v203, v203, s54
  v_lshl_add_u32 v203, v202, 4, v203
  v_cndmask_b32 v189, v207, v203, vcc
  v_lshrrev_b32 v208, 4, v164
  v_bfe_u32 v209, v164, 2, 2
  v_and_b32 v210, 3, v164
  v_lshl_add_u32 v211, v208, 3, v209
  s_mul_i32 s53, s42, 5120
  s_add_u32 s53, s53, 106496
  v_mul_u32_u24 v200, 160, v211
  v_add_u32 v200, s53, v200
  v_lshl_add_u32 v190, v210, 4, v200
  v_lshl_add_u32 v191, v210, 3, v200
  v_add_u32 v192, s53, v195
  s_bfe_u32 s53, s2, 0x20001
  s_lshr_b32 s54, s2, 5
  s_lshl_b32 s53, s53, 3
  s_add_u32 s80, s53, s54
  s_and_b32 s53, s2, 1
  s_lshl_b32 s53, s53, 2
  s_bfe_u32 s54, s2, 0x20003
  s_add_u32 s81, s53, s54
  s_mul_i32 s53, s81, 48
  s_mul_i32 s54, s42, 12
  s_add_u32 s53, s53, s54
  s_mul_i32 s53, s53, 5120
  s_add_u32 s82, s53, 9437184
  s_and_b32 s53, s48, 127
  s_lshl_b32 s53, s53, 1
  s_lshr_b32 s54, s42, 1
  s_add_u32 s53, s53, s54
  s_mul_i32 s53, s53, 5120
  s_add_u32 s49, s53, 12386304
  s_lshl_b32 s53, s48, 8
  s_add_u32 s83, s53, 14737408
  s_waitcnt vmcnt(13)
  s_barrier
  ds_read_b128 a[0:3], v178 offset:0
  ds_read_b64_tr_b16 a[20:21], v180 offset:0
  ds_read_b64_tr_b16 a[22:23], v180 offset:1024
  ds_read_b64_tr_b16 a[24:25], v181 offset:0
  ds_read_b64_tr_b16 a[26:27], v181 offset:1024
  ds_read_b128 a[4:7], v178 offset:2048
  ds_read_b64_tr_b16 a[28:29], v182 offset:0
  ds_read_b64_tr_b16 a[30:31], v182 offset:1024
  ds_read_b64_tr_b16 a[32:33], v183 offset:0
  ds_read_b64_tr_b16 a[34:35], v183 offset:1024
  ds_read_b128 a[8:11], v178 offset:4096
  ds_read_b128 a[12:15], v178 offset:6144
  ds_read_b128 a[16:19], v178 offset:8192
  ds_read_b64_tr_b16 a[36:37], v180 offset:16384
  ds_read_b64_tr_b16 a[38:39], v180 offset:17408
  ds_read_b64_tr_b16 a[40:41], v181 offset:16384
  ds_read_b64_tr_b16 a[42:43], v181 offset:17408
  ds_read_b64_tr_b16 a[44:45], v182 offset:16384
  ds_read_b64_tr_b16 a[46:47], v182 offset:17408
  ds_read_b64_tr_b16 a[48:49], v183 offset:16384
  ds_read_b64_tr_b16 a[50:51], v183 offset:17408
  s_mov_b32 s46, 106496
  s_add_u32 m0, s46, s51
  s_nop 0
  buffer_load_dwordx4 v173, s[12:15], s45 offen lds
  s_addk_i32 m0, 0x400
  s_nop 0
  buffer_load_dwordx4 v174, s[12:15], s45 offen lds
  s_addk_i32 m0, 0x400
  s_nop 0
  buffer_load_dwordx4 v175, s[12:15], s45 offen lds
  s_addk_i32 m0, 0x400
  s_nop 0
  buffer_load_dwordx4 v176, s[12:15], s45 offen lds
  s_add_u32 m0, s46, s52
  s_nop 0
  buffer_load_dwordx4 v173, s[16:19], s45 offen lds
  s_addk_i32 m0, 0x400
  s_nop 0
  buffer_load_dwordx4 v174, s[16:19], s45 offen lds
  s_addk_i32 m0, 0x400
  s_nop 0
  buffer_load_dwordx4 v175, s[16:19], s45 offen lds
  s_cmp_eq_u32 s42, 0
  s_cselect_b32 s91, 26, 10
  s_cselect_b32 s92, 84, 4
  s_mov_b32 s43, -1
  s_mov_b32 s59, 53248
  s_mov_b32 s47, 4294860800
  s_waitcnt lgkmcnt(0)
  s_mul_i32 s100, s100, 0x9E3779B1
  s_add_u32 s100, s100, 0x7F4A7C15
  v_mov_b32 v196, s100
  s_and_b32 s93, s2, 31
  s_lshl_b32 s93, s93, 8
  s_lshr_b32 s53, s2, 5
  s_lshl_b32 s53, s53, 2
  s_add_u32 s93, s93, s53
  s_add_u32 s93, s93, 14696448
  v_lshrrev_b32 v198, 1, v164
  v_lshlrev_b32 v198, 8, v198
  v_and_b32 v243, 16, v195
  s_mov_b32 s53, 14696448
  v_add3_u32 v198, v198, v243, s53
  s_branch L_gu_mid
L_gu_evT:
  s_cmp_lg_u32 s43, 2
  s_cbranch_scc1 L_gu_evT2
  ds_write_b128 v192, a[140:143] offset:0
  ds_write_b128 v192, a[144:147] offset:1024
  ds_write_b128 v192, a[148:151] offset:2048
  ds_write_b128 v192, a[152:155] offset:3072
  ds_write_b128 v192, a[156:159] offset:4096
  ds_read_b64_tr_b16 a[120:121], v190 offset:0
  ds_read_b64_tr_b16 a[122:123], v190 offset:640
  ds_read_b64_tr_b16 a[124:125], v190 offset:8
  ds_read_b64_tr_b16 a[126:127], v190 offset:648
  ds_read_b64_tr_b16 a[128:129], v190 offset:64
  ds_read_b64_tr_b16 a[130:131], v190 offset:704
  ds_read_b64_tr_b16 a[132:133], v190 offset:72
  ds_read_b64_tr_b16 a[134:135], v190 offset:712
  ds_read_b64_tr_b16 a[136:137], v191 offset:128
  ds_read_b64_tr_b16 a[138:139], v191 offset:768
  s_branch L_gu_evT_ret
L_gu_evT2:
  s_cmp_lg_u32 s43, 4
  s_cbranch_scc1 L_gu_evT3
  s_mov_b64 exec, 1
  buffer_store_dword v196, off, s[20:23], s93 sc1
  s_mov_b64 exec, -1
  s_branch L_gu_evT_ret
L_gu_evT3:
  buffer_load_dwordx4 v[244:247], v198, s[20:23], 0 offen sc1
  s_branch L_gu_evT_ret
L_gu_evE:
  s_cmp_lg_u32 s43, 1
  s_cbranch_scc1 L_gu_evE2
  buffer_load_dwordx4 a[140:143], v185, s[84:87], s88 offen
  buffer_load_dwordx4 a[144:147], v186, s[84:87], s88 offen
  buffer_load_dwordx4 a[148:151], v187, s[84:87], s88 offen
  buffer_load_dwordx4 a[152:155], v188, s[84:87], s88 offen
  buffer_load_dwordx4 a[156:159], v189, s[84:87], s88 offen
  s_branch L_gu_evE_ret
L_gu_evE2:
  s_cmp_lg_u32 s43, 3
  s_cbranch_scc1 L_gu_evE3
  buffer_store_dwordx4 a[120:123], v195, s[20:23], s89 offen offset:0 sc1
  buffer_store_dwordx4 a[124:127], v195, s[20:23], s89 offen offset:1024 sc1
  buffer_store_dwordx4 a[128:131], v195, s[20:23], s89 offen offset:2048 sc1
  buffer_store_dwordx4 a[132:135], v195, s[20:23], s89 offen offset:3072 sc1
  buffer_store_dwordx4 a[136:139], v195, s[20:23], s90 offen sc1
  s_branch L_gu_evE_ret
L_gu_evE3:
  s_cmp_lg_u32 s43, 4
  s_cbranch_scc1 L_gu_evE4
  v_lshlrev_b32 v240, 7, v164
  s_mul_i32 s53, s2, 3200
  s_add_u32 s53, s53, 11403264
  s_mov_b64 exec, 0x1ffffff
  buffer_load_dword v241, v240, s[20:23], s53 offen sc1
  s_mul_i32 s53, s2, 640
  s_add_u32 s53, s53, 14680064
  s_mov_b64 exec, 0x1f
  buffer_load_dword v241, v240, s[20:23], s53 offen sc1
  s_mov_b64 exec, -1
  s_branch L_gu_evE_ret
L_gu_evE4:
  s_mov_b64 exec, 1
  buffer_store_dword v196, off, s[20:23], s93 sc1
  s_mov_b64 exec, -1
  s_branch L_gu_evE_ret
L_gu_A:
  s_waitcnt vmcnt(13) lgkmcnt(0)
  s_barrier
  v_add_u32 v178, s47, v178
  v_add_u32 v179, s47, v179
  v_add_u32 v180, s47, v180
  v_add_u32 v181, s47, v181
  v_add_u32 v182, s47, v182
  v_add_u32 v183, s47, v183
  s_bitcmp1_b32 s92, s43
  s_cbranch_scc1 L_gu_evT
L_gu_evT_ret:
  v_mfma_f32_16x16x32_bf16 v[0:3], a[76:79], a[56:59], v[0:3]
  ds_read_b128 a[0:3], v178 offset:0
  v_mfma_f32_16x16x32_bf16 v[4:7], a[80:83], a[56:59], v[4:7]
  ds_read_b64_tr_b16 a[20:21], v180 offset:0
  s_add_u32 m0, s46, s51
  v_mfma_f32_16x16x32_bf16 v[8:11], a[84:87], a[56:59], v[8:11]
  buffer_load_dwordx4 v173, s[12:15], s45 offen lds
  v_mfma_f32_16x16x32_bf16 v[12:15], a[88:91], a[56:59], v[12:15]
  ds_read_b64_tr_b16 a[22:23], v180 offset:1024
  v_mfma_f32_16x16x32_bf16 v[16:19], a[92:95], a[56:59], v[16:19]
  ds_read_b64_tr_b16 a[24:25], v181 offset:0
  v_mfma_f32_16x16x32_bf16 v[20:23], a[96:99], a[56:59], v[20:23]
  v_mfma_f32_16x16x32_bf16 v[24:27], a[100:103], a[56:59], v[24:27]
  ds_read_b64_tr_b16 a[26:27], v181 offset:1024
  v_mfma_f32_16x16x32_bf16 v[28:31], a[104:107], a[56:59], v[28:31]
  ds_read_b128 a[4:7], v178 offset:2048
  s_addk_i32 m0, 0x400
  v_mfma_f32_16x16x32_bf16 v[32:35], a[76:79], a[60:63], v[32:35]
  buffer_load_dwordx4 v174, s[12:15], s45 offen lds
  v_mfma_f32_16x16x32_bf16 v[36:39], a[80:83], a[60:63], v[36:39]
  ds_read_b64_tr_b16 a[28:29], v182 offset:0
  v_mfma_f32_16x16x32_bf16 v[40:43], a[84:87], a[60:63], v[40:43]
  ds_read_b64_tr_b16 a[30:31], v182 offset:1024
  v_mfma_f32_16x16x32_bf16 v[44:47], a[88:91], a[60:63], v[44:47]
  v_mfma_f32_16x16x32_bf16 v[48:51], a[92:95], a[60:63], v[48:51]
  ds_read_b64_tr_b16 a[32:33], v183 offset:0
  v_mfma_f32_16x16x32_bf16 v[52:55], a[96:99], a[60:63], v[52:55]
  ds_read_b64_tr_b16 a[34:35], v183 offset:1024
  s_addk_i32 m0, 0x400
  v_mfma_f32_16x16x32_bf16 v[56:59], a[100:103], a[60:63], v[56:59]
  buffer_load_dwordx4 v175, s[12:15], s45 offen lds
  v_mfma_f32_16x16x32_bf16 v[60:63], a[104:107], a[60:63], v[60:63]
  ds_read_b128 a[8:11], v178 offset:4096
  v_mfma_f32_16x16x32_bf16 v[64:67], a[76:79], a[64:67], v[64:67]
  ds_read_b128 a[12:15], v178 offset:6144
  v_mfma_f32_16x16x32_bf16 v[68:71], a[80:83], a[64:67], v[68:71]
  v_mfma_f32_16x16x32_bf16 v[72:75], a[84:87], a[64:67], v[72:75]
  ds_read_b128 a[16:19], v178 offset:8192
  v_mfma_f32_16x16x32_bf16 v[76:79], a[88:91], a[64:67], v[76:79]
  ds_read_b64_tr_b16 a[36:37], v180 offset:16384
  s_addk_i32 m0, 0x400
  v_mfma_f32_16x16x32_bf16 v[80:83], a[92:95], a[64:67], v[80:83]
  buffer_load_dwordx4 v176, s[12:15], s45 offen lds
  v_mfma_f32_16x16x32_bf16 v[84:87], a[96:99], a[64:67], v[84:87]
  ds_read_b64_tr_b16 a[38:39], v180 offset:17408
  v_mfma_f32_16x16x32_bf16 v[88:91], a[100:103], a[64:67], v[88:91]
  ds_read_b64_tr_b16 a[40:41], v181 offset:16384
  v_mfma_f32_16x16x32_bf16 v[92:95], a[104:107], a[64:67], v[92:95]
  v_mfma_f32_16x16x32_bf16 v[96:99], a[76:79], a[68:71], v[96:99]
  ds_read_b64_tr_b16 a[42:43], v181 offset:17408
  v_mfma_f32_16x16x32_bf16 v[100:103], a[80:83], a[68:71], v[100:103]
  ds_read_b64_tr_b16 a[44:45], v182 offset:16384
  s_add_u32 m0, s46, s52
  v_mfma_f32_16x16x32_bf16 v[104:107], a[84:87], a[68:71], v[104:107]
  buffer_load_dwordx4 v173, s[16:19], s45 offen lds
  v_mfma_f32_16x16x32_bf16 v[108:111], a[88:91], a[68:71], v[108:111]
  ds_read_b64_tr_b16 a[46:47], v182 offset:17408
  v_mfma_f32_16x16x32_bf16 v[112:115], a[92:95], a[68:71], v[112:115]
  ds_read_b64_tr_b16 a[48:49], v183 offset:16384
  v_mfma_f32_16x16x32_bf16 v[116:119], a[96:99], a[68:71], v[116:119]
  v_mfma_f32_16x16x32_bf16 v[120:123], a[100:103], a[68:71], v[120:123]
  ds_read_b64_tr_b16 a[50:51], v183 offset:17408
  v_mfma_f32_16x16x32_bf16 v[124:127], a[104:107], a[68:71], v[124:127]
  s_addk_i32 m0, 0x400
  v_mfma_f32_16x16x32_bf16 v[128:131], a[76:79], a[72:75], v[128:131]
  buffer_load_dwordx4 v174, s[16:19], s45 offen lds
  v_mfma_f32_16x16x32_bf16 v[132:135], a[80:83], a[72:75], v[132:135]
  v_mfma_f32_16x16x32_bf16 v[136:139], a[84:87], a[72:75], v[136:139]
  v_mfma_f32_16x16x32_bf16 v[140:143], a[88:91], a[72:75], v[140:143]
  v_mfma_f32_16x16x32_bf16 v[144:147], a[92:95], a[72:75], v[144:147]
  v_mfma_f32_16x16x32_bf16 v[148:151], a[96:99], a[72:75], v[148:151]
  s_addk_i32 m0, 0x400
  v_mfma_f32_16x16x32_bf16 v[152:155], a[100:103], a[72:75], v[152:155]
  buffer_load_dwordx4 v175, s[16:19], s45 offen lds
  v_mfma_f32_16x16x32_bf16 v[156:159], a[104:107], a[72:75], v[156:159]
L_gu_mid:
  s_waitcnt lgkmcnt(0)
  v_mfma_f32_16x16x32_bf16 v[0:3], a[20:23], a[0:3], v[0:3]
  ds_read_b128 a[56:59], v179 offset:0
  v_mfma_f32_16x16x32_bf16 v[4:7], a[24:27], a[0:3], v[4:7]
  ds_read_b64_tr_b16 a[76:77], v180 offset:8192
  v_mfma_f32_16x16x32_bf16 v[8:11], a[28:31], a[0:3], v[8:11]
  s_addk_i32 m0, 0x400
  v_mfma_f32_16x16x32_bf16 v[12:15], a[32:35], a[0:3], v[12:15]
  ds_read_b64_tr_b16 a[78:79], v180 offset:9216
  buffer_load_dwordx4 v176, s[16:19], s45 offen lds
  v_mfma_f32_16x16x32_bf16 v[16:19], a[36:39], a[0:3], v[16:19]
  ds_read_b64_tr_b16 a[80:81], v181 offset:8192
  v_mfma_f32_16x16x32_bf16 v[20:23], a[40:43], a[0:3], v[20:23]
  v_mfma_f32_16x16x32_bf16 v[24:27], a[44:47], a[0:3], v[24:27]
  ds_read_b64_tr_b16 a[82:83], v181 offset:9216
  v_mfma_f32_16x16x32_bf16 v[28:31], a[48:51], a[0:3], v[28:31]
  ds_read_b128 a[60:63], v179 offset:2048
  v_mfma_f32_16x16x32_bf16 v[32:35], a[20:23], a[4:7], v[32:35]
  s_add_u32 m0, s46, s50
  v_mfma_f32_16x16x32_bf16 v[36:39], a[24:27], a[4:7], v[36:39]
  ds_read_b64_tr_b16 a[84:85], v182 offset:8192
  buffer_load_dwordx4 v165, s[8:11], s44 offen lds
  v_mfma_f32_16x16x32_bf16 v[40:43], a[28:31], a[4:7], v[40:43]
  ds_read_b64_tr_b16 a[86:87], v182 offset:9216
  v_mfma_f32_16x16x32_bf16 v[44:47], a[32:35], a[4:7], v[44:47]
  v_mfma_f32_16x16x32_bf16 v[48:51], a[36:39], a[4:7], v[48:51]
  ds_read_b64_tr_b16 a[88:89], v183 offset:8192
  v_mfma_f32_16x16x32_bf16 v[52:55], a[40:43], a[4:7], v[52:55]
  ds_read_b64_tr_b16 a[90:91], v183 offset:9216
  v_mfma_f32_16x16x32_bf16 v[56:59], a[44:47], a[4:7], v[56:59]
  s_addk_i32 m0, 0x400
  v_mfma_f32_16x16x32_bf16 v[60:63], a[48:51], a[4:7], v[60:63]
  ds_read_b128 a[64:67], v179 offset:4096
  buffer_load_dwordx4 v166, s[8:11], s44 offen lds
  v_mfma_f32_16x16x32_bf16 v[64:67], a[20:23], a[8:11], v[64:67]
  ds_read_b128 a[68:71], v179 offset:6144
  v_mfma_f32_16x16x32_bf16 v[68:71], a[24:27], a[8:11], v[68:71]
  v_mfma_f32_16x16x32_bf16 v[72:75], a[28:31], a[8:11], v[72:75]
  ds_read_b128 a[72:75], v179 offset:8192
  v_mfma_f32_16x16x32_bf16 v[76:79], a[32:35], a[8:11], v[76:79]
  ds_read_b64_tr_b16 a[92:93], v180 offset:24576
  v_mfma_f32_16x16x32_bf16 v[80:83], a[36:39], a[8:11], v[80:83]
  s_addk_i32 m0, 0x400
  v_mfma_f32_16x16x32_bf16 v[84:87], a[40:43], a[8:11], v[84:87]
  ds_read_b64_tr_b16 a[94:95], v180 offset:25600
  buffer_load_dwordx4 v167, s[8:11], s44 offen lds
  v_mfma_f32_16x16x32_bf16 v[88:91], a[44:47], a[8:11], v[88:91]
  ds_read_b64_tr_b16 a[96:97], v181 offset:24576
  v_mfma_f32_16x16x32_bf16 v[92:95], a[48:51], a[8:11], v[92:95]
  v_mfma_f32_16x16x32_bf16 v[96:99], a[20:23], a[12:15], v[96:99]
  ds_read_b64_tr_b16 a[98:99], v181 offset:25600
  v_mfma_f32_16x16x32_bf16 v[100:103], a[24:27], a[12:15], v[100:103]
  ds_read_b64_tr_b16 a[100:101], v182 offset:24576
  v_mfma_f32_16x16x32_bf16 v[104:107], a[28:31], a[12:15], v[104:107]
  s_addk_i32 m0, 0x400
  v_mfma_f32_16x16x32_bf16 v[108:111], a[32:35], a[12:15], v[108:111]
  ds_read_b64_tr_b16 a[102:103], v182 offset:25600
  buffer_load_dwordx4 v168, s[8:11], s44 offen lds
  v_mfma_f32_16x16x32_bf16 v[112:115], a[36:39], a[12:15], v[112:115]
  ds_read_b64_tr_b16 a[104:105], v183 offset:24576
  v_mfma_f32_16x16x32_bf16 v[116:119], a[40:43], a[12:15], v[116:119]
  v_mfma_f32_16x16x32_bf16 v[120:123], a[44:47], a[12:15], v[120:123]
  ds_read_b64_tr_b16 a[106:107], v183 offset:25600
  v_mfma_f32_16x16x32_bf16 v[124:127], a[48:51], a[12:15], v[124:127]
  v_mfma_f32_16x16x32_bf16 v[128:131], a[20:23], a[16:19], v[128:131]
  s_addk_i32 m0, 0x400
  v_mfma_f32_16x16x32_bf16 v[132:135], a[24:27], a[16:19], v[132:135]
  buffer_load_dwordx4 v169, s[8:11], s44 offen lds
  v_mfma_f32_16x16x32_bf16 v[136:139], a[28:31], a[16:19], v[136:139]
  s_add_u32 s44, s44, 128
  s_add_u32 s45, s45, 196608
  s_cmp_eq_u32 s44, 1280
  s_cselect_b32 s44, 0, s44
  s_cselect_b32 s45, 0, s45
  v_mfma_f32_16x16x32_bf16 v[140:143], a[32:35], a[16:19], v[140:143]
  s_add_u32 s46, s46, s47
  s_add_u32 s43, s43, 1
  v_mfma_f32_16x16x32_bf16 v[144:147], a[36:39], a[16:19], v[144:147]
  s_cmp_eq_u32 s46, 106496
  s_cselect_b32 s47, 4294860800, s59
  v_mfma_f32_16x16x32_bf16 v[148:151], a[40:43], a[16:19], v[148:151]
  v_mfma_f32_16x16x32_bf16 v[152:155], a[44:47], a[16:19], v[152:155]
  s_bitcmp1_b32 s91, s43
  v_mfma_f32_16x16x32_bf16 v[156:159], a[48:51], a[16:19], v[156:159]
  s_cbranch_scc1 L_gu_evE
L_gu_evE_ret:
  s_cmp_lt_u32 s43, 7
  s_cbranch_scc1 L_gu_A
  s_waitcnt vmcnt(13) lgkmcnt(0)
  s_cmp_lg_u32 s42, 0
  s_cbranch_scc1 L_gufw_done
  s_mov_b32 s57, 0
L_gufw_poll:
  v_cmp_eq_u32 vcc, s100, v244
  v_cmp_eq_u32 s[76:77], s100, v245
  s_nop 0
  s_and_b64 vcc, vcc, s[76:77]
  v_cmp_eq_u32 s[76:77], s100, v246
  s_nop 0
  s_and_b64 vcc, vcc, s[76:77]
  v_cmp_eq_u32 s[76:77], s100, v247
  s_nop 0
  s_and_b64 vcc, vcc, s[76:77]
  s_cmp_eq_u64 vcc, -1
  s_cbranch_scc1 L_gufw_ok
  s_add_u32 s57, s57, 1
  s_cmp_gt_u32 s57, 131072
  s_cbranch_scc1 L_gufw_ok
  s_sleep 8
  buffer_load_dwordx4 v[244:247], v198, s[20:23], 0 offen sc1
  s_waitcnt vmcnt(0)
  s_branch L_gufw_poll
L_gufw_ok:
L_gufw_done:
  s_barrier
  v_add_u32 v178, 53248, v178
  v_add_u32 v179, 53248, v179
  v_add_u32 v180, 53248, v180
  v_add_u32 v181, 53248, v181
  v_add_u32 v182, 53248, v182
  v_add_u32 v183, 53248, v183
  v_mfma_f32_16x16x32_bf16 v[0:3], a[76:79], a[56:59], v[0:3]
  ds_read_b128 a[0:3], v178 offset:0
  v_mfma_f32_16x16x32_bf16 v[4:7], a[80:83], a[56:59], v[4:7]
  ds_read_b64_tr_b16 a[20:21], v180 offset:0
  buffer_load_dwordx4 a[120:123], v195, s[20:23], s82 offen offset:0 sc1
  v_mfma_f32_16x16x32_bf16 v[8:11], a[84:87], a[56:59], v[8:11]
  v_mfma_f32_16x16x32_bf16 v[12:15], a[88:91], a[56:59], v[12:15]
  ds_read_b64_tr_b16 a[22:23], v180 offset:1024
  v_mfma_f32_16x16x32_bf16 v[16:19], a[92:95], a[56:59], v[16:19]
  ds_read_b64_tr_b16 a[24:25], v181 offset:0
  buffer_load_dwordx4 a[124:127], v195, s[20:23], s82 offen offset:1024 sc1
  v_mfma_f32_16x16x32_bf16 v[20:23], a[96:99], a[56:59], v[20:23]
  v_mfma_f32_16x16x32_bf16 v[24:27], a[100:103], a[56:59], v[24:27]
  ds_read_b64_tr_b16 a[26:27], v181 offset:1024
  v_mfma_f32_16x16x32_bf16 v[28:31], a[104:107], a[56:59], v[28:31]
  ds_read_b128 a[4:7], v178 offset:2048
  v_mfma_f32_16x16x32_bf16 v[32:35], a[76:79], a[60:63], v[32:35]
  buffer_load_dwordx4 a[128:131], v195, s[20:23], s82 offen offset:2048 sc1
  v_mfma_f32_16x16x32_bf16 v[36:39], a[80:83], a[60:63], v[36:39]
  ds_read_b64_tr_b16 a[28:29], v182 offset:0
  v_mfma_f32_16x16x32_bf16 v[40:43], a[84:87], a[60:63], v[40:43]
  ds_read_b64_tr_b16 a[30:31], v182 offset:1024
  v_mfma_f32_16x16x32_bf16 v[44:47], a[88:91], a[60:63], v[44:47]
  v_mfma_f32_16x16x32_bf16 v[48:51], a[92:95], a[60:63], v[48:51]
  ds_read_b64_tr_b16 a[32:33], v183 offset:0
  buffer_load_dwordx4 a[132:135], v195, s[20:23], s82 offen offset:3072 sc1
  v_mfma_f32_16x16x32_bf16 v[52:55], a[96:99], a[60:63], v[52:55]
  ds_read_b64_tr_b16 a[34:35], v183 offset:1024
  v_mfma_f32_16x16x32_bf16 v[56:59], a[100:103], a[60:63], v[56:59]
  v_mfma_f32_16x16x32_bf16 v[60:63], a[104:107], a[60:63], v[60:63]
  ds_read_b128 a[8:11], v178 offset:4096
  s_addk_i32 s82, 0x1000
  buffer_load_dwordx4 a[136:139], v195, s[20:23], s82 offen offset:0 sc1
  v_mfma_f32_16x16x32_bf16 v[64:67], a[76:79], a[64:67], v[64:67]
  ds_read_b128 a[12:15], v178 offset:6144
  v_mfma_f32_16x16x32_bf16 v[68:71], a[80:83], a[64:67], v[68:71]
  v_mfma_f32_16x16x32_bf16 v[72:75], a[84:87], a[64:67], v[72:75]
  ds_read_b128 a[16:19], v178 offset:8192
  v_mfma_f32_16x16x32_bf16 v[76:79], a[88:91], a[64:67], v[76:79]
  ds_read_b64_tr_b16 a[36:37], v180 offset:16384
  buffer_load_dwordx4 a[140:143], v195, s[20:23], s82 offen offset:1024 sc1
  v_mfma_f32_16x16x32_bf16 v[80:83], a[92:95], a[64:67], v[80:83]
  v_mfma_f32_16x16x32_bf16 v[84:87], a[96:99], a[64:67], v[84:87]
  ds_read_b64_tr_b16 a[38:39], v180 offset:17408
  v_mfma_f32_16x16x32_bf16 v[88:91], a[100:103], a[64:67], v[88:91]
  ds_read_b64_tr_b16 a[40:41], v181 offset:16384
  v_mfma_f32_16x16x32_bf16 v[92:95], a[104:107], a[64:67], v[92:95]
  buffer_load_dwordx4 a[144:147], v195, s[20:23], s82 offen offset:2048 sc1
  v_mfma_f32_16x16x32_bf16 v[96:99], a[76:79], a[68:71], v[96:99]
  ds_read_b64_tr_b16 a[42:43], v181 offset:17408
  v_mfma_f32_16x16x32_bf16 v[100:103], a[80:83], a[68:71], v[100:103]
  ds_read_b64_tr_b16 a[44:45], v182 offset:16384
  v_mfma_f32_16x16x32_bf16 v[104:107], a[84:87], a[68:71], v[104:107]
  buffer_load_dwordx4 a[148:151], v195, s[20:23], s82 offen offset:3072 sc1
  v_mfma_f32_16x16x32_bf16 v[108:111], a[88:91], a[68:71], v[108:111]
  ds_read_b64_tr_b16 a[46:47], v182 offset:17408
  v_mfma_f32_16x16x32_bf16 v[112:115], a[92:95], a[68:71], v[112:115]
  ds_read_b64_tr_b16 a[48:49], v183 offset:16384
  v_mfma_f32_16x16x32_bf16 v[116:119], a[96:99], a[68:71], v[116:119]
  v_mfma_f32_16x16x32_bf16 v[120:123], a[100:103], a[68:71], v[120:123]
  ds_read_b64_tr_b16 a[50:51], v183 offset:17408
  s_addk_i32 s82, 0x1000
  buffer_load_dwordx4 a[152:155], v195, s[20:23], s82 offen offset:0 sc1
  v_mfma_f32_16x16x32_bf16 v[124:127], a[104:107], a[68:71], v[124:127]
  v_mfma_f32_16x16x32_bf16 v[128:131], a[76:79], a[72:75], v[128:131]
  v_mfma_f32_16x16x32_bf16 v[132:135], a[80:83], a[72:75], v[132:135]
  v_mfma_f32_16x16x32_bf16 v[136:139], a[84:87], a[72:75], v[136:139]
  buffer_load_dwordx4 a[156:159], v195, s[20:23], s82 offen offset:1024 sc1
  v_mfma_f32_16x16x32_bf16 v[140:143], a[88:91], a[72:75], v[140:143]
  v_mfma_f32_16x16x32_bf16 v[144:147], a[92:95], a[72:75], v[144:147]
  v_mfma_f32_16x16x32_bf16 v[148:151], a[96:99], a[72:75], v[148:151]
  v_mfma_f32_16x16x32_bf16 v[152:155], a[100:103], a[72:75], v[152:155]
  v_mfma_f32_16x16x32_bf16 v[156:159], a[104:107], a[72:75], v[156:159]
  s_waitcnt lgkmcnt(0)
  v_mfma_f32_16x16x32_bf16 v[0:3], a[20:23], a[0:3], v[0:3]
  ds_read_b128 a[56:59], v179 offset:0
  v_mfma_f32_16x16x32_bf16 v[4:7], a[24:27], a[0:3], v[4:7]
  ds_read_b64_tr_b16 a[76:77], v180 offset:8192
  buffer_load_dwordx4 a[160:163], v195, s[20:23], s82 offen offset:2048 sc1
  v_mfma_f32_16x16x32_bf16 v[8:11], a[28:31], a[0:3], v[8:11]
  v_mfma_f32_16x16x32_bf16 v[12:15], a[32:35], a[0:3], v[12:15]
  ds_read_b64_tr_b16 a[78:79], v180 offset:9216
  v_mfma_f32_16x16x32_bf16 v[16:19], a[36:39], a[0:3], v[16:19]
  ds_read_b64_tr_b16 a[80:81], v181 offset:8192
  buffer_load_dwordx4 a[164:167], v195, s[20:23], s82 offen offset:3072 sc1
  v_mfma_f32_16x16x32_bf16 v[20:23], a[40:43], a[0:3], v[20:23]
  v_mfma_f32_16x16x32_bf16 v[24:27], a[44:47], a[0:3], v[24:27]
  ds_read_b64_tr_b16 a[82:83], v181 offset:9216
  v_mfma_f32_16x16x32_bf16 v[28:31], a[48:51], a[0:3], v[28:31]
  ds_read_b128 a[60:63], v179 offset:2048
  s_addk_i32 s82, 0x1000
  buffer_load_dwordx4 a[168:171], v195, s[20:23], s82 offen offset:0 sc1
  v_mfma_f32_16x16x32_bf16 v[32:35], a[20:23], a[4:7], v[32:35]
  v_mfma_f32_16x16x32_bf16 v[36:39], a[24:27], a[4:7], v[36:39]
  ds_read_b64_tr_b16 a[84:85], v182 offset:8192
  v_mfma_f32_16x16x32_bf16 v[40:43], a[28:31], a[4:7], v[40:43]
  ds_read_b64_tr_b16 a[86:87], v182 offset:9216
  buffer_load_dwordx4 a[172:175], v195, s[20:23], s82 offen offset:1024 sc1
  v_mfma_f32_16x16x32_bf16 v[44:47], a[32:35], a[4:7], v[44:47]
  v_mfma_f32_16x16x32_bf16 v[48:51], a[36:39], a[4:7], v[48:51]
  ds_read_b64_tr_b16 a[88:89], v183 offset:8192
  v_mfma_f32_16x16x32_bf16 v[52:55], a[40:43], a[4:7], v[52:55]
  ds_read_b64_tr_b16 a[90:91], v183 offset:9216
  buffer_load_dwordx4 a[176:179], v195, s[20:23], s82 offen offset:2048 sc1
  v_mfma_f32_16x16x32_bf16 v[56:59], a[44:47], a[4:7], v[56:59]
  v_mfma_f32_16x16x32_bf16 v[60:63], a[48:51], a[4:7], v[60:63]
  ds_read_b128 a[64:67], v179 offset:4096
  v_mfma_f32_16x16x32_bf16 v[64:67], a[20:23], a[8:11], v[64:67]
  ds_read_b128 a[68:71], v179 offset:6144
  buffer_load_dwordx4 a[180:183], v195, s[20:23], s82 offen offset:3072 sc1
  v_mfma_f32_16x16x32_bf16 v[68:71], a[24:27], a[8:11], v[68:71]
  v_mfma_f32_16x16x32_bf16 v[72:75], a[28:31], a[8:11], v[72:75]
  ds_read_b128 a[72:75], v179 offset:8192
  v_mfma_f32_16x16x32_bf16 v[76:79], a[32:35], a[8:11], v[76:79]
  ds_read_b64_tr_b16 a[92:93], v180 offset:24576
  s_addk_i32 s82, 0x1000
  buffer_load_dwordx4 a[184:187], v195, s[20:23], s82 offen offset:0 sc1
  v_mfma_f32_16x16x32_bf16 v[80:83], a[36:39], a[8:11], v[80:83]
  v_mfma_f32_16x16x32_bf16 v[84:87], a[40:43], a[8:11], v[84:87]
  ds_read_b64_tr_b16 a[94:95], v180 offset:25600
  v_mfma_f32_16x16x32_bf16 v[88:91], a[44:47], a[8:11], v[88:91]
  ds_read_b64_tr_b16 a[96:97], v181 offset:24576
  buffer_load_dwordx4 a[188:191], v195, s[20:23], s82 offen offset:1024 sc1
  v_mfma_f32_16x16x32_bf16 v[92:95], a[48:51], a[8:11], v[92:95]
  v_mfma_f32_16x16x32_bf16 v[96:99], a[20:23], a[12:15], v[96:99]
  ds_read_b64_tr_b16 a[98:99], v181 offset:25600
  v_mfma_f32_16x16x32_bf16 v[100:103], a[24:27], a[12:15], v[100:103]
  ds_read_b64_tr_b16 a[100:101], v182 offset:24576
  buffer_load_dwordx4 a[192:195], v195, s[20:23], s82 offen offset:2048 sc1
  v_mfma_f32_16x16x32_bf16 v[104:107], a[28:31], a[12:15], v[104:107]
  v_mfma_f32_16x16x32_bf16 v[108:111], a[32:35], a[12:15], v[108:111]
  ds_read_b64_tr_b16 a[102:103], v182 offset:25600
  v_mfma_f32_16x16x32_bf16 v[112:115], a[36:39], a[12:15], v[112:115]
  ds_read_b64_tr_b16 a[104:105], v183 offset:24576
  buffer_load_dwordx4 a[196:199], v195, s[20:23], s82 offen offset:3072 sc1
  v_mfma_f32_16x16x32_bf16 v[116:119], a[40:43], a[12:15], v[116:119]
  v_mfma_f32_16x16x32_bf16 v[120:123], a[44:47], a[12:15], v[120:123]
  ds_read_b64_tr_b16 a[106:107], v183 offset:25600
  v_mfma_f32_16x16x32_bf16 v[124:127], a[48:51], a[12:15], v[124:127]
  s_addk_i32 s82, 0x1000
  buffer_load_dwordx4 a[200:203], v195, s[20:23], s82 offen offset:0 sc1
  v_mfma_f32_16x16x32_bf16 v[128:131], a[20:23], a[16:19], v[128:131]
  v_mfma_f32_16x16x32_bf16 v[132:135], a[24:27], a[16:19], v[132:135]
  v_mfma_f32_16x16x32_bf16 v[136:139], a[28:31], a[16:19], v[136:139]
  buffer_load_dwordx4 a[204:207], v195, s[20:23], s82 offen offset:1024 sc1
  v_mfma_f32_16x16x32_bf16 v[140:143], a[32:35], a[16:19], v[140:143]
  v_mfma_f32_16x16x32_bf16 v[144:147], a[36:39], a[16:19], v[144:147]
  v_mfma_f32_16x16x32_bf16 v[148:151], a[40:43], a[16:19], v[148:151]
  v_mfma_f32_16x16x32_bf16 v[152:155], a[44:47], a[16:19], v[152:155]
  v_mfma_f32_16x16x32_bf16 v[156:159], a[48:51], a[16:19], v[156:159]
  s_waitcnt vmcnt(22) lgkmcnt(0)
  s_barrier
  v_add_u32 v178, 4294860800, v178
  v_add_u32 v179, 4294860800, v179
  v_add_u32 v180, 4294860800, v180
  v_add_u32 v181, 4294860800, v181
  v_add_u32 v182, 4294860800, v182
  v_add_u32 v183, 4294860800, v183
  v_mfma_f32_16x16x32_bf16 v[0:3], a[76:79], a[56:59], v[0:3]
  ds_read_b128 a[0:3], v178 offset:0
  v_mfma_f32_16x16x32_bf16 v[4:7], a[80:83], a[56:59], v[4:7]
  ds_read_b64_tr_b16 a[20:21], v180 offset:0
  buffer_load_dwordx4 a[208:211], v195, s[20:23], s82 offen offset:2048 sc1
  v_mfma_f32_16x16x32_bf16 v[8:11], a[84:87], a[56:59], v[8:11]
  v_mfma_f32_16x16x32_bf16 v[12:15], a[88:91], a[56:59], v[12:15]
  ds_read_b64_tr_b16 a[22:23], v180 offset:1024
  buffer_load_dwordx4 a[212:215], v195, s[20:23], s82 offen offset:3072 sc1
  v_mfma_f32_16x16x32_bf16 v[16:19], a[92:95], a[56:59], v[16:19]
  ds_read_b64_tr_b16 a[24:25], v181 offset:0
  v_mfma_f32_16x16x32_bf16 v[20:23], a[96:99], a[56:59], v[20:23]
  v_mfma_f32_16x16x32_bf16 v[24:27], a[100:103], a[56:59], v[24:27]
  ds_read_b64_tr_b16 a[26:27], v181 offset:1024
  s_addk_i32 s82, 0x1000
  buffer_load_dwordx4 a[216:219], v195, s[20:23], s82 offen offset:0 sc1
  v_mfma_f32_16x16x32_bf16 v[28:31], a[104:107], a[56:59], v[28:31]
  ds_read_b128 a[4:7], v178 offset:2048
  v_mfma_f32_16x16x32_bf16 v[32:35], a[76:79], a[60:63], v[32:35]
  v_mfma_f32_16x16x32_bf16 v[36:39], a[80:83], a[60:63], v[36:39]
  ds_read_b64_tr_b16 a[28:29], v182 offset:0
  buffer_load_dwordx4 a[220:223], v195, s[20:23], s82 offen offset:1024 sc1
  v_mfma_f32_16x16x32_bf16 v[40:43], a[84:87], a[60:63], v[40:43]
  ds_read_b64_tr_b16 a[30:31], v182 offset:1024
  v_mfma_f32_16x16x32_bf16 v[44:47], a[88:91], a[60:63], v[44:47]
  v_mfma_f32_16x16x32_bf16 v[48:51], a[92:95], a[60:63], v[48:51]
  ds_read_b64_tr_b16 a[32:33], v183 offset:0
  buffer_load_dwordx4 a[224:227], v195, s[20:23], s82 offen offset:2048 sc1
  v_mfma_f32_16x16x32_bf16 v[52:55], a[96:99], a[60:63], v[52:55]
  ds_read_b64_tr_b16 a[34:35], v183 offset:1024
  v_mfma_f32_16x16x32_bf16 v[56:59], a[100:103], a[60:63], v[56:59]
  v_mfma_f32_16x16x32_bf16 v[60:63], a[104:107], a[60:63], v[60:63]
  ds_read_b128 a[8:11], v178 offset:4096
  buffer_load_dwordx4 a[228:231], v195, s[20:23], s82 offen offset:3072 sc1
  v_mfma_f32_16x16x32_bf16 v[64:67], a[76:79], a[64:67], v[64:67]
  ds_read_b128 a[12:15], v178 offset:6144
  v_mfma_f32_16x16x32_bf16 v[68:71], a[80:83], a[64:67], v[68:71]
  v_mfma_f32_16x16x32_bf16 v[72:75], a[84:87], a[64:67], v[72:75]
  ds_read_b128 a[16:19], v178 offset:8192
  s_addk_i32 s82, 0x1000
  buffer_load_dwordx4 a[232:235], v195, s[20:23], s82 offen offset:0 sc1
  v_mfma_f32_16x16x32_bf16 v[76:79], a[88:91], a[64:67], v[76:79]
  ds_read_b64_tr_b16 a[36:37], v180 offset:16384
  v_mfma_f32_16x16x32_bf16 v[80:83], a[92:95], a[64:67], v[80:83]
  buffer_load_dwordx4 a[236:239], v195, s[20:23], s82 offen offset:1024 sc1
  v_mfma_f32_16x16x32_bf16 v[84:87], a[96:99], a[64:67], v[84:87]
  ds_read_b64_tr_b16 a[38:39], v180 offset:17408
  v_mfma_f32_16x16x32_bf16 v[88:91], a[100:103], a[64:67], v[88:91]
  ds_read_b64_tr_b16 a[40:41], v181 offset:16384
  v_mfma_f32_16x16x32_bf16 v[92:95], a[104:107], a[64:67], v[92:95]
  s_addk_i32 s82, 0x800
  buffer_load_dwordx4 a[240:243], v195, s[20:23], s49 offen offset:0 sc1
  v_mfma_f32_16x16x32_bf16 v[96:99], a[76:79], a[68:71], v[96:99]
  ds_read_b64_tr_b16 a[42:43], v181 offset:17408
  v_mfma_f32_16x16x32_bf16 v[100:103], a[80:83], a[68:71], v[100:103]
  ds_read_b64_tr_b16 a[44:45], v182 offset:16384
  v_mfma_f32_16x16x32_bf16 v[104:107], a[84:87], a[68:71], v[104:107]
  buffer_load_dwordx4 a[244:247], v195, s[20:23], s49 offen offset:1024 sc1
  v_mfma_f32_16x16x32_bf16 v[108:111], a[88:91], a[68:71], v[108:111]
  ds_read_b64_tr_b16 a[46:47], v182 offset:17408
  v_mfma_f32_16x16x32_bf16 v[112:115], a[92:95], a[68:71], v[112:115]
  ds_read_b64_tr_b16 a[48:49], v183 offset:16384
  v_mfma_f32_16x16x32_bf16 v[116:119], a[96:99], a[68:71], v[116:119]
  buffer_load_dwordx4 a[248:251], v195, s[20:23], s49 offen offset:2048 sc1
  v_mfma_f32_16x16x32_bf16 v[120:123], a[100:103], a[68:71], v[120:123]
  ds_read_b64_tr_b16 a[50:51], v183 offset:17408
  v_mfma_f32_16x16x32_bf16 v[124:127], a[104:107], a[68:71], v[124:127]
  v_mfma_f32_16x16x32_bf16 v[128:131], a[76:79], a[72:75], v[128:131]
  buffer_load_dwordx4 a[252:255], v195, s[20:23], s49 offen offset:3072 sc1
  v_mfma_f32_16x16x32_bf16 v[132:135], a[80:83], a[72:75], v[132:135]
  v_mfma_f32_16x16x32_bf16 v[136:139], a[84:87], a[72:75], v[136:139]
  v_mfma_f32_16x16x32_bf16 v[140:143], a[88:91], a[72:75], v[140:143]
  s_addk_i32 s49, 0x1000
  buffer_load_dwordx4 a[112:115], v195, s[20:23], s49 offen offset:0 sc1
  v_mfma_f32_16x16x32_bf16 v[144:147], a[92:95], a[72:75], v[144:147]
  v_mfma_f32_16x16x32_bf16 v[148:151], a[96:99], a[72:75], v[148:151]
  v_mfma_f32_16x16x32_bf16 v[152:155], a[100:103], a[72:75], v[152:155]
  v_mfma_f32_16x16x32_bf16 v[156:159], a[104:107], a[72:75], v[156:159]
  s_waitcnt lgkmcnt(0)
  v_mfma_f32_16x16x32_bf16 v[0:3], a[20:23], a[0:3], v[0:3]
  ds_read_b128 a[56:59], v179 offset:0
  ds_read_b64_tr_b16 a[76:77], v180 offset:8192
  s_mov_b32 s70, 3216550459
  s_mov_b32 s71, 3216550459
  v_mfma_f32_16x16x32_bf16 v[4:7], a[24:27], a[0:3], v[4:7]
  ds_read_b64_tr_b16 a[78:79], v180 offset:9216
  ds_read_b64_tr_b16 a[80:81], v181 offset:8192
  s_mov_b32 s72, 1.0
  s_mov_b32 s73, 1.0
  v_mfma_f32_16x16x32_bf16 v[8:11], a[28:31], a[0:3], v[8:11]
  ds_read_b64_tr_b16 a[82:83], v181 offset:9216
  ds_read_b128 a[60:63], v179 offset:2048
  s_mul_i32 s53, s6, 10
  s_mul_i32 s54, s56, 5
  v_mfma_f32_16x16x32_bf16 v[12:15], a[32:35], a[0:3], v[12:15]
  ds_read_b64_tr_b16 a[84:85], v182 offset:8192
  s_add_u32 s53, s53, s54
  s_lshl_b32 s74, s7, 2
  v_mfma_f32_16x16x32_bf16 v[16:19], a[36:39], a[0:3], v[16:19]
  ds_read_b64_tr_b16 a[86:87], v182 offset:9216
  ds_read_b64_tr_b16 a[88:89], v183 offset:8192
  s_lshl_b32 s55, s55, 1
  s_add_u32 s74, s74, s55
  v_mfma_f32_16x16x32_bf16 v[20:23], a[40:43], a[0:3], v[20:23]
  ds_read_b64_tr_b16 a[90:91], v183 offset:9216
  ds_read_b128 a[64:67], v179 offset:4096
  v_mov_b32 v186, 2147418112
  v_mfma_f32_16x16x32_bf16 v[24:27], a[44:47], a[0:3], v[24:27]
  ds_read_b128 a[68:71], v179 offset:6144
  ds_read_b128 a[72:75], v179 offset:8192
  v_mfma_f32_16x16x32_bf16 v[28:31], a[48:51], a[0:3], v[28:31]
  ds_read_b64_tr_b16 a[92:93], v180 offset:24576
  v_mfma_f32_16x16x32_bf16 v[32:35], a[20:23], a[4:7], v[32:35]
  ds_read_b64_tr_b16 a[94:95], v180 offset:25600
  ds_read_b64_tr_b16 a[96:97], v181 offset:24576
  v_mfma_f32_16x16x32_bf16 v[36:39], a[24:27], a[4:7], v[36:39]
  ds_read_b64_tr_b16 a[98:99], v181 offset:25600
  ds_read_b64_tr_b16 a[100:101], v182 offset:24576
  v_mfma_f32_16x16x32_bf16 v[40:43], a[28:31], a[4:7], v[40:43]
  ds_read_b64_tr_b16 a[102:103], v182 offset:25600
  ds_read_b64_tr_b16 a[104:105], v183 offset:24576
  v_mfma_f32_16x16x32_bf16 v[44:47], a[32:35], a[4:7], v[44:47]
  ds_read_b64_tr_b16 a[106:107], v183 offset:25600
  v_mfma_f32_16x16x32_bf16 v[48:51], a[36:39], a[4:7], v[48:51]
  v_mfma_f32_16x16x32_bf16 v[52:55], a[40:43], a[4:7], v[52:55]
  v_mfma_f32_16x16x32_bf16 v[56:59], a[44:47], a[4:7], v[56:59]
  v_mfma_f32_16x16x32_bf16 v[60:63], a[48:51], a[4:7], v[60:63]
  s_waitcnt lgkmcnt(0)
  s_barrier
  v_mfma_f32_16x16x32_bf16 v[0:3], a[76:79], a[56:59], v[0:3]
  s_mul_i32 m0, s42, 30720
  s_nop 0
  buffer_load_dwordx4 v195, s[20:23], s82 offen offset:0 sc1 lds
  v_mfma_f32_16x16x32_bf16 v[4:7], a[80:83], a[56:59], v[4:7]
  v_mfma_f32_16x16x32_bf16 v[8:11], a[84:87], a[56:59], v[8:11]
  v_mfma_f32_16x16x32_bf16 v[12:15], a[88:91], a[56:59], v[12:15]
  v_mfma_f32_16x16x32_bf16 v[16:19], a[92:95], a[56:59], v[16:19]
  v_mfma_f32_16x16x32_bf16 v[20:23], a[96:99], a[56:59], v[20:23]
  v_mfma_f32_16x16x32_bf16 v[24:27], a[100:103], a[56:59], v[24:27]
  buffer_load_dwordx4 v195, s[20:23], s82 offen offset:1024 sc1 lds
  v_mfma_f32_16x16x32_bf16 v[28:31], a[104:107], a[56:59], v[28:31]
  v_mfma_f32_16x16x32_bf16 v[32:35], a[76:79], a[60:63], v[32:35]
  v_mfma_f32_16x16x32_bf16 v[36:39], a[80:83], a[60:63], v[36:39]
  s_lshr_b32 s54, s53, 2
  s_mul_i32 s54, s54, 68
  s_add_u32 s54, s54, s74
  s_lshl_b32 s54, s54, 2
  v_mfma_f32_16x16x32_bf16 v[40:43], a[84:87], a[60:63], v[40:43]
  s_and_b32 s55, s53, 3
  s_add_u32 s54, s54, s55
  s_lshl_b32 s54, s54, 10
  s_add_u32 s55, s54, 4096
  v_mfma_f32_16x16x32_bf16 v[44:47], a[88:91], a[60:63], v[44:47]
  s_sub_u32 s75, s53, 128
  s_ashr_i32 s75, s75, 31
  v_bfi_b32 v185, s75, v195, v186
  v_mfma_f32_16x16x32_bf16 v[48:51], a[92:95], a[60:63], v[48:51]
  buffer_load_dwordx4 v195, s[20:23], s82 offen offset:2048 sc1 lds
  s_add_u32 s53, s53, 1
  v_pk_mul_f32 v[200:201], v[0:1], s[70:71]
  v_mfma_f32_16x16x32_bf16 v[52:55], a[96:99], a[60:63], v[52:55]
  v_pk_mul_f32 v[202:203], v[2:3], s[70:71]
  v_pk_mul_f32 v[204:205], v[4:5], s[70:71]
  v_mfma_f32_16x16x32_bf16 v[56:59], a[100:103], a[60:63], v[56:59]
  v_pk_mul_f32 v[206:207], v[6:7], s[70:71]
  v_mfma_f32_16x16x32_bf16 v[60:63], a[104:107], a[60:63], v[60:63]
  v_exp_f32 v200, v200
  v_mfma_f32_16x16x32_bf16 v[64:67], a[20:23], a[8:11], v[64:67]
  v_exp_f32 v201, v201
  v_mfma_f32_16x16x32_bf16 v[68:71], a[24:27], a[8:11], v[68:71]
  v_exp_f32 v202, v202
  v_mfma_f32_16x16x32_bf16 v[72:75], a[28:31], a[8:11], v[72:75]
  buffer_load_dwordx4 v195, s[20:23], s82 offen offset:3072 sc1 lds
  v_exp_f32 v203, v203
  v_mfma_f32_16x16x32_bf16 v[76:79], a[32:35], a[8:11], v[76:79]
  v_exp_f32 v204, v204
  v_mfma_f32_16x16x32_bf16 v[80:83], a[36:39], a[8:11], v[80:83]
  v_exp_f32 v205, v205
  v_mfma_f32_16x16x32_bf16 v[84:87], a[40:43], a[8:11], v[84:87]
  v_exp_f32 v206, v206
  v_mfma_f32_16x16x32_bf16 v[88:91], a[44:47], a[8:11], v[88:91]
  v_exp_f32 v207, v207
  v_mfma_f32_16x16x32_bf16 v[92:95], a[48:51], a[8:11], v[92:95]
  v_pk_add_f32 v[200:201], v[200:201], s[72:73]
  v_pk_add_f32 v[202:203], v[202:203], s[72:73]
  v_mfma_f32_16x16x32_bf16 v[64:67], a[76:79], a[64:67], v[64:67]
  s_addk_i32 m0, 0x1000
  s_addk_i32 s82, 0x1000
  buffer_load_dwordx4 v195, s[20:23], s82 offen offset:0 sc1 lds
  v_pk_add_f32 v[204:205], v[204:205], s[72:73]
  v_pk_add_f32 v[206:207], v[206:207], s[72:73]
  v_mfma_f32_16x16x32_bf16 v[68:71], a[80:83], a[64:67], v[68:71]
  v_rcp_f32 v200, v200
  v_mfma_f32_16x16x32_bf16 v[72:75], a[84:87], a[64:67], v[72:75]
  v_rcp_f32 v201, v201
  v_mfma_f32_16x16x32_bf16 v[76:79], a[88:91], a[64:67], v[76:79]
  v_rcp_f32 v202, v202
  v_mfma_f32_16x16x32_bf16 v[80:83], a[92:95], a[64:67], v[80:83]
  v_rcp_f32 v203, v203
  v_mfma_f32_16x16x32_bf16 v[84:87], a[96:99], a[64:67], v[84:87]
  v_rcp_f32 v204, v204
  v_mfma_f32_16x16x32_bf16 v[88:91], a[100:103], a[64:67], v[88:91]
  buffer_load_dwordx4 v195, s[20:23], s82 offen offset:1024 sc1 lds
  v_rcp_f32 v205, v205
  v_mfma_f32_16x16x32_bf16 v[92:95], a[104:107], a[64:67], v[92:95]
  v_rcp_f32 v206, v206
  v_mfma_f32_16x16x32_bf16 v[96:99], a[20:23], a[12:15], v[96:99]
  v_rcp_f32 v207, v207
  v_mfma_f32_16x16x32_bf16 v[100:103], a[24:27], a[12:15], v[100:103]
  v_pk_mul_f32 v[200:201], v[200:201], v[16:17]
  v_pk_mul_f32 v[202:203], v[202:203], v[18:19]
  v_mfma_f32_16x16x32_bf16 v[104:107], a[28:31], a[12:15], v[104:107]
  v_pk_mul_f32 v[204:205], v[204:205], v[20:21]
  v_pk_mul_f32 v[206:207], v[206:207], v[22:23]
  v_mfma_f32_16x16x32_bf16 v[108:111], a[32:35], a[12:15], v[108:111]
  v_cvt_pk_bf16_f32 v208, v200, v201
  v_cvt_pk_bf16_f32 v209, v202, v203
  v_mfma_f32_16x16x32_bf16 v[112:115], a[36:39], a[12:15], v[112:115]
  buffer_load_dwordx4 v195, s[20:23], s82 offen offset:2048 sc1 lds
  v_cvt_pk_bf16_f32 v210, v204, v205
  v_cvt_pk_bf16_f32 v211, v206, v207
  v_mfma_f32_16x16x32_bf16 v[116:119], a[40:43], a[12:15], v[116:119]
  buffer_store_dwordx4 v[208:211], v185, s[20:23], s54 offen sc1
  v_pk_mul_f32 v[216:217], v[8:9], s[70:71]
  v_mfma_f32_16x16x32_bf16 v[120:123], a[44:47], a[12:15], v[120:123]
  v_pk_mul_f32 v[218:219], v[10:11], s[70:71]
  v_pk_mul_f32 v[220:221], v[12:13], s[70:71]
  v_mfma_f32_16x16x32_bf16 v[124:127], a[48:51], a[12:15], v[124:127]
  v_pk_mul_f32 v[222:223], v[14:15], s[70:71]
  v_mfma_f32_16x16x32_bf16 v[96:99], a[76:79], a[68:71], v[96:99]
  v_exp_f32 v216, v216
  v_mfma_f32_16x16x32_bf16 v[100:103], a[80:83], a[68:71], v[100:103]
  v_exp_f32 v217, v217
  v_mfma_f32_16x16x32_bf16 v[104:107], a[84:87], a[68:71], v[104:107]
  buffer_load_dwordx4 v195, s[20:23], s82 offen offset:3072 sc1 lds
  v_exp_f32 v218, v218
  v_mfma_f32_16x16x32_bf16 v[108:111], a[88:91], a[68:71], v[108:111]
  v_exp_f32 v219, v219
  v_mfma_f32_16x16x32_bf16 v[112:115], a[92:95], a[68:71], v[112:115]
  v_exp_f32 v220, v220
  v_mfma_f32_16x16x32_bf16 v[116:119], a[96:99], a[68:71], v[116:119]
  v_exp_f32 v221, v221
  v_mfma_f32_16x16x32_bf16 v[120:123], a[100:103], a[68:71], v[120:123]
  v_exp_f32 v222, v222
  v_mfma_f32_16x16x32_bf16 v[124:127], a[104:107], a[68:71], v[124:127]
  v_exp_f32 v223, v223
  v_mfma_f32_16x16x32_bf16 v[128:131], a[20:23], a[16:19], v[128:131]
  s_addk_i32 m0, 0x1000
  s_addk_i32 s82, 0x1000
  buffer_load_dwordx4 v195, s[20:23], s82 offen offset:0 sc1 lds
  v_pk_add_f32 v[216:217], v[216:217], s[72:73]
  v_pk_add_f32 v[218:219], v[218:219], s[72:73]
  v_mfma_f32_16x16x32_bf16 v[132:135], a[24:27], a[16:19], v[132:135]
  v_pk_add_f32 v[220:221], v[220:221], s[72:73]
  v_pk_add_f32 v[222:223], v[222:223], s[72:73]
  v_mfma_f32_16x16x32_bf16 v[136:139], a[28:31], a[16:19], v[136:139]
  v_rcp_f32 v216, v216
  v_mfma_f32_16x16x32_bf16 v[140:143], a[32:35], a[16:19], v[140:143]
  v_rcp_f32 v217, v217
  v_mfma_f32_16x16x32_bf16 v[144:147], a[36:39], a[16:19], v[144:147]
  v_rcp_f32 v218, v218
  v_mfma_f32_16x16x32_bf16 v[148:151], a[40:43], a[16:19], v[148:151]
  v_rcp_f32 v219, v219
  v_mfma_f32_16x16x32_bf16 v[152:155], a[44:47], a[16:19], v[152:155]
  buffer_load_dwordx4 v195, s[20:23], s82 offen offset:1024 sc1 lds
  v_rcp_f32 v220, v220
  v_mfma_f32_16x16x32_bf16 v[156:159], a[48:51], a[16:19], v[156:159]
  v_rcp_f32 v221, v221
  v_mfma_f32_16x16x32_bf16 v[128:131], a[76:79], a[72:75], v[128:131]
  v_rcp_f32 v222, v222
  v_mfma_f32_16x16x32_bf16 v[132:135], a[80:83], a[72:75], v[132:135]
  v_rcp_f32 v223, v223
  v_mfma_f32_16x16x32_bf16 v[136:139], a[84:87], a[72:75], v[136:139]
  v_pk_mul_f32 v[216:217], v[216:217], v[24:25]
  v_pk_mul_f32 v[218:219], v[218:219], v[26:27]
  v_mfma_f32_16x16x32_bf16 v[140:143], a[88:91], a[72:75], v[140:143]
  v_pk_mul_f32 v[220:221], v[220:221], v[28:29]
  v_pk_mul_f32 v[222:223], v[222:223], v[30:31]
  v_mfma_f32_16x16x32_bf16 v[144:147], a[92:95], a[72:75], v[144:147]
  buffer_load_dwordx4 v195, s[20:23], s82 offen offset:2048 sc1 lds
  v_cvt_pk_bf16_f32 v224, v216, v217
  v_cvt_pk_bf16_f32 v225, v218, v219
  v_mfma_f32_16x16x32_bf16 v[148:151], a[96:99], a[72:75], v[148:151]
  v_cvt_pk_bf16_f32 v226, v220, v221
  v_cvt_pk_bf16_f32 v227, v222, v223
  v_mfma_f32_16x16x32_bf16 v[152:155], a[100:103], a[72:75], v[152:155]
  buffer_store_dwordx4 v[224:227], v185, s[20:23], s55 offen sc1
  s_lshr_b32 s54, s53, 2
  s_mul_i32 s54, s54, 68
  v_mfma_f32_16x16x32_bf16 v[156:159], a[104:107], a[72:75], v[156:159]
  s_add_u32 s54, s54, s74
  s_lshl_b32 s54, s54, 2
  s_and_b32 s55, s53, 3
  s_add_u32 s54, s54, s55
  s_lshl_b32 s54, s54, 10
  s_add_u32 s55, s54, 4096
  s_sub_u32 s75, s53, 128
  s_ashr_i32 s75, s75, 31
  v_bfi_b32 v185, s75, v195, v186
  s_add_u32 s53, s53, 1
  v_pk_mul_f32 v[200:201], v[32:33], s[70:71]
  v_pk_mul_f32 v[202:203], v[34:35], s[70:71]
  v_pk_mul_f32 v[204:205], v[36:37], s[70:71]
  v_pk_mul_f32 v[206:207], v[38:39], s[70:71]
  v_exp_f32 v200, v200
  v_exp_f32 v201, v201
  v_exp_f32 v202, v202
  buffer_load_dwordx4 v195, s[20:23], s82 offen offset:3072 sc1 lds
  v_exp_f32 v203, v203
  v_exp_f32 v204, v204
  v_exp_f32 v205, v205
  v_exp_f32 v206, v206
  v_exp_f32 v207, v207
  v_pk_add_f32 v[200:201], v[200:201], s[72:73]
  v_pk_add_f32 v[202:203], v[202:203], s[72:73]
  v_pk_add_f32 v[204:205], v[204:205], s[72:73]
  v_pk_add_f32 v[206:207], v[206:207], s[72:73]
  v_rcp_f32 v200, v200
  v_rcp_f32 v201, v201
  v_rcp_f32 v202, v202
  v_rcp_f32 v203, v203
  v_rcp_f32 v204, v204
  s_addk_i32 m0, 0x1000
  s_addk_i32 s82, 0x1000
  buffer_load_dwordx4 v195, s[20:23], s82 offen offset:0 sc1 lds
  v_rcp_f32 v205, v205
  v_rcp_f32 v206, v206
  v_rcp_f32 v207, v207
  v_pk_mul_f32 v[200:201], v[200:201], v[48:49]
  v_pk_mul_f32 v[202:203], v[202:203], v[50:51]
  v_pk_mul_f32 v[204:205], v[204:205], v[52:53]
  v_pk_mul_f32 v[206:207], v[206:207], v[54:55]
  v_cvt_pk_bf16_f32 v208, v200, v201
  v_cvt_pk_bf16_f32 v209, v202, v203
  v_cvt_pk_bf16_f32 v210, v204, v205
  v_cvt_pk_bf16_f32 v211, v206, v207
  buffer_store_dwordx4 v[208:211], v185, s[20:23], s54 offen sc1
  v_pk_mul_f32 v[216:217], v[40:41], s[70:71]
  v_pk_mul_f32 v[218:219], v[42:43], s[70:71]
  v_pk_mul_f32 v[220:221], v[44:45], s[70:71]
  v_pk_mul_f32 v[222:223], v[46:47], s[70:71]
  v_exp_f32 v216, v216
  v_exp_f32 v217, v217
  v_exp_f32 v218, v218
  buffer_load_dwordx4 v195, s[20:23], s82 offen offset:1024 sc1 lds
  v_exp_f32 v219, v219
  v_exp_f32 v220, v220
  v_exp_f32 v221, v221
  v_exp_f32 v222, v222
  v_exp_f32 v223, v223
  v_pk_add_f32 v[216:217], v[216:217], s[72:73]
  v_pk_add_f32 v[218:219], v[218:219], s[72:73]
  v_pk_add_f32 v[220:221], v[220:221], s[72:73]
  v_pk_add_f32 v[222:223], v[222:223], s[72:73]
  v_rcp_f32 v216, v216
  v_rcp_f32 v217, v217
  v_rcp_f32 v218, v218
  v_rcp_f32 v219, v219
  v_rcp_f32 v220, v220
  buffer_load_dwordx4 v195, s[20:23], s82 offen offset:2048 sc1 lds
  v_rcp_f32 v221, v221
  v_rcp_f32 v222, v222
  v_rcp_f32 v223, v223
  v_pk_mul_f32 v[216:217], v[216:217], v[56:57]
  v_pk_mul_f32 v[218:219], v[218:219], v[58:59]
  v_pk_mul_f32 v[220:221], v[220:221], v[60:61]
  v_pk_mul_f32 v[222:223], v[222:223], v[62:63]
  v_cvt_pk_bf16_f32 v224, v216, v217
  v_cvt_pk_bf16_f32 v225, v218, v219
  v_cvt_pk_bf16_f32 v226, v220, v221
  v_cvt_pk_bf16_f32 v227, v222, v223
  buffer_store_dwordx4 v[224:227], v185, s[20:23], s55 offen sc1
  s_lshr_b32 s54, s53, 2
  s_mul_i32 s54, s54, 68
  s_add_u32 s54, s54, s74
  s_lshl_b32 s54, s54, 2
  s_and_b32 s55, s53, 3
  s_add_u32 s54, s54, s55
  s_lshl_b32 s54, s54, 10
  s_add_u32 s55, s54, 4096
  s_sub_u32 s75, s53, 128
  s_ashr_i32 s75, s75, 31
  v_bfi_b32 v185, s75, v195, v186
  s_add_u32 s53, s53, 1
  v_pk_mul_f32 v[200:201], v[64:65], s[70:71]
  v_pk_mul_f32 v[202:203], v[66:67], s[70:71]
  v_pk_mul_f32 v[204:205], v[68:69], s[70:71]
  buffer_load_dwordx4 v195, s[20:23], s82 offen offset:3072 sc1 lds
  v_pk_mul_f32 v[206:207], v[70:71], s[70:71]
  v_exp_f32 v200, v200
  v_exp_f32 v201, v201
  v_exp_f32 v202, v202
  v_exp_f32 v203, v203
  v_exp_f32 v204, v204
  v_exp_f32 v205, v205
  v_exp_f32 v206, v206
  v_exp_f32 v207, v207
  v_pk_add_f32 v[200:201], v[200:201], s[72:73]
  v_pk_add_f32 v[202:203], v[202:203], s[72:73]
  v_pk_add_f32 v[204:205], v[204:205], s[72:73]
  v_pk_add_f32 v[206:207], v[206:207], s[72:73]
  v_rcp_f32 v200, v200
  v_rcp_f32 v201, v201
  s_addk_i32 m0, 0x1000
  s_addk_i32 s82, 0x1000
  buffer_load_dwordx4 v195, s[20:23], s82 offen offset:0 sc1 lds
  v_rcp_f32 v202, v202
  v_rcp_f32 v203, v203
  v_rcp_f32 v204, v204
  v_rcp_f32 v205, v205
  v_rcp_f32 v206, v206
  v_rcp_f32 v207, v207
  v_pk_mul_f32 v[200:201], v[200:201], v[80:81]
  v_pk_mul_f32 v[202:203], v[202:203], v[82:83]
  v_pk_mul_f32 v[204:205], v[204:205], v[84:85]
  v_pk_mul_f32 v[206:207], v[206:207], v[86:87]
  v_cvt_pk_bf16_f32 v208, v200, v201
  v_cvt_pk_bf16_f32 v209, v202, v203
  v_cvt_pk_bf16_f32 v210, v204, v205
  v_cvt_pk_bf16_f32 v211, v206, v207
  buffer_store_dwordx4 v[208:211], v185, s[20:23], s54 offen sc1
  v_pk_mul_f32 v[216:217], v[72:73], s[70:71]
  v_pk_mul_f32 v[218:219], v[74:75], s[70:71]
  v_pk_mul_f32 v[220:221], v[76:77], s[70:71]
  buffer_load_dwordx4 v195, s[20:23], s82 offen offset:1024 sc1 lds
  v_pk_mul_f32 v[222:223], v[78:79], s[70:71]
  v_exp_f32 v216, v216
  v_exp_f32 v217, v217
  v_exp_f32 v218, v218
  v_exp_f32 v219, v219
  v_exp_f32 v220, v220
  v_exp_f32 v221, v221
  v_exp_f32 v222, v222
  v_exp_f32 v223, v223
  v_pk_add_f32 v[216:217], v[216:217], s[72:73]
  v_pk_add_f32 v[218:219], v[218:219], s[72:73]
  v_pk_add_f32 v[220:221], v[220:221], s[72:73]
  v_pk_add_f32 v[222:223], v[222:223], s[72:73]
  v_rcp_f32 v216, v216
  v_rcp_f32 v217, v217
  buffer_load_dwordx4 v195, s[20:23], s82 offen offset:2048 sc1 lds
  v_rcp_f32 v218, v218
  v_rcp_f32 v219, v219
  v_rcp_f32 v220, v220
  v_rcp_f32 v221, v221
  v_rcp_f32 v222, v222
  v_rcp_f32 v223, v223
  v_pk_mul_f32 v[216:217], v[216:217], v[88:89]
  v_pk_mul_f32 v[218:219], v[218:219], v[90:91]
  v_pk_mul_f32 v[220:221], v[220:221], v[92:93]
  v_pk_mul_f32 v[222:223], v[222:223], v[94:95]
  v_cvt_pk_bf16_f32 v224, v216, v217
  v_cvt_pk_bf16_f32 v225, v218, v219
  v_cvt_pk_bf16_f32 v226, v220, v221
  v_cvt_pk_bf16_f32 v227, v222, v223
  buffer_store_dwordx4 v[224:227], v185, s[20:23], s55 offen sc1
  s_lshr_b32 s54, s53, 2
  s_mul_i32 s54, s54, 68
  s_add_u32 s54, s54, s74
  s_lshl_b32 s54, s54, 2
  s_and_b32 s55, s53, 3
  s_add_u32 s54, s54, s55
  buffer_load_dwordx4 v195, s[20:23], s82 offen offset:3072 sc1 lds
  s_lshl_b32 s54, s54, 10
  s_add_u32 s55, s54, 4096
  s_sub_u32 s75, s53, 128
  s_ashr_i32 s75, s75, 31
  v_bfi_b32 v185, s75, v195, v186
  s_add_u32 s53, s53, 1
  v_pk_mul_f32 v[200:201], v[96:97], s[70:71]
  v_pk_mul_f32 v[202:203], v[98:99], s[70:71]
  v_pk_mul_f32 v[204:205], v[100:101], s[70:71]
  v_pk_mul_f32 v[206:207], v[102:103], s[70:71]
  v_exp_f32 v200, v200
  v_exp_f32 v201, v201
  v_exp_f32 v202, v202
  v_exp_f32 v203, v203
  v_exp_f32 v204, v204
  v_exp_f32 v205, v205
  v_exp_f32 v206, v206
  v_exp_f32 v207, v207
  v_pk_add_f32 v[200:201], v[200:201], s[72:73]
  s_addk_i32 m0, 0x1000
  s_addk_i32 s82, 0x1000
  buffer_load_dwordx4 v195, s[20:23], s82 offen offset:0 sc1 lds
  v_pk_add_f32 v[202:203], v[202:203], s[72:73]
  v_pk_add_f32 v[204:205], v[204:205], s[72:73]
  v_pk_add_f32 v[206:207], v[206:207], s[72:73]
  v_rcp_f32 v200, v200
  v_rcp_f32 v201, v201
  v_rcp_f32 v202, v202
  v_rcp_f32 v203, v203
  v_rcp_f32 v204, v204
  v_rcp_f32 v205, v205
  v_rcp_f32 v206, v206
  v_rcp_f32 v207, v207
  v_pk_mul_f32 v[200:201], v[200:201], v[112:113]
  v_pk_mul_f32 v[202:203], v[202:203], v[114:115]
  v_pk_mul_f32 v[204:205], v[204:205], v[116:117]
  v_pk_mul_f32 v[206:207], v[206:207], v[118:119]
  v_cvt_pk_bf16_f32 v208, v200, v201
  buffer_load_dwordx4 v195, s[20:23], s82 offen offset:1024 sc1 lds
  v_cvt_pk_bf16_f32 v209, v202, v203
  v_cvt_pk_bf16_f32 v210, v204, v205
  v_cvt_pk_bf16_f32 v211, v206, v207
  buffer_store_dwordx4 v[208:211], v185, s[20:23], s54 offen sc1
  v_pk_mul_f32 v[216:217], v[104:105], s[70:71]
  v_pk_mul_f32 v[218:219], v[106:107], s[70:71]
  v_pk_mul_f32 v[220:221], v[108:109], s[70:71]
  v_pk_mul_f32 v[222:223], v[110:111], s[70:71]
  v_exp_f32 v216, v216
  v_exp_f32 v217, v217
  v_exp_f32 v218, v218
  v_exp_f32 v219, v219
  v_exp_f32 v220, v220
  v_exp_f32 v221, v221
  v_exp_f32 v222, v222
  v_exp_f32 v223, v223
  buffer_load_dwordx4 v195, s[20:23], s82 offen offset:2048 sc1 lds
  v_pk_add_f32 v[216:217], v[216:217], s[72:73]
  v_pk_add_f32 v[218:219], v[218:219], s[72:73]
  v_pk_add_f32 v[220:221], v[220:221], s[72:73]
  v_pk_add_f32 v[222:223], v[222:223], s[72:73]
  v_rcp_f32 v216, v216
  v_rcp_f32 v217, v217
  v_rcp_f32 v218, v218
  v_rcp_f32 v219, v219
  v_rcp_f32 v220, v220
  v_rcp_f32 v221, v221
  v_rcp_f32 v222, v222
  v_rcp_f32 v223, v223
  v_pk_mul_f32 v[216:217], v[216:217], v[120:121]
  v_pk_mul_f32 v[218:219], v[218:219], v[122:123]
  v_pk_mul_f32 v[220:221], v[220:221], v[124:125]
  v_pk_mul_f32 v[222:223], v[222:223], v[126:127]
  buffer_load_dwordx4 v195, s[20:23], s82 offen offset:3072 sc1 lds
  v_cvt_pk_bf16_f32 v224, v216, v217
  v_cvt_pk_bf16_f32 v225, v218, v219
  v_cvt_pk_bf16_f32 v226, v220, v221
  v_cvt_pk_bf16_f32 v227, v222, v223
  buffer_store_dwordx4 v[224:227], v185, s[20:23], s55 offen sc1
  s_lshr_b32 s54, s53, 2
  s_mul_i32 s54, s54, 68
  s_add_u32 s54, s54, s74
  s_lshl_b32 s54, s54, 2
  s_and_b32 s55, s53, 3
  s_add_u32 s54, s54, s55
  s_lshl_b32 s54, s54, 10
  s_add_u32 s55, s54, 4096
  s_sub_u32 s75, s53, 128
  s_ashr_i32 s75, s75, 31
  v_bfi_b32 v185, s75, v195, v186
  s_add_u32 s53, s53, 1
  v_pk_mul_f32 v[200:201], v[128:129], s[70:71]
  v_pk_mul_f32 v[202:203], v[130:131], s[70:71]
  v_pk_mul_f32 v[204:205], v[132:133], s[70:71]
  v_pk_mul_f32 v[206:207], v[134:135], s[70:71]
  v_exp_f32 v200, v200
  v_exp_f32 v201, v201
  v_exp_f32 v202, v202
  v_exp_f32 v203, v203
  v_exp_f32 v204, v204
  v_exp_f32 v205, v205
  v_exp_f32 v206, v206
  v_exp_f32 v207, v207
  v_pk_add_f32 v[200:201], v[200:201], s[72:73]
  v_pk_add_f32 v[202:203], v[202:203], s[72:73]
  v_pk_add_f32 v[204:205], v[204:205], s[72:73]
  v_pk_add_f32 v[206:207], v[206:207], s[72:73]
  v_rcp_f32 v200, v200
  v_rcp_f32 v201, v201
  v_rcp_f32 v202, v202
  v_rcp_f32 v203, v203
  v_rcp_f32 v204, v204
  v_rcp_f32 v205, v205
  v_rcp_f32 v206, v206
  v_rcp_f32 v207, v207
  v_pk_mul_f32 v[200:201], v[200:201], v[144:145]
  v_pk_mul_f32 v[202:203], v[202:203], v[146:147]
  v_pk_mul_f32 v[204:205], v[204:205], v[148:149]
  v_pk_mul_f32 v[206:207], v[206:207], v[150:151]
  v_cvt_pk_bf16_f32 v208, v200, v201
  v_cvt_pk_bf16_f32 v209, v202, v203
  v_cvt_pk_bf16_f32 v210, v204, v205
  v_cvt_pk_bf16_f32 v211, v206, v207
  buffer_store_dwordx4 v[208:211], v185, s[20:23], s54 offen sc1
  v_pk_mul_f32 v[216:217], v[136:137], s[70:71]
  v_pk_mul_f32 v[218:219], v[138:139], s[70:71]
  v_pk_mul_f32 v[220:221], v[140:141], s[70:71]
  v_pk_mul_f32 v[222:223], v[142:143], s[70:71]
  v_exp_f32 v216, v216
  v_exp_f32 v217, v217
  v_exp_f32 v218, v218
  v_exp_f32 v219, v219
  v_exp_f32 v220, v220
  v_exp_f32 v221, v221
  v_exp_f32 v222, v222
  v_exp_f32 v223, v223
  v_pk_add_f32 v[216:217], v[216:217], s[72:73]
  v_pk_add_f32 v[218:219], v[218:219], s[72:73]
  v_pk_add_f32 v[220:221], v[220:221], s[72:73]
  v_pk_add_f32 v[222:223], v[222:223], s[72:73]
  v_rcp_f32 v216, v216
  v_rcp_f32 v217, v217
  v_rcp_f32 v218, v218
  v_rcp_f32 v219, v219
  v_rcp_f32 v220, v220
  v_rcp_f32 v221, v221
  v_rcp_f32 v222, v222
  v_rcp_f32 v223, v223
  v_pk_mul_f32 v[216:217], v[216:217], v[152:153]
  v_pk_mul_f32 v[218:219], v[218:219], v[154:155]
  v_pk_mul_f32 v[220:221], v[220:221], v[156:157]
  v_pk_mul_f32 v[222:223], v[222:223], v[158:159]
  v_cvt_pk_bf16_f32 v224, v216, v217
  v_cvt_pk_bf16_f32 v225, v218, v219
  v_cvt_pk_bf16_f32 v226, v220, v221
  v_cvt_pk_bf16_f32 v227, v222, v223
  buffer_store_dwordx4 v[224:227], v185, s[20:23], s55 offen sc1
  s_addk_i32 m0, 0x1000
  s_addk_i32 s82, 0x1000
  s_nop 0
  buffer_load_dwordx4 v195, s[20:23], s82 offen offset:0 sc1 lds
  buffer_load_dwordx4 v195, s[20:23], s82 offen offset:1024 sc1 lds
  buffer_load_dwordx4 v195, s[20:23], s82 offen offset:2048 sc1 lds
  buffer_load_dwordx4 v195, s[20:23], s82 offen offset:3072 sc1 lds
  s_addk_i32 m0, 0x1000
  s_addk_i32 s82, 0x1000
  s_nop 0
  buffer_load_dwordx4 v195, s[20:23], s82 offen offset:0 sc1 lds
  buffer_load_dwordx4 v195, s[20:23], s82 offen offset:1024 sc1 lds
  s_branch L_p2
L_sideonly:
  s_add_u32 s48, s3, 156
  s_waitcnt lgkmcnt(0)
  s_mov_b32 s20, s40
  s_mov_b32 s21, s41
  s_mov_b32 s22, 19398656
  s_mov_b32 s23, 0x00020000
  s_mov_b32 s53, 14688256
  s_load_dword s100, s[40:41], s53
  s_mov_b32 s86, 819200
  s_cmp_lt_u32 s48, 96
  s_cselect_b32 s84, s36, s28
  s_cselect_b32 s85, s37, s29
  s_cselect_b32 s86, 1966080, s86
  s_mov_b32 s87, 0x00020000
  s_cselect_b32 s91, 0, 96
  s_cselect_b32 s92, 32, 20
  s_cselect_b64 s[94:95], -1, 0
  s_sub_u32 s91, s48, s91
  s_and_b32 s93, s91, 1
  s_lshr_b32 s91, s91, 1
  s_lshl_b32 s93, s93, 2
  s_add_u32 s93, s93, s42
  s_mov_b32 s88, s91
  s_mul_i32 s88, s88, s92
  s_mul_i32 s88, s88, 1280
  s_mul_i32 s53, s93, 160
  s_add_u32 s88, s88, s53
  s_mul_i32 s53, s93, 48
  s_add_u32 s53, s53, s91
  s_mul_i32 s53, s53, 5120
  s_add_u32 s53, s53, 9437184
  s_lshl_b32 s54, s91, 3
  s_add_u32 s54, s54, s93
  s_mul_i32 s54, s54, 5120
  s_add_u32 s54, s54, 12386304
  s_cmp_lt_u32 s48, 96
  s_cselect_b32 s89, s53, s54
  s_add_u32 s90, s89, 4096
  s_movk_i32 s54, 1280
  v_mov_b32 v207, 2147418112
  v_add_u32 v200, 0, v164
  v_mul_u32_u24 v201, 6554, v200
  v_lshrrev_b32 v201, 16, v201
  v_mul_u32_u24 v202, 10, v201
  v_sub_u32 v202, v200, v202
  v_bfe_u32 v203, v201, 2, 1
  v_lshlrev_b32 v203, 4, v203
  v_lshrrev_b32 v204, 3, v201
  v_lshl_add_u32 v203, v204, 2, v203
  v_and_b32 v204, 3, v201
  v_add_u32 v203, v203, v204
  v_cndmask_b32 v203, v201, v203, s[94:95]
  v_cmp_gt_u32 vcc, s92, v203
  v_mul_lo_u32 v203, v203, s54
  v_lshl_add_u32 v203, v202, 4, v203
  v_cndmask_b32 v185, v207, v203, vcc
  v_add_u32 v200, 64, v164
  v_mul_u32_u24 v201, 6554, v200
  v_lshrrev_b32 v201, 16, v201
  v_mul_u32_u24 v202, 10, v201
  v_sub_u32 v202, v200, v202
  v_bfe_u32 v203, v201, 2, 1
  v_lshlrev_b32 v203, 4, v203
  v_lshrrev_b32 v204, 3, v201
  v_lshl_add_u32 v203, v204, 2, v203
  v_and_b32 v204, 3, v201
  v_add_u32 v203, v203, v204
  v_cndmask_b32 v203, v201, v203, s[94:95]
  v_cmp_gt_u32 vcc, s92, v203
  v_mul_lo_u32 v203, v203, s54
  v_lshl_add_u32 v203, v202, 4, v203
  v_cndmask_b32 v186, v207, v203, vcc
  v_add_u32 v200, 128, v164
  v_mul_u32_u24 v201, 6554, v200
  v_lshrrev_b32 v201, 16, v201
  v_mul_u32_u24 v202, 10, v201
  v_sub_u32 v202, v200, v202
  v_bfe_u32 v203, v201, 2, 1
  v_lshlrev_b32 v203, 4, v203
  v_lshrrev_b32 v204, 3, v201
  v_lshl_add_u32 v203, v204, 2, v203
  v_and_b32 v204, 3, v201
  v_add_u32 v203, v203, v204
  v_cndmask_b32 v203, v201, v203, s[94:95]
  v_cmp_gt_u32 vcc, s92, v203
  v_mul_lo_u32 v203, v203, s54
  v_lshl_add_u32 v203, v202, 4, v203
  v_cndmask_b32 v187, v207, v203, vcc
  v_add_u32 v200, 192, v164
  v_mul_u32_u24 v201, 6554, v200
  v_lshrrev_b32 v201, 16, v201
  v_mul_u32_u24 v202, 10, v201
  v_sub_u32 v202, v200, v202
  v_bfe_u32 v203, v201, 2, 1
  v_lshlrev_b32 v203, 4, v203
  v_lshrrev_b32 v204, 3, v201
  v_lshl_add_u32 v203, v204, 2, v203
  v_and_b32 v204, 3, v201
  v_add_u32 v203, v203, v204
  v_cndmask_b32 v203, v201, v203, s[94:95]
  v_cmp_gt_u32 vcc, s92, v203
  v_mul_lo_u32 v203, v203, s54
  v_lshl_add_u32 v203, v202, 4, v203
  v_cndmask_b32 v188, v207, v203, vcc
  v_add_u32 v200, 256, v164
  v_mul_u32_u24 v201, 6554, v200
  v_lshrrev_b32 v201, 16, v201
  v_mul_u32_u24 v202, 10, v201
  v_sub_u32 v202, v200, v202
  v_bfe_u32 v203, v201, 2, 1
  v_lshlrev_b32 v203, 4, v203
  v_lshrrev_b32 v204, 3, v201
  v_lshl_add_u32 v203, v204, 2, v203
  v_and_b32 v204, 3, v201
  v_add_u32 v203, v203, v204
  v_cndmask_b32 v203, v201, v203, s[94:95]
  v_cmp_gt_u32 vcc, s92, v203
  v_mul_lo_u32 v203, v203, s54
  v_lshl_add_u32 v203, v202, 4, v203
  v_cndmask_b32 v189, v207, v203, vcc
  v_lshrrev_b32 v208, 4, v164
  v_bfe_u32 v209, v164, 2, 2
  v_and_b32 v210, 3, v164
  v_lshl_add_u32 v211, v208, 3, v209
  s_mul_i32 s53, s42, 5120
  s_add_u32 s53, s53, 106496
  v_mul_u32_u24 v200, 160, v211
  v_add_u32 v200, s53, v200
  v_lshl_add_u32 v190, v210, 4, v200
  v_lshl_add_u32 v191, v210, 3, v200
  v_add_u32 v192, s53, v195
  buffer_load_dwordx4 a[140:143], v185, s[84:87], s88 offen
  buffer_load_dwordx4 a[144:147], v186, s[84:87], s88 offen
  buffer_load_dwordx4 a[148:151], v187, s[84:87], s88 offen
  buffer_load_dwordx4 a[152:155], v188, s[84:87], s88 offen
  buffer_load_dwordx4 a[156:159], v189, s[84:87], s88 offen
  s_bfe_u32 s53, s2, 0x20001
  s_lshr_b32 s54, s2, 5
  s_lshl_b32 s53, s53, 3
  s_add_u32 s80, s53, s54
  s_and_b32 s53, s2, 1
  s_lshl_b32 s53, s53, 2
  s_bfe_u32 s54, s2, 0x20003
  s_add_u32 s81, s53, s54
  s_mul_i32 s53, s81, 48
  s_mul_i32 s54, s42, 12
  s_add_u32 s53, s53, s54
  s_mul_i32 s53, s53, 5120
  s_add_u32 s82, s53, 9437184
  s_and_b32 s53, s48, 127
  s_lshl_b32 s53, s53, 1
  s_lshr_b32 s54, s42, 1
  s_add_u32 s53, s53, s54
  s_mul_i32 s53, s53, 5120
  s_add_u32 s49, s53, 12386304
  s_add_u32 s53, s48, 96
  s_lshl_b32 s53, s53, 8
  s_add_u32 s83, s53, 14712832
  s_waitcnt vmcnt(0)
  ds_write_b128 v192, a[140:143] offset:0
  ds_write_b128 v192, a[144:147] offset:1024
  ds_write_b128 v192, a[148:151] offset:2048
  ds_write_b128 v192, a[152:155] offset:3072
  ds_write_b128 v192, a[156:159] offset:4096
  ds_read_b64_tr_b16 a[120:121], v190 offset:0
  ds_read_b64_tr_b16 a[122:123], v190 offset:640
  ds_read_b64_tr_b16 a[124:125], v190 offset:8
  ds_read_b64_tr_b16 a[126:127], v190 offset:648
  ds_read_b64_tr_b16 a[128:129], v190 offset:64
  ds_read_b64_tr_b16 a[130:131], v190 offset:704
  ds_read_b64_tr_b16 a[132:133], v190 offset:72
  ds_read_b64_tr_b16 a[134:135], v190 offset:712
  ds_read_b64_tr_b16 a[136:137], v191 offset:128
  ds_read_b64_tr_b16 a[138:139], v191 offset:768
  s_waitcnt lgkmcnt(0)
  buffer_store_dwordx4 a[120:123], v195, s[20:23], s89 offen offset:0 sc1
  buffer_store_dwordx4 a[124:127], v195, s[20:23], s89 offen offset:1024 sc1
  buffer_store_dwordx4 a[128:131], v195, s[20:23], s89 offen offset:2048 sc1
  buffer_store_dwordx4 a[132:135], v195, s[20:23], s89 offen offset:3072 sc1
  buffer_store_dwordx4 a[136:139], v195, s[20:23], s90 offen sc1
  v_mov_b64 v[0:1], 0
  v_mov_b64 v[2:3], 0
  s_lshl_b32 s53, s42, 10
  s_add_u32 s53, s53, 14692352
  buffer_store_dwordx4 v[0:3], v195, s[20:23], s53 offen sc1
  s_mul_i32 s100, s100, 0x9E3779B1
  s_add_u32 s100, s100, 0x7F4A7C15
  v_mov_b32 v196, s100
  s_and_b32 s93, s2, 31
  s_lshl_b32 s93, s93, 8
  s_lshr_b32 s53, s2, 5
  s_lshl_b32 s53, s53, 2
  s_add_u32 s93, s93, s53
  s_add_u32 s93, s93, 14696448
  v_lshrrev_b32 v198, 1, v164
  v_lshlrev_b32 v198, 8, v198
  v_and_b32 v243, 16, v195
  s_mov_b32 s53, 14696448
  v_add3_u32 v198, v198, v243, s53
  s_waitcnt vmcnt(0)
  s_barrier
  s_cmp_lg_u32 s42, 0
  s_cbranch_scc1 L_so_nosig
  s_mov_b64 exec, 1
  buffer_store_dword v196, off, s[20:23], s93 sc1
  s_mov_b64 exec, -1
  v_lshlrev_b32 v240, 7, v164
  s_mul_i32 s53, s2, 3200
  s_add_u32 s53, s53, 11403264
  s_mov_b64 exec, 0x1ffffff
  buffer_load_dword v241, v240, s[20:23], s53 offen sc1
  s_mul_i32 s53, s2, 640
  s_add_u32 s53, s53, 14680064
  s_mov_b64 exec, 0x1f
  buffer_load_dword v241, v240, s[20:23], s53 offen sc1
  s_mov_b64 exec, -1
  buffer_load_dwordx4 v[244:247], v198, s[20:23], 0 offen sc1
  s_waitcnt vmcnt(0)
  s_mov_b32 s57, 0
L_sofw_poll:
  v_cmp_eq_u32 vcc, s100, v244
  v_cmp_eq_u32 s[76:77], s100, v245
  s_nop 0
  s_and_b64 vcc, vcc, s[76:77]
  v_cmp_eq_u32 s[76:77], s100, v246
  s_nop 0
  s_and_b64 vcc, vcc, s[76:77]
  v_cmp_eq_u32 s[76:77], s100, v247
  s_nop 0
  s_and_b64 vcc, vcc, s[76:77]
  s_cmp_eq_u64 vcc, -1
  s_cbranch_scc1 L_sofw_ok
  s_add_u32 s57, s57, 1
  s_cmp_gt_u32 s57, 131072
  s_cbranch_scc1 L_sofw_ok
  s_sleep 32
  buffer_load_dwordx4 v[244:247], v198, s[20:23], 0 offen sc1
  s_waitcnt vmcnt(0)
  s_branch L_sofw_poll
L_sofw_ok:
L_so_nosig:
  s_barrier
  buffer_load_dwordx4 a[120:123], v195, s[20:23], s82 offen offset:0 sc1
  buffer_load_dwordx4 a[124:127], v195, s[20:23], s82 offen offset:1024 sc1
  buffer_load_dwordx4 a[128:131], v195, s[20:23], s82 offen offset:2048 sc1
  buffer_load_dwordx4 a[132:135], v195, s[20:23], s82 offen offset:3072 sc1
  s_addk_i32 s82, 0x1000
  buffer_load_dwordx4 a[136:139], v195, s[20:23], s82 offen offset:0 sc1
  buffer_load_dwordx4 a[140:143], v195, s[20:23], s82 offen offset:1024 sc1
  buffer_load_dwordx4 a[144:147], v195, s[20:23], s82 offen offset:2048 sc1
  buffer_load_dwordx4 a[148:151], v195, s[20:23], s82 offen offset:3072 sc1
  s_addk_i32 s82, 0x1000
  buffer_load_dwordx4 a[152:155], v195, s[20:23], s82 offen offset:0 sc1
  buffer_load_dwordx4 a[156:159], v195, s[20:23], s82 offen offset:1024 sc1
  buffer_load_dwordx4 a[160:163], v195, s[20:23], s82 offen offset:2048 sc1
  buffer_load_dwordx4 a[164:167], v195, s[20:23], s82 offen offset:3072 sc1
  s_addk_i32 s82, 0x1000
  buffer_load_dwordx4 a[168:171], v195, s[20:23], s82 offen offset:0 sc1
  buffer_load_dwordx4 a[172:175], v195, s[20:23], s82 offen offset:1024 sc1
  buffer_load_dwordx4 a[176:179], v195, s[20:23], s82 offen offset:2048 sc1
  buffer_load_dwordx4 a[180:183], v195, s[20:23], s82 offen offset:3072 sc1
  s_addk_i32 s82, 0x1000
  buffer_load_dwordx4 a[184:187], v195, s[20:23], s82 offen offset:0 sc1
  buffer_load_dwordx4 a[188:191], v195, s[20:23], s82 offen offset:1024 sc1
  buffer_load_dwordx4 a[192:195], v195, s[20:23], s82 offen offset:2048 sc1
  buffer_load_dwordx4 a[196:199], v195, s[20:23], s82 offen offset:3072 sc1
  s_addk_i32 s82, 0x1000
  buffer_load_dwordx4 a[200:203], v195, s[20:23], s82 offen offset:0 sc1
  buffer_load_dwordx4 a[204:207], v195, s[20:23], s82 offen offset:1024 sc1
  buffer_load_dwordx4 a[208:211], v195, s[20:23], s82 offen offset:2048 sc1
  buffer_load_dwordx4 a[212:215], v195, s[20:23], s82 offen offset:3072 sc1
  s_addk_i32 s82, 0x1000
  buffer_load_dwordx4 a[216:219], v195, s[20:23], s82 offen offset:0 sc1
  buffer_load_dwordx4 a[220:223], v195, s[20:23], s82 offen offset:1024 sc1
  buffer_load_dwordx4 a[224:227], v195, s[20:23], s82 offen offset:2048 sc1
  buffer_load_dwordx4 a[228:231], v195, s[20:23], s82 offen offset:3072 sc1
  s_addk_i32 s82, 0x1000
  buffer_load_dwordx4 a[232:235], v195, s[20:23], s82 offen offset:0 sc1
  buffer_load_dwordx4 a[236:239], v195, s[20:23], s82 offen offset:1024 sc1
  s_addk_i32 s82, 0x800
  s_waitcnt vmcnt(16)
  s_mul_i32 m0, s42, 30720
  s_nop 0
  buffer_load_dwordx4 v195, s[20:23], s82 offen offset:0 sc1 lds
  buffer_load_dwordx4 v195, s[20:23], s82 offen offset:1024 sc1 lds
  buffer_load_dwordx4 v195, s[20:23], s82 offen offset:2048 sc1 lds
  buffer_load_dwordx4 v195, s[20:23], s82 offen offset:3072 sc1 lds
  s_addk_i32 m0, 0x1000
  s_addk_i32 s82, 0x1000
  s_nop 0
  buffer_load_dwordx4 v195, s[20:23], s82 offen offset:0 sc1 lds
  buffer_load_dwordx4 v195, s[20:23], s82 offen offset:1024 sc1 lds
  buffer_load_dwordx4 v195, s[20:23], s82 offen offset:2048 sc1 lds
  buffer_load_dwordx4 v195, s[20:23], s82 offen offset:3072 sc1 lds
  s_addk_i32 m0, 0x1000
  s_addk_i32 s82, 0x1000
  s_nop 0
  buffer_load_dwordx4 v195, s[20:23], s82 offen offset:0 sc1 lds
  buffer_load_dwordx4 v195, s[20:23], s82 offen offset:1024 sc1 lds
  buffer_load_dwordx4 v195, s[20:23], s82 offen offset:2048 sc1 lds
  buffer_load_dwordx4 v195, s[20:23], s82 offen offset:3072 sc1 lds
  s_addk_i32 m0, 0x1000
  s_addk_i32 s82, 0x1000
  s_nop 0
  buffer_load_dwordx4 v195, s[20:23], s82 offen offset:0 sc1 lds
  buffer_load_dwordx4 v195, s[20:23], s82 offen offset:1024 sc1 lds
  buffer_load_dwordx4 v195, s[20:23], s82 offen offset:2048 sc1 lds
  buffer_load_dwordx4 v195, s[20:23], s82 offen offset:3072 sc1 lds
  s_addk_i32 m0, 0x1000
  s_addk_i32 s82, 0x1000
  s_nop 0
  buffer_load_dwordx4 v195, s[20:23], s82 offen offset:0 sc1 lds
  buffer_load_dwordx4 v195, s[20:23], s82 offen offset:1024 sc1 lds
  buffer_load_dwordx4 v195, s[20:23], s82 offen offset:2048 sc1 lds
  buffer_load_dwordx4 v195, s[20:23], s82 offen offset:3072 sc1 lds
  s_addk_i32 m0, 0x1000
  s_addk_i32 s82, 0x1000
  s_nop 0
  buffer_load_dwordx4 v195, s[20:23], s82 offen offset:0 sc1 lds
  buffer_load_dwordx4 v195, s[20:23], s82 offen offset:1024 sc1 lds
  buffer_load_dwordx4 v195, s[20:23], s82 offen offset:2048 sc1 lds
  buffer_load_dwordx4 v195, s[20:23], s82 offen offset:3072 sc1 lds
  s_addk_i32 m0, 0x1000
  s_addk_i32 s82, 0x1000
  s_nop 0
  buffer_load_dwordx4 v195, s[20:23], s82 offen offset:0 sc1 lds
  buffer_load_dwordx4 v195, s[20:23], s82 offen offset:1024 sc1 lds
  buffer_load_dwordx4 v195, s[20:23], s82 offen offset:2048 sc1 lds
  buffer_load_dwordx4 v195, s[20:23], s82 offen offset:3072 sc1 lds
  s_addk_i32 m0, 0x1000
  s_addk_i32 s82, 0x1000
  s_nop 0
  buffer_load_dwordx4 v195, s[20:23], s82 offen offset:0 sc1 lds
  buffer_load_dwordx4 v195, s[20:23], s82 offen offset:1024 sc1 lds
  s_branch L_p2
L_q2:
  s_lshl_b32 s53, s42, 13
  v_and_b32 v200, 15, v164
  v_lshrrev_b32 v201, 4, v164
  v_lshrrev_b32 v202, 1, v200
  v_xor_b32 v202, v202, v201
  v_lshlrev_b32 v203, 7, v200
  v_add_u32 v203, s53, v203
  v_lshl_add_u32 v178, v202, 4, v203
  v_xor_b32 v179, 64, v178
  v_lshrrev_b32 v208, 4, v164
  v_bfe_u32 v209, v164, 2, 2
  v_and_b32 v210, 3, v164
  v_lshl_add_u32 v211, v208, 3, v209
  v_and_b32 v200, 1, v208
  v_xor_b32 v200, v200, v210
  v_mul_u32_u24 v201, 320, v211
  v_lshl_add_u32 v201, v200, 4, v201
  v_add_u32 v201, 32768, v201
  v_and_b32 v202, 1, v210
  v_lshl_add_u32 v180, v202, 3, v201
  v_xor_b32 v181, 8, v180
  s_lshl_b32 s53, s58, 7
  s_add_u32 s53, s53, 159744
  v_lshl_add_u32 v184, v208, 4, s53
  s_mov_b32 s70, 1065353224
  s_mov_b32 s71, 1065353224
  v_mov_b64 v[0:1], 0
  v_mov_b64 v[2:3], 0
  v_mov_b64 v[4:5], 0
  v_mov_b64 v[6:7], 0
  v_mov_b64 v[8:9], 0
  v_mov_b64 v[10:11], 0
  v_mov_b64 v[12:13], 0
  v_mov_b64 v[14:15], 0
  v_mov_b64 v[16:17], 0
  v_mov_b64 v[18:19], 0
  v_mov_b64 v[20:21], 0
  v_mov_b64 v[22:23], 0
  v_mov_b64 v[24:25], 0
  v_mov_b64 v[26:27], 0
  v_mov_b64 v[28:29], 0
  v_mov_b64 v[30:31], 0
  v_mov_b64 v[32:33], 0
  v_mov_b64 v[34:35], 0
  v_mov_b64 v[36:37], 0
  v_mov_b64 v[38:39], 0
  v_mov_b64 v[40:41], 0
  v_mov_b64 v[42:43], 0
  v_mov_b64 v[44:45], 0
  v_mov_b64 v[46:47], 0
  v_mov_b64 v[48:49], 0
  v_mov_b64 v[50:51], 0
  v_mov_b64 v[52:53], 0
  v_mov_b64 v[54:55], 0
  v_mov_b64 v[56:57], 0
  v_mov_b64 v[58:59], 0
  v_mov_b64 v[60:61], 0
  v_mov_b64 v[62:63], 0
  v_mov_b64 v[64:65], 0
  v_mov_b64 v[66:67], 0
  v_mov_b64 v[68:69], 0
  v_mov_b64 v[70:71], 0
  v_mov_b64 v[72:73], 0
  v_mov_b64 v[74:75], 0
  v_mov_b64 v[76:77], 0
  v_mov_b64 v[78:79], 0
  v_mov_b64 v[80:81], 0
  v_mov_b64 v[82:83], 0
  v_mov_b64 v[84:85], 0
  v_mov_b64 v[86:87], 0
  v_mov_b64 v[88:89], 0
  v_mov_b64 v[90:91], 0
  v_mov_b64 v[92:93], 0
  v_mov_b64 v[94:95], 0
  v_mov_b64 v[96:97], 0
  v_mov_b64 v[98:99], 0
  v_mov_b64 v[100:101], 0
  v_mov_b64 v[102:103], 0
  v_mov_b64 v[104:105], 0
  v_mov_b64 v[106:107], 0
  v_mov_b64 v[108:109], 0
  v_mov_b64 v[110:111], 0
  v_mov_b64 v[112:113], 0
  v_mov_b64 v[114:115], 0
  v_mov_b64 v[116:117], 0
  v_mov_b64 v[118:119], 0
  v_mov_b64 v[120:121], 0
  v_mov_b64 v[122:123], 0
  v_mov_b64 v[124:125], 0
  v_mov_b64 v[126:127], 0
  v_mov_b64 v[128:129], 0
  v_mov_b64 v[130:131], 0
  v_mov_b64 v[132:133], 0
  v_mov_b64 v[134:135], 0
  v_mov_b64 v[136:137], 0
  v_mov_b64 v[138:139], 0
  v_mov_b64 v[140:141], 0
  v_mov_b64 v[142:143], 0
  v_mov_b64 v[144:145], 0
  v_mov_b64 v[146:147], 0
  v_mov_b64 v[148:149], 0
  v_mov_b64 v[150:151], 0
  v_mov_b64 v[152:153], 0
  v_mov_b64 v[154:155], 0
  v_mov_b64 v[156:157], 0
  v_mov_b64 v[158:159], 0
  v_mov_b64 v[160:161], 0
  v_mov_b64 v[162:163], 0
  s_add_u32 s44, s44, 128
  s_add_u32 s45, s45, 245760
  s_cmp_eq_u32 s44, 1280
  s_cselect_b32 s44, 0, s44
  s_cselect_b32 s45, 0, s45
  s_mov_b32 s46, 53248
  s_add_u32 m0, s46, s50
  s_nop 0
  buffer_load_dwordx4 v165, s[8:11], s44 offen lds
  s_addk_i32 m0, 0x400
  s_nop 0
  buffer_load_dwordx4 v166, s[8:11], s44 offen lds
  s_addk_i32 m0, 0x400
  s_nop 0
  buffer_load_dwordx4 v167, s[8:11], s44 offen lds
  s_addk_i32 m0, 0x400
  s_nop 0
  buffer_load_dwordx4 v168, s[8:11], s44 offen lds
  s_addk_i32 m0, 0x400
  s_nop 0
  buffer_load_dwordx4 v169, s[8:11], s44 offen lds
  s_addk_i32 m0, 0x400
  s_nop 0
  buffer_load_dwordx4 v170, s[8:11], s44 offen lds
  s_addk_i32 m0, 0x400
  s_nop 0
  buffer_load_dwordx4 v171, s[8:11], s44 offen lds
  s_addk_i32 m0, 0x400
  s_nop 0
  buffer_load_dwordx4 v172, s[8:11], s44 offen lds
  s_add_u32 m0, s46, s51
  s_nop 0
  buffer_load_dwordx4 v173, s[12:15], s45 offen lds
  s_addk_i32 m0, 0x400
  s_nop 0
  buffer_load_dwordx4 v174, s[12:15], s45 offen lds
  s_addk_i32 m0, 0x400
  s_nop 0
  buffer_load_dwordx4 v175, s[12:15], s45 offen lds
  s_addk_i32 m0, 0x400
  s_nop 0
  buffer_load_dwordx4 v176, s[12:15], s45 offen lds
  s_addk_i32 m0, 0x400
  s_nop 0
  buffer_load_dwordx4 v177, s[12:15], s45 offen lds
  s_add_u32 s44, s44, 128
  s_add_u32 s45, s45, 245760
  s_cmp_eq_u32 s44, 1280
  s_cselect_b32 s44, 0, s44
  s_cselect_b32 s45, 0, s45
  s_bfe_u32 s53, s2, 0x20001
  s_lshr_b32 s54, s2, 5
  s_lshl_b32 s53, s53, 3
  s_add_u32 s80, s53, s54
  s_and_b32 s53, s2, 1
  s_lshl_b32 s53, s53, 2
  s_bfe_u32 s54, s2, 0x20003
  s_add_u32 s81, s53, s54
  s_mul_i32 s53, s81, 48
  s_mul_i32 s54, s42, 12
  s_add_u32 s53, s53, s54
  s_mul_i32 s53, s53, 5120
  s_add_u32 s82, s53, 9437184
  s_and_b32 s53, s48, 127
  s_lshl_b32 s53, s53, 1
  s_lshr_b32 s54, s42, 1
  s_add_u32 s53, s53, s54
  s_mul_i32 s53, s53, 5120
  s_add_u32 s49, s53, 12386304
  s_lshl_b32 s53, s6, 2
  s_add_u32 s53, s53, s3
  s_lshl_b32 s53, s53, 8
  s_add_u32 s83, s53, 14729216
  s_xor_b32 s53, s3, 0
  s_lshl_b32 s53, s53, 10
  v_add_u32 v185, s53, v195
  s_xor_b32 s53, s3, 1
  s_lshl_b32 s53, s53, 10
  v_add_u32 v186, s53, v195
  s_xor_b32 s53, s3, 2
  s_lshl_b32 s53, s53, 10
  v_add_u32 v187, s53, v195
  s_xor_b32 s53, s3, 3
  s_lshl_b32 s53, s53, 10
  v_add_u32 v188, s53, v195
  v_lshlrev_b32 v201, 2, v164
  v_cmp_gt_u32 vcc, 16, v164
  v_mov_b32 v202, 2147418112
  s_nop 0
  v_cndmask_b32 v189, v202, v201, vcc
  s_waitcnt vmcnt(13)
  s_barrier
  ds_read_b128 a[0:3], v178 offset:0
  ds_read_b64_tr_b16 a[16:17], v180 offset:0
  ds_read_b64_tr_b16 a[18:19], v180 offset:1280
  ds_read_b64_tr_b16 a[20:21], v181 offset:0
  ds_read_b64_tr_b16 a[22:23], v181 offset:1280
  ds_read_b128 a[4:7], v178 offset:2048
  ds_read_b64_tr_b16 a[24:25], v180 offset:64
  ds_read_b64_tr_b16 a[26:27], v180 offset:1344
  ds_read_b64_tr_b16 a[28:29], v181 offset:64
  ds_read_b64_tr_b16 a[30:31], v181 offset:1344
  ds_read_b128 a[8:11], v178 offset:4096
  ds_read_b128 a[12:15], v178 offset:6144
  ds_read_b64_tr_b16 a[32:33], v180 offset:128
  ds_read_b64_tr_b16 a[34:35], v180 offset:1408
  ds_read_b64_tr_b16 a[36:37], v181 offset:128
  ds_read_b64_tr_b16 a[38:39], v181 offset:1408
  ds_read_b64_tr_b16 a[40:41], v180 offset:192
  ds_read_b64_tr_b16 a[42:43], v180 offset:1472
  ds_read_b64_tr_b16 a[44:45], v181 offset:192
  ds_read_b64_tr_b16 a[46:47], v181 offset:1472
  ds_read_b64_tr_b16 a[48:49], v180 offset:256
  ds_read_b64_tr_b16 a[50:51], v180 offset:1536
  ds_read_b64_tr_b16 a[52:53], v181 offset:256
  ds_read_b64_tr_b16 a[54:55], v181 offset:1536
  ds_read_b128 a[112:115], v184 offset:0
  s_mov_b32 s46, 106496
  s_add_u32 m0, s46, s50
  s_nop 0
  buffer_load_dwordx4 v165, s[8:11], s44 offen lds
  s_addk_i32 m0, 0x400
  s_nop 0
  buffer_load_dwordx4 v166, s[8:11], s44 offen lds
  s_addk_i32 m0, 0x400
  s_nop 0
  buffer_load_dwordx4 v167, s[8:11], s44 offen lds
  s_addk_i32 m0, 0x400
  s_nop 0
  buffer_load_dwordx4 v168, s[8:11], s44 offen lds
  s_addk_i32 m0, 0x400
  s_nop 0
  buffer_load_dwordx4 v169, s[8:11], s44 offen lds
  s_addk_i32 m0, 0x400
  s_nop 0
  buffer_load_dwordx4 v170, s[8:11], s44 offen lds
  s_addk_i32 m0, 0x400
  s_nop 0
  buffer_load_dwordx4 v171, s[8:11], s44 offen lds
  s_cmp_eq_u32 s42, 0
  s_cselect_b32 s91, 18, 0
  s_cselect_b32 s92, 64, 0
  s_mov_b32 s43, -1
  s_mov_b32 s59, 53248
  s_mov_b32 s47, 4294860800
  s_waitcnt lgkmcnt(0)
  s_mul_i32 s100, s100, 0x9E3779B1
  s_add_u32 s100, s100, 0x7F4A7C15
  v_mov_b32 v196, s100
  s_and_b32 s93, s2, 31
  s_lshl_b32 s93, s93, 8
  s_lshr_b32 s53, s2, 5
  s_lshl_b32 s53, s53, 2
  s_add_u32 s93, s93, s53
  s_add_u32 s93, s93, 14696448
  v_lshrrev_b32 v198, 1, v164
  v_lshlrev_b32 v198, 8, v198
  v_and_b32 v243, 16, v195
  s_mov_b32 s53, 14696448
  v_add3_u32 v198, v198, v243, s53
  s_branch L_q_mid
L_q_evT:
  buffer_load_dwordx4 v[244:247], v198, s[20:23], 0 offen sc1
  s_branch L_q_evT_ret
L_q_evE:
  s_cmp_lg_u32 s43, 4
  s_cbranch_scc1 L_q_evE4
  v_lshlrev_b32 v240, 7, v164
  s_mul_i32 s53, s2, 3200
  s_add_u32 s53, s53, 11403264
  s_mov_b64 exec, 0x1ffffff
  buffer_load_dword v241, v240, s[20:23], s53 offen sc1
  s_mul_i32 s53, s2, 640
  s_add_u32 s53, s53, 14680064
  s_mov_b64 exec, 0x1f
  buffer_load_dword v241, v240, s[20:23], s53 offen sc1
  s_mov_b64 exec, -1
  s_branch L_q_evE_ret
L_q_evE4:
  s_mov_b64 exec, 1
  buffer_store_dword v196, off, s[20:23], s93 sc1
  s_mov_b64 exec, -1
  s_branch L_q_evE_ret
L_q_A:
  s_waitcnt vmcnt(13) lgkmcnt(0)
  s_barrier
  v_add_u32 v178, s47, v178
  v_add_u32 v179, s47, v179
  v_add_u32 v180, s47, v180
  v_add_u32 v181, s47, v181
  v_add_u32 v184, 128, v184
  v_add_u32 v190, 4294966016, v184
  v_cmp_gt_u32 vcc, 161024, v184
  s_nop 1
  v_cndmask_b32 v184, v190, v184, vcc
  s_bitcmp1_b32 s92, s43
  s_cbranch_scc1 L_q_evT
L_q_evT_ret:
  v_mfma_f32_16x16x32_bf16 v[0:3], a[72:75], a[56:59], v[0:3]
  ds_read_b128 a[0:3], v178 offset:0
  v_mfma_f32_16x16x32_bf16 v[4:7], a[76:79], a[56:59], v[4:7]
  ds_read_b64_tr_b16 a[16:17], v180 offset:0
  s_add_u32 m0, s46, s50
  v_mfma_f32_16x16x32_bf16 v[8:11], a[80:83], a[56:59], v[8:11]
  ds_read_b64_tr_b16 a[18:19], v180 offset:1280
  buffer_load_dwordx4 v165, s[8:11], s44 offen lds
  v_mfma_f32_16x16x32_bf16 v[12:15], a[84:87], a[56:59], v[12:15]
  ds_read_b64_tr_b16 a[20:21], v181 offset:0
  v_mfma_f32_16x16x32_bf16 v[16:19], a[88:91], a[56:59], v[16:19]
  v_mfma_f32_16x16x32_bf16 v[20:23], a[92:95], a[56:59], v[20:23]
  ds_read_b64_tr_b16 a[22:23], v181 offset:1280
  v_mfma_f32_16x16x32_bf16 v[24:27], a[96:99], a[56:59], v[24:27]
  ds_read_b128 a[4:7], v178 offset:2048
  v_mfma_f32_16x16x32_bf16 v[28:31], a[100:103], a[56:59], v[28:31]
  ds_read_b64_tr_b16 a[24:25], v180 offset:64
  s_addk_i32 m0, 0x400
  v_mfma_f32_16x16x32_bf16 v[32:35], a[104:107], a[56:59], v[32:35]
  ds_read_b64_tr_b16 a[26:27], v180 offset:1344
  buffer_load_dwordx4 v166, s[8:11], s44 offen lds
  v_mfma_f32_16x16x32_bf16 v[36:39], a[108:111], a[56:59], v[36:39]
  v_mfma_f32_16x16x32_bf16 v[40:43], a[72:75], a[60:63], v[40:43]
  ds_read_b64_tr_b16 a[28:29], v181 offset:64
  v_mfma_f32_16x16x32_bf16 v[44:47], a[76:79], a[60:63], v[44:47]
  ds_read_b64_tr_b16 a[30:31], v181 offset:1344
  v_mfma_f32_16x16x32_bf16 v[48:51], a[80:83], a[60:63], v[48:51]
  ds_read_b128 a[8:11], v178 offset:4096
  v_mfma_f32_16x16x32_bf16 v[52:55], a[84:87], a[60:63], v[52:55]
  s_addk_i32 m0, 0x400
  v_mfma_f32_16x16x32_bf16 v[56:59], a[88:91], a[60:63], v[56:59]
  ds_read_b128 a[12:15], v178 offset:6144
  buffer_load_dwordx4 v167, s[8:11], s44 offen lds
  v_mfma_f32_16x16x32_bf16 v[60:63], a[92:95], a[60:63], v[60:63]
  ds_read_b64_tr_b16 a[32:33], v180 offset:128
  v_mfma_f32_16x16x32_bf16 v[64:67], a[96:99], a[60:63], v[64:67]
  ds_read_b64_tr_b16 a[34:35], v180 offset:1408
  v_mfma_f32_16x16x32_bf16 v[68:71], a[100:103], a[60:63], v[68:71]
  ds_read_b64_tr_b16 a[36:37], v181 offset:128
  v_mfma_f32_16x16x32_bf16 v[72:75], a[104:107], a[60:63], v[72:75]
  v_mfma_f32_16x16x32_bf16 v[76:79], a[108:111], a[60:63], v[76:79]
  ds_read_b64_tr_b16 a[38:39], v181 offset:1408
  s_addk_i32 m0, 0x400
  v_mfma_f32_16x16x32_bf16 v[80:83], a[72:75], a[64:67], v[80:83]
  ds_read_b64_tr_b16 a[40:41], v180 offset:192
  buffer_load_dwordx4 v168, s[8:11], s44 offen lds
  v_mfma_f32_16x16x32_bf16 v[84:87], a[76:79], a[64:67], v[84:87]
  ds_read_b64_tr_b16 a[42:43], v180 offset:1472
  v_mfma_f32_16x16x32_bf16 v[88:91], a[80:83], a[64:67], v[88:91]
  v_mfma_f32_16x16x32_bf16 v[92:95], a[84:87], a[64:67], v[92:95]
  ds_read_b64_tr_b16 a[44:45], v181 offset:192
  v_mfma_f32_16x16x32_bf16 v[96:99], a[88:91], a[64:67], v[96:99]
  ds_read_b64_tr_b16 a[46:47], v181 offset:1472
  v_mfma_f32_16x16x32_bf16 v[100:103], a[92:95], a[64:67], v[100:103]
  ds_read_b64_tr_b16 a[48:49], v180 offset:256
  s_addk_i32 m0, 0x400
  v_mfma_f32_16x16x32_bf16 v[104:107], a[96:99], a[64:67], v[104:107]
  ds_read_b64_tr_b16 a[50:51], v180 offset:1536
  buffer_load_dwordx4 v169, s[8:11], s44 offen lds
  v_mfma_f32_16x16x32_bf16 v[108:111], a[100:103], a[64:67], v[108:111]
  v_mfma_f32_16x16x32_bf16 v[112:115], a[104:107], a[64:67], v[112:115]
  ds_read_b64_tr_b16 a[52:53], v181 offset:256
  v_mfma_f32_16x16x32_bf16 v[116:119], a[108:111], a[64:67], v[116:119]
  ds_read_b64_tr_b16 a[54:55], v181 offset:1536
  v_mfma_f32_16x16x32_bf16 v[120:123], a[72:75], a[68:71], v[120:123]
  ds_read_b128 a[112:115], v184 offset:0
  v_mfma_f32_16x16x32_bf16 v[124:127], a[76:79], a[68:71], v[124:127]
  s_addk_i32 m0, 0x400
  v_mfma_f32_16x16x32_bf16 v[128:131], a[80:83], a[68:71], v[128:131]
  buffer_load_dwordx4 v170, s[8:11], s44 offen lds
  v_mfma_f32_16x16x32_bf16 v[132:135], a[84:87], a[68:71], v[132:135]
  v_mfma_f32_16x16x32_bf16 v[136:139], a[88:91], a[68:71], v[136:139]
  v_mfma_f32_16x16x32_bf16 v[140:143], a[92:95], a[68:71], v[140:143]
  v_mfma_f32_16x16x32_bf16 v[144:147], a[96:99], a[68:71], v[144:147]
  v_mfma_f32_16x16x32_bf16 v[148:151], a[100:103], a[68:71], v[148:151]
  s_addk_i32 m0, 0x400
  v_mfma_f32_16x16x32_bf16 v[152:155], a[104:107], a[68:71], v[152:155]
  buffer_load_dwordx4 v171, s[8:11], s44 offen lds
  v_mfma_f32_16x16x32_bf16 v[156:159], a[108:111], a[68:71], v[156:159]
  v_mfma_f32_16x16x32_bf16 v[160:163], a[116:119], a[56:59], v[160:163]
L_q_mid:
  s_waitcnt lgkmcnt(0)
  v_mfma_f32_16x16x32_bf16 v[0:3], a[16:19], a[0:3], v[0:3]
  ds_read_b128 a[56:59], v179 offset:0
  v_mfma_f32_16x16x32_bf16 v[4:7], a[20:23], a[0:3], v[4:7]
  ds_read_b64_tr_b16 a[72:73], v180 offset:10240
  v_mfma_f32_16x16x32_bf16 v[8:11], a[24:27], a[0:3], v[8:11]
  ds_read_b64_tr_b16 a[74:75], v180 offset:11520
  s_addk_i32 m0, 0x400
  v_mfma_f32_16x16x32_bf16 v[12:15], a[28:31], a[0:3], v[12:15]
  ds_read_b64_tr_b16 a[76:77], v181 offset:10240
  buffer_load_dwordx4 v172, s[8:11], s44 offen lds
  v_mfma_f32_16x16x32_bf16 v[16:19], a[32:35], a[0:3], v[16:19]
  v_mfma_f32_16x16x32_bf16 v[20:23], a[36:39], a[0:3], v[20:23]
  ds_read_b64_tr_b16 a[78:79], v181 offset:11520
  v_mfma_f32_16x16x32_bf16 v[24:27], a[40:43], a[0:3], v[24:27]
  ds_read_b128 a[60:63], v179 offset:2048
  v_mfma_f32_16x16x32_bf16 v[28:31], a[44:47], a[0:3], v[28:31]
  ds_read_b64_tr_b16 a[80:81], v180 offset:10304
  v_mfma_f32_16x16x32_bf16 v[32:35], a[48:51], a[0:3], v[32:35]
  ds_read_b64_tr_b16 a[82:83], v180 offset:11584
  s_add_u32 m0, s46, s51
  v_mfma_f32_16x16x32_bf16 v[36:39], a[52:55], a[0:3], v[36:39]
  buffer_load_dwordx4 v173, s[12:15], s45 offen lds
  v_mfma_f32_16x16x32_bf16 v[40:43], a[16:19], a[4:7], v[40:43]
  ds_read_b64_tr_b16 a[84:85], v181 offset:10304
  v_mfma_f32_16x16x32_bf16 v[44:47], a[20:23], a[4:7], v[44:47]
  ds_read_b64_tr_b16 a[86:87], v181 offset:11584
  v_mfma_f32_16x16x32_bf16 v[48:51], a[24:27], a[4:7], v[48:51]
  ds_read_b128 a[64:67], v179 offset:4096
  v_mfma_f32_16x16x32_bf16 v[52:55], a[28:31], a[4:7], v[52:55]
  v_mfma_f32_16x16x32_bf16 v[56:59], a[32:35], a[4:7], v[56:59]
  ds_read_b128 a[68:71], v179 offset:6144
  s_addk_i32 m0, 0x400
  v_mfma_f32_16x16x32_bf16 v[60:63], a[36:39], a[4:7], v[60:63]
  ds_read_b64_tr_b16 a[88:89], v180 offset:10368
  buffer_load_dwordx4 v174, s[12:15], s45 offen lds
  v_mfma_f32_16x16x32_bf16 v[64:67], a[40:43], a[4:7], v[64:67]
  ds_read_b64_tr_b16 a[90:91], v180 offset:11648
  v_mfma_f32_16x16x32_bf16 v[68:71], a[44:47], a[4:7], v[68:71]
  ds_read_b64_tr_b16 a[92:93], v181 offset:10368
  v_mfma_f32_16x16x32_bf16 v[72:75], a[48:51], a[4:7], v[72:75]
  v_mfma_f32_16x16x32_bf16 v[76:79], a[52:55], a[4:7], v[76:79]
  ds_read_b64_tr_b16 a[94:95], v181 offset:11648
  v_mfma_f32_16x16x32_bf16 v[80:83], a[16:19], a[8:11], v[80:83]
  ds_read_b64_tr_b16 a[96:97], v180 offset:10432
  s_addk_i32 m0, 0x400
  v_mfma_f32_16x16x32_bf16 v[84:87], a[20:23], a[8:11], v[84:87]
  ds_read_b64_tr_b16 a[98:99], v180 offset:11712
  buffer_load_dwordx4 v175, s[12:15], s45 offen lds
  v_mfma_f32_16x16x32_bf16 v[88:91], a[24:27], a[8:11], v[88:91]
  v_mfma_f32_16x16x32_bf16 v[92:95], a[28:31], a[8:11], v[92:95]
  ds_read_b64_tr_b16 a[100:101], v181 offset:10432
  v_mfma_f32_16x16x32_bf16 v[96:99], a[32:35], a[8:11], v[96:99]
  ds_read_b64_tr_b16 a[102:103], v181 offset:11712
  v_mfma_f32_16x16x32_bf16 v[100:103], a[36:39], a[8:11], v[100:103]
  ds_read_b64_tr_b16 a[104:105], v180 offset:10496
  v_mfma_f32_16x16x32_bf16 v[104:107], a[40:43], a[8:11], v[104:107]
  ds_read_b64_tr_b16 a[106:107], v180 offset:11776
  s_addk_i32 m0, 0x400
  v_mfma_f32_16x16x32_bf16 v[108:111], a[44:47], a[8:11], v[108:111]
  buffer_load_dwordx4 v176, s[12:15], s45 offen lds
  v_mfma_f32_16x16x32_bf16 v[112:115], a[48:51], a[8:11], v[112:115]
  ds_read_b64_tr_b16 a[108:109], v181 offset:10496
  v_mfma_f32_16x16x32_bf16 v[116:119], a[52:55], a[8:11], v[116:119]
  ds_read_b64_tr_b16 a[110:111], v181 offset:11776
  v_mfma_f32_16x16x32_bf16 v[120:123], a[16:19], a[12:15], v[120:123]
  ds_read_b128 a[116:119], v184 offset:64
  v_mfma_f32_16x16x32_bf16 v[124:127], a[20:23], a[12:15], v[124:127]
  v_mfma_f32_16x16x32_bf16 v[128:131], a[24:27], a[12:15], v[128:131]
  s_addk_i32 m0, 0x400
  v_mfma_f32_16x16x32_bf16 v[132:135], a[28:31], a[12:15], v[132:135]
  buffer_load_dwordx4 v177, s[12:15], s45 offen lds
  v_mfma_f32_16x16x32_bf16 v[136:139], a[32:35], a[12:15], v[136:139]
  s_add_u32 s44, s44, 128
  s_add_u32 s45, s45, 245760
  s_cmp_eq_u32 s44, 1280
  s_cselect_b32 s44, 0, s44
  s_cselect_b32 s45, 0, s45
  v_mfma_f32_16x16x32_bf16 v[140:143], a[36:39], a[12:15], v[140:143]
  s_add_u32 s46, s46, s47
  s_add_u32 s43, s43, 1
  v_mfma_f32_16x16x32_bf16 v[144:147], a[40:43], a[12:15], v[144:147]
  s_cmp_eq_u32 s46, 106496
  s_cselect_b32 s47, 4294860800, s59
  v_mfma_f32_16x16x32_bf16 v[148:151], a[44:47], a[12:15], v[148:151]
  v_mfma_f32_16x16x32_bf16 v[152:155], a[48:51], a[12:15], v[152:155]
  s_bitcmp1_b32 s91, s43
  v_mfma_f32_16x16x32_bf16 v[156:159], a[52:55], a[12:15], v[156:159]
  v_mfma_f32_16x16x32_bf16 v[160:163], a[112:115], a[0:3], v[160:163]
  s_cbranch_scc1 L_q_evE
L_q_evE_ret:
  s_cmp_lt_u32 s43, 7
  s_cbranch_scc1 L_q_A
  s_waitcnt vmcnt(13) lgkmcnt(0)
  s_cmp_lg_u32 s42, 0
  s_cbranch_scc1 L_qfw_done
  s_mov_b32 s57, 0
L_qfw_poll:
  v_cmp_eq_u32 vcc, s100, v244
  v_cmp_eq_u32 s[76:77], s100, v245
  s_nop 0
  s_and_b64 vcc, vcc, s[76:77]
  v_cmp_eq_u32 s[76:77], s100, v246
  s_nop 0
  s_and_b64 vcc, vcc, s[76:77]
  v_cmp_eq_u32 s[76:77], s100, v247
  s_nop 0
  s_and_b64 vcc, vcc, s[76:77]
  s_cmp_eq_u64 vcc, -1
  s_cbranch_scc1 L_qfw_ok
  s_add_u32 s57, s57, 1
  s_cmp_gt_u32 s57, 131072
  s_cbranch_scc1 L_qfw_ok
  s_sleep 8
  buffer_load_dwordx4 v[244:247], v198, s[20:23], 0 offen sc1
  s_waitcnt vmcnt(0)
  s_branch L_qfw_poll
L_qfw_ok:
L_qfw_done:
  s_barrier
  v_add_u32 v178, 53248, v178
  v_add_u32 v179, 53248, v179
  v_add_u32 v180, 53248, v180
  v_add_u32 v181, 53248, v181
  v_add_u32 v184, 128, v184
  v_add_u32 v190, 4294966016, v184
  v_cmp_gt_u32 vcc, 161024, v184
  s_nop 1
  v_cndmask_b32 v184, v190, v184, vcc
  v_mfma_f32_16x16x32_bf16 v[0:3], a[72:75], a[56:59], v[0:3]
  ds_read_b128 a[0:3], v178 offset:0
  v_mfma_f32_16x16x32_bf16 v[4:7], a[76:79], a[56:59], v[4:7]
  ds_read_b64_tr_b16 a[16:17], v180 offset:0
  buffer_load_dwordx4 a[120:123], v195, s[20:23], s82 offen offset:0 sc1
  v_mfma_f32_16x16x32_bf16 v[8:11], a[80:83], a[56:59], v[8:11]
  ds_read_b64_tr_b16 a[18:19], v180 offset:1280
  v_mfma_f32_16x16x32_bf16 v[12:15], a[84:87], a[56:59], v[12:15]
  ds_read_b64_tr_b16 a[20:21], v181 offset:0
  v_mfma_f32_16x16x32_bf16 v[16:19], a[88:91], a[56:59], v[16:19]
  v_mfma_f32_16x16x32_bf16 v[20:23], a[92:95], a[56:59], v[20:23]
  ds_read_b64_tr_b16 a[22:23], v181 offset:1280
  buffer_load_dwordx4 a[124:127], v195, s[20:23], s82 offen offset:1024 sc1
  v_mfma_f32_16x16x32_bf16 v[24:27], a[96:99], a[56:59], v[24:27]
  ds_read_b128 a[4:7], v178 offset:2048
  v_mfma_f32_16x16x32_bf16 v[28:31], a[100:103], a[56:59], v[28:31]
  ds_read_b64_tr_b16 a[24:25], v180 offset:64
  v_mfma_f32_16x16x32_bf16 v[32:35], a[104:107], a[56:59], v[32:35]
  ds_read_b64_tr_b16 a[26:27], v180 offset:1344
  v_mfma_f32_16x16x32_bf16 v[36:39], a[108:111], a[56:59], v[36:39]
  v_mfma_f32_16x16x32_bf16 v[40:43], a[72:75], a[60:63], v[40:43]
  ds_read_b64_tr_b16 a[28:29], v181 offset:64
  buffer_load_dwordx4 a[128:131], v195, s[20:23], s82 offen offset:2048 sc1
  v_mfma_f32_16x16x32_bf16 v[44:47], a[76:79], a[60:63], v[44:47]
  ds_read_b64_tr_b16 a[30:31], v181 offset:1344
  v_mfma_f32_16x16x32_bf16 v[48:51], a[80:83], a[60:63], v[48:51]
  ds_read_b128 a[8:11], v178 offset:4096
  v_mfma_f32_16x16x32_bf16 v[52:55], a[84:87], a[60:63], v[52:55]
  v_mfma_f32_16x16x32_bf16 v[56:59], a[88:91], a[60:63], v[56:59]
  ds_read_b128 a[12:15], v178 offset:6144
  buffer_load_dwordx4 a[132:135], v195, s[20:23], s82 offen offset:3072 sc1
  v_mfma_f32_16x16x32_bf16 v[60:63], a[92:95], a[60:63], v[60:63]
  ds_read_b64_tr_b16 a[32:33], v180 offset:128
  v_mfma_f32_16x16x32_bf16 v[64:67], a[96:99], a[60:63], v[64:67]
  ds_read_b64_tr_b16 a[34:35], v180 offset:1408
  v_mfma_f32_16x16x32_bf16 v[68:71], a[100:103], a[60:63], v[68:71]
  ds_read_b64_tr_b16 a[36:37], v181 offset:128
  v_mfma_f32_16x16x32_bf16 v[72:75], a[104:107], a[60:63], v[72:75]
  v_mfma_f32_16x16x32_bf16 v[76:79], a[108:111], a[60:63], v[76:79]
  ds_read_b64_tr_b16 a[38:39], v181 offset:1408
  s_addk_i32 s82, 0x1000
  buffer_load_dwordx4 a[136:139], v195, s[20:23], s82 offen offset:0 sc1
  v_mfma_f32_16x16x32_bf16 v[80:83], a[72:75], a[64:67], v[80:83]
  ds_read_b64_tr_b16 a[40:41], v180 offset:192
  v_mfma_f32_16x16x32_bf16 v[84:87], a[76:79], a[64:67], v[84:87]
  ds_read_b64_tr_b16 a[42:43], v180 offset:1472
  v_mfma_f32_16x16x32_bf16 v[88:91], a[80:83], a[64:67], v[88:91]
  v_mfma_f32_16x16x32_bf16 v[92:95], a[84:87], a[64:67], v[92:95]
  ds_read_b64_tr_b16 a[44:45], v181 offset:192
  v_mfma_f32_16x16x32_bf16 v[96:99], a[88:91], a[64:67], v[96:99]
  ds_read_b64_tr_b16 a[46:47], v181 offset:1472
  buffer_load_dwordx4 a[140:143], v195, s[20:23], s82 offen offset:1024 sc1
  v_mfma_f32_16x16x32_bf16 v[100:103], a[92:95], a[64:67], v[100:103]
  ds_read_b64_tr_b16 a[48:49], v180 offset:256
  v_mfma_f32_16x16x32_bf16 v[104:107], a[96:99], a[64:67], v[104:107]
  ds_read_b64_tr_b16 a[50:51], v180 offset:1536
  v_mfma_f32_16x16x32_bf16 v[108:111], a[100:103], a[64:67], v[108:111]
  v_mfma_f32_16x16x32_bf16 v[112:115], a[104:107], a[64:67], v[112:115]
  ds_read_b64_tr_b16 a[52:53], v181 offset:256
  buffer_load_dwordx4 a[144:147], v195, s[20:23], s82 offen offset:2048 sc1
  v_mfma_f32_16x16x32_bf16 v[116:119], a[108:111], a[64:67], v[116:119]
  ds_read_b64_tr_b16 a[54:55], v181 offset:1536
  v_mfma_f32_16x16x32_bf16 v[120:123], a[72:75], a[68:71], v[120:123]
  ds_read_b128 a[112:115], v184 offset:0
  v_mfma_f32_16x16x32_bf16 v[124:127], a[76:79], a[68:71], v[124:127]
  v_mfma_f32_16x16x32_bf16 v[128:131], a[80:83], a[68:71], v[128:131]
  v_mfma_f32_16x16x32_bf16 v[132:135], a[84:87], a[68:71], v[132:135]
  buffer_load_dwordx4 a[148:151], v195, s[20:23], s82 offen offset:3072 sc1
  v_mfma_f32_16x16x32_bf16 v[136:139], a[88:91], a[68:71], v[136:139]
  v_mfma_f32_16x16x32_bf16 v[140:143], a[92:95], a[68:71], v[140:143]
  v_mfma_f32_16x16x32_bf16 v[144:147], a[96:99], a[68:71], v[144:147]
  v_mfma_f32_16x16x32_bf16 v[148:151], a[100:103], a[68:71], v[148:151]
  v_mfma_f32_16x16x32_bf16 v[152:155], a[104:107], a[68:71], v[152:155]
  s_addk_i32 s82, 0x1000
  v_mfma_f32_16x16x32_bf16 v[156:159], a[108:111], a[68:71], v[156:159]
  v_mfma_f32_16x16x32_bf16 v[160:163], a[116:119], a[56:59], v[160:163]
  s_waitcnt lgkmcnt(0)
  v_mfma_f32_16x16x32_bf16 v[0:3], a[16:19], a[0:3], v[0:3]
  ds_read_b128 a[56:59], v179 offset:0
  v_mfma_f32_16x16x32_bf16 v[4:7], a[20:23], a[0:3], v[4:7]
  ds_read_b64_tr_b16 a[72:73], v180 offset:10240
  buffer_load_dwordx4 a[152:155], v195, s[20:23], s82 offen offset:0 sc1
  v_mfma_f32_16x16x32_bf16 v[8:11], a[24:27], a[0:3], v[8:11]
  ds_read_b64_tr_b16 a[74:75], v180 offset:11520
  v_mfma_f32_16x16x32_bf16 v[12:15], a[28:31], a[0:3], v[12:15]
  ds_read_b64_tr_b16 a[76:77], v181 offset:10240
  v_mfma_f32_16x16x32_bf16 v[16:19], a[32:35], a[0:3], v[16:19]
  buffer_load_dwordx4 a[156:159], v195, s[20:23], s82 offen offset:1024 sc1
  v_mfma_f32_16x16x32_bf16 v[20:23], a[36:39], a[0:3], v[20:23]
  ds_read_b64_tr_b16 a[78:79], v181 offset:11520
  v_mfma_f32_16x16x32_bf16 v[24:27], a[40:43], a[0:3], v[24:27]
  ds_read_b128 a[60:63], v179 offset:2048
  v_mfma_f32_16x16x32_bf16 v[28:31], a[44:47], a[0:3], v[28:31]
  ds_read_b64_tr_b16 a[80:81], v180 offset:10304
  buffer_load_dwordx4 a[160:163], v195, s[20:23], s82 offen offset:2048 sc1
  v_mfma_f32_16x16x32_bf16 v[32:35], a[48:51], a[0:3], v[32:35]
  ds_read_b64_tr_b16 a[82:83], v180 offset:11584
  v_mfma_f32_16x16x32_bf16 v[36:39], a[52:55], a[0:3], v[36:39]
  v_mfma_f32_16x16x32_bf16 v[40:43], a[16:19], a[4:7], v[40:43]
  ds_read_b64_tr_b16 a[84:85], v181 offset:10304
  v_mfma_f32_16x16x32_bf16 v[44:47], a[20:23], a[4:7], v[44:47]
  ds_read_b64_tr_b16 a[86:87], v181 offset:11584
  buffer_load_dwordx4 a[164:167], v195, s[20:23], s82 offen offset:3072 sc1
  v_mfma_f32_16x16x32_bf16 v[48:51], a[24:27], a[4:7], v[48:51]
  ds_read_b128 a[64:67], v179 offset:4096
  v_mfma_f32_16x16x32_bf16 v[52:55], a[28:31], a[4:7], v[52:55]
  v_mfma_f32_16x16x32_bf16 v[56:59], a[32:35], a[4:7], v[56:59]
  ds_read_b128 a[68:71], v179 offset:6144
  s_addk_i32 s82, 0x1000
  buffer_load_dwordx4 a[168:171], v195, s[20:23], s82 offen offset:0 sc1
  v_mfma_f32_16x16x32_bf16 v[60:63], a[36:39], a[4:7], v[60:63]
  ds_read_b64_tr_b16 a[88:89], v180 offset:10368
  v_mfma_f32_16x16x32_bf16 v[64:67], a[40:43], a[4:7], v[64:67]
  ds_read_b64_tr_b16 a[90:91], v180 offset:11648
  v_mfma_f32_16x16x32_bf16 v[68:71], a[44:47], a[4:7], v[68:71]
  ds_read_b64_tr_b16 a[92:93], v181 offset:10368
  buffer_load_dwordx4 a[172:175], v195, s[20:23], s82 offen offset:1024 sc1
  v_mfma_f32_16x16x32_bf16 v[72:75], a[48:51], a[4:7], v[72:75]
  v_mfma_f32_16x16x32_bf16 v[76:79], a[52:55], a[4:7], v[76:79]
  ds_read_b64_tr_b16 a[94:95], v181 offset:11648
  v_mfma_f32_16x16x32_bf16 v[80:83], a[16:19], a[8:11], v[80:83]
  ds_read_b64_tr_b16 a[96:97], v180 offset:10432
  v_mfma_f32_16x16x32_bf16 v[84:87], a[20:23], a[8:11], v[84:87]
  ds_read_b64_tr_b16 a[98:99], v180 offset:11712
  buffer_load_dwordx4 a[176:179], v195, s[20:23], s82 offen offset:2048 sc1
  v_mfma_f32_16x16x32_bf16 v[88:91], a[24:27], a[8:11], v[88:91]
  v_mfma_f32_16x16x32_bf16 v[92:95], a[28:31], a[8:11], v[92:95]
  ds_read_b64_tr_b16 a[100:101], v181 offset:10432
  v_mfma_f32_16x16x32_bf16 v[96:99], a[32:35], a[8:11], v[96:99]
  ds_read_b64_tr_b16 a[102:103], v181 offset:11712
  buffer_load_dwordx4 a[180:183], v195, s[20:23], s82 offen offset:3072 sc1
  v_mfma_f32_16x16x32_bf16 v[100:103], a[36:39], a[8:11], v[100:103]
  ds_read_b64_tr_b16 a[104:105], v180 offset:10496
  v_mfma_f32_16x16x32_bf16 v[104:107], a[40:43], a[8:11], v[104:107]
  ds_read_b64_tr_b16 a[106:107], v180 offset:11776
  v_mfma_f32_16x16x32_bf16 v[108:111], a[44:47], a[8:11], v[108:111]
  s_addk_i32 s82, 0x1000
  buffer_load_dwordx4 a[184:187], v195, s[20:23], s82 offen offset:0 sc1
  v_mfma_f32_16x16x32_bf16 v[112:115], a[48:51], a[8:11], v[112:115]
  ds_read_b64_tr_b16 a[108:109], v181 offset:10496
  v_mfma_f32_16x16x32_bf16 v[116:119], a[52:55], a[8:11], v[116:119]
  ds_read_b64_tr_b16 a[110:111], v181 offset:11776
  v_mfma_f32_16x16x32_bf16 v[120:123], a[16:19], a[12:15], v[120:123]
  ds_read_b128 a[116:119], v184 offset:64
  v_mfma_f32_16x16x32_bf16 v[124:127], a[20:23], a[12:15], v[124:127]
  buffer_load_dwordx4 a[188:191], v195, s[20:23], s82 offen offset:1024 sc1
  v_mfma_f32_16x16x32_bf16 v[128:131], a[24:27], a[12:15], v[128:131]
  v_mfma_f32_16x16x32_bf16 v[132:135], a[28:31], a[12:15], v[132:135]
  v_mfma_f32_16x16x32_bf16 v[136:139], a[32:35], a[12:15], v[136:139]
  buffer_load_dwordx4 a[192:195], v195, s[20:23], s82 offen offset:2048 sc1
  v_mfma_f32_16x16x32_bf16 v[140:143], a[36:39], a[12:15], v[140:143]
  v_mfma_f32_16x16x32_bf16 v[144:147], a[40:43], a[12:15], v[144:147]
  v_mfma_f32_16x16x32_bf16 v[148:151], a[44:47], a[12:15], v[148:151]
  v_mfma_f32_16x16x32_bf16 v[152:155], a[48:51], a[12:15], v[152:155]
  v_mfma_f32_16x16x32_bf16 v[156:159], a[52:55], a[12:15], v[156:159]
  v_mfma_f32_16x16x32_bf16 v[160:163], a[112:115], a[0:3], v[160:163]
  s_waitcnt vmcnt(19) lgkmcnt(0)
  s_barrier
  v_add_u32 v178, 4294860800, v178
  v_add_u32 v179, 4294860800, v179
  v_add_u32 v180, 4294860800, v180
  v_add_u32 v181, 4294860800, v181
  v_add_u32 v184, 128, v184
  v_add_u32 v190, 4294966016, v184
  v_cmp_gt_u32 vcc, 161024, v184
  s_nop 1
  v_cndmask_b32 v184, v190, v184, vcc
  v_mfma_f32_16x16x32_bf16 v[0:3], a[72:75], a[56:59], v[0:3]
  ds_read_b128 a[0:3], v178 offset:0
  v_mfma_f32_16x16x32_bf16 v[4:7], a[76:79], a[56:59], v[4:7]
  ds_read_b64_tr_b16 a[16:17], v180 offset:0
  buffer_load_dwordx4 a[196:199], v195, s[20:23], s82 offen offset:3072 sc1
  v_mfma_f32_16x16x32_bf16 v[8:11], a[80:83], a[56:59], v[8:11]
  ds_read_b64_tr_b16 a[18:19], v180 offset:1280
  v_mfma_f32_16x16x32_bf16 v[12:15], a[84:87], a[56:59], v[12:15]
  ds_read_b64_tr_b16 a[20:21], v181 offset:0
  v_mfma_f32_16x16x32_bf16 v[16:19], a[88:91], a[56:59], v[16:19]
  s_addk_i32 s82, 0x1000
  buffer_load_dwordx4 a[200:203], v195, s[20:23], s82 offen offset:0 sc1
  v_mfma_f32_16x16x32_bf16 v[20:23], a[92:95], a[56:59], v[20:23]
  ds_read_b64_tr_b16 a[22:23], v181 offset:1280
  v_mfma_f32_16x16x32_bf16 v[24:27], a[96:99], a[56:59], v[24:27]
  ds_read_b128 a[4:7], v178 offset:2048
  v_mfma_f32_16x16x32_bf16 v[28:31], a[100:103], a[56:59], v[28:31]
  ds_read_b64_tr_b16 a[24:25], v180 offset:64
  buffer_load_dwordx4 a[204:207], v195, s[20:23], s82 offen offset:1024 sc1
  v_mfma_f32_16x16x32_bf16 v[32:35], a[104:107], a[56:59], v[32:35]
  ds_read_b64_tr_b16 a[26:27], v180 offset:1344
  v_mfma_f32_16x16x32_bf16 v[36:39], a[108:111], a[56:59], v[36:39]
  v_mfma_f32_16x16x32_bf16 v[40:43], a[72:75], a[60:63], v[40:43]
  ds_read_b64_tr_b16 a[28:29], v181 offset:64
  v_mfma_f32_16x16x32_bf16 v[44:47], a[76:79], a[60:63], v[44:47]
  ds_read_b64_tr_b16 a[30:31], v181 offset:1344
  buffer_load_dwordx4 a[208:211], v195, s[20:23], s82 offen offset:2048 sc1
  v_mfma_f32_16x16x32_bf16 v[48:51], a[80:83], a[60:63], v[48:51]
  ds_read_b128 a[8:11], v178 offset:4096
  v_mfma_f32_16x16x32_bf16 v[52:55], a[84:87], a[60:63], v[52:55]
  v_mfma_f32_16x16x32_bf16 v[56:59], a[88:91], a[60:63], v[56:59]
  ds_read_b128 a[12:15], v178 offset:6144
  buffer_load_dwordx4 a[212:215], v195, s[20:23], s82 offen offset:3072 sc1
  v_mfma_f32_16x16x32_bf16 v[60:63], a[92:95], a[60:63], v[60:63]
  ds_read_b64_tr_b16 a[32:33], v180 offset:128
  v_mfma_f32_16x16x32_bf16 v[64:67], a[96:99], a[60:63], v[64:67]
  ds_read_b64_tr_b16 a[34:35], v180 offset:1408
  v_mfma_f32_16x16x32_bf16 v[68:71], a[100:103], a[60:63], v[68:71]
  ds_read_b64_tr_b16 a[36:37], v181 offset:128
  s_addk_i32 s82, 0x1000
  buffer_load_dwordx4 a[216:219], v195, s[20:23], s82 offen offset:0 sc1
  v_mfma_f32_16x16x32_bf16 v[72:75], a[104:107], a[60:63], v[72:75]
  v_mfma_f32_16x16x32_bf16 v[76:79], a[108:111], a[60:63], v[76:79]
  ds_read_b64_tr_b16 a[38:39], v181 offset:1408
  v_mfma_f32_16x16x32_bf16 v[80:83], a[72:75], a[64:67], v[80:83]
  ds_read_b64_tr_b16 a[40:41], v180 offset:192
  v_mfma_f32_16x16x32_bf16 v[84:87], a[76:79], a[64:67], v[84:87]
  ds_read_b64_tr_b16 a[42:43], v180 offset:1472
  buffer_load_dwordx4 a[220:223], v195, s[20:23], s82 offen offset:1024 sc1
  v_mfma_f32_16x16x32_bf16 v[88:91], a[80:83], a[64:67], v[88:91]
  v_mfma_f32_16x16x32_bf16 v[92:95], a[84:87], a[64:67], v[92:95]
  ds_read_b64_tr_b16 a[44:45], v181 offset:192
  v_mfma_f32_16x16x32_bf16 v[96:99], a[88:91], a[64:67], v[96:99]
  ds_read_b64_tr_b16 a[46:47], v181 offset:1472
  buffer_load_dwordx4 a[224:227], v195, s[20:23], s82 offen offset:2048 sc1
  v_mfma_f32_16x16x32_bf16 v[100:103], a[92:95], a[64:67], v[100:103]
  ds_read_b64_tr_b16 a[48:49], v180 offset:256
  v_mfma_f32_16x16x32_bf16 v[104:107], a[96:99], a[64:67], v[104:107]
  ds_read_b64_tr_b16 a[50:51], v180 offset:1536
  v_mfma_f32_16x16x32_bf16 v[108:111], a[100:103], a[64:67], v[108:111]
  buffer_load_dwordx4 a[228:231], v195, s[20:23], s82 offen offset:3072 sc1
  v_mfma_f32_16x16x32_bf16 v[112:115], a[104:107], a[64:67], v[112:115]
  ds_read_b64_tr_b16 a[52:53], v181 offset:256
  v_mfma_f32_16x16x32_bf16 v[116:119], a[108:111], a[64:67], v[116:119]
  ds_read_b64_tr_b16 a[54:55], v181 offset:1536
  v_mfma_f32_16x16x32_bf16 v[120:123], a[72:75], a[68:71], v[120:123]
  ds_read_b128 a[112:115], v184 offset:0
  v_mfma_f32_16x16x32_bf16 v[124:127], a[76:79], a[68:71], v[124:127]
  s_addk_i32 s82, 0x1000
  buffer_load_dwordx4 a[232:235], v195, s[20:23], s82 offen offset:0 sc1
  v_mfma_f32_16x16x32_bf16 v[128:131], a[80:83], a[68:71], v[128:131]
  v_mfma_f32_16x16x32_bf16 v[132:135], a[84:87], a[68:71], v[132:135]
  v_mfma_f32_16x16x32_bf16 v[136:139], a[88:91], a[68:71], v[136:139]
  buffer_load_dwordx4 a[236:239], v195, s[20:23], s82 offen offset:1024 sc1
  v_mfma_f32_16x16x32_bf16 v[140:143], a[92:95], a[68:71], v[140:143]
  v_mfma_f32_16x16x32_bf16 v[144:147], a[96:99], a[68:71], v[144:147]
  v_mfma_f32_16x16x32_bf16 v[148:151], a[100:103], a[68:71], v[148:151]
  v_mfma_f32_16x16x32_bf16 v[152:155], a[104:107], a[68:71], v[152:155]
  s_addk_i32 s82, 0x800
  v_mfma_f32_16x16x32_bf16 v[156:159], a[108:111], a[68:71], v[156:159]
  v_mfma_f32_16x16x32_bf16 v[160:163], a[116:119], a[56:59], v[160:163]
  s_waitcnt lgkmcnt(0)
  v_mfma_f32_16x16x32_bf16 v[0:3], a[16:19], a[0:3], v[0:3]
  ds_read_b128 a[56:59], v179 offset:0
  ds_read_b64_tr_b16 a[72:73], v180 offset:10240
  s_mov_b32 s70, 1069066811
  s_mov_b32 s71, 1069066811
  v_mfma_f32_16x16x32_bf16 v[4:7], a[20:23], a[0:3], v[4:7]
  ds_read_b64_tr_b16 a[74:75], v180 offset:11520
  v_mov_b32 v238, 3216550471
  v_mov_b32 v239, 3216550471
  v_mfma_f32_16x16x32_bf16 v[8:11], a[24:27], a[0:3], v[8:11]
  ds_read_b64_tr_b16 a[76:77], v181 offset:10240
  ds_read_b64_tr_b16 a[78:79], v181 offset:11520
  s_mov_b32 s74, 897988541
  s_mov_b32 s75, 897988541
  v_mfma_f32_16x16x32_bf16 v[12:15], a[28:31], a[0:3], v[12:15]
  ds_read_b128 a[60:63], v179 offset:2048
  s_lshl_b32 s53, s6, 2
  s_add_u32 s53, s53, s42
  v_mfma_f32_16x16x32_bf16 v[16:19], a[32:35], a[0:3], v[16:19]
  ds_read_b64_tr_b16 a[80:81], v180 offset:10304
  ds_read_b64_tr_b16 a[82:83], v180 offset:11584
  s_mul_i32 s54, s53, 20
  s_mul_i32 s55, s3, 5
  v_mfma_f32_16x16x32_bf16 v[20:23], a[36:39], a[0:3], v[20:23]
  ds_read_b64_tr_b16 a[84:85], v181 offset:10304
  s_add_u32 s54, s54, s55
  s_lshl_b32 s84, s54, 12
  v_mfma_f32_16x16x32_bf16 v[24:27], a[40:43], a[0:3], v[24:27]
  ds_read_b64_tr_b16 a[86:87], v181 offset:11584
  ds_read_b128 a[64:67], v179 offset:4096
  s_add_u32 s84, s84, 16777216
  s_add_u32 s85, s84, 4096
  v_mfma_f32_16x16x32_bf16 v[28:31], a[44:47], a[0:3], v[28:31]
  ds_read_b128 a[68:71], v179 offset:6144
  s_add_u32 s86, s84, 8192
  s_add_u32 s87, s84, 12288
  v_mfma_f32_16x16x32_bf16 v[32:35], a[48:51], a[0:3], v[32:35]
  ds_read_b64_tr_b16 a[88:89], v180 offset:10368
  ds_read_b64_tr_b16 a[90:91], v180 offset:11648
  s_add_u32 s88, s84, 16384
  s_lshl_b32 s54, s53, 2
  v_mfma_f32_16x16x32_bf16 v[36:39], a[52:55], a[0:3], v[36:39]
  ds_read_b64_tr_b16 a[92:93], v181 offset:10368
  s_add_u32 s54, s54, s3
  s_lshl_b32 s54, s54, 6
  v_mfma_f32_16x16x32_bf16 v[160:163], a[112:115], a[0:3], v[160:163]
  ds_read_b64_tr_b16 a[94:95], v181 offset:11648
  ds_read_b64_tr_b16 a[96:97], v180 offset:10432
  s_add_u32 s54, s54, 14680064
  v_mfma_f32_16x16x32_bf16 v[40:43], a[16:19], a[4:7], v[40:43]
  ds_read_b64_tr_b16 a[98:99], v180 offset:11712
  v_mfma_f32_16x16x32_bf16 v[44:47], a[20:23], a[4:7], v[44:47]
  ds_read_b64_tr_b16 a[100:101], v181 offset:10432
  ds_read_b64_tr_b16 a[102:103], v181 offset:11712
  v_mfma_f32_16x16x32_bf16 v[48:51], a[24:27], a[4:7], v[48:51]
  ds_read_b64_tr_b16 a[104:105], v180 offset:10496
  v_mfma_f32_16x16x32_bf16 v[52:55], a[28:31], a[4:7], v[52:55]
  ds_read_b64_tr_b16 a[106:107], v180 offset:11776
  ds_read_b64_tr_b16 a[108:109], v181 offset:10496
  v_mfma_f32_16x16x32_bf16 v[56:59], a[32:35], a[4:7], v[56:59]
  ds_read_b64_tr_b16 a[110:111], v181 offset:11776
  v_mfma_f32_16x16x32_bf16 v[60:63], a[36:39], a[4:7], v[60:63]
  ds_read_b128 a[116:119], v184 offset:64
  v_mfma_f32_16x16x32_bf16 v[64:67], a[40:43], a[4:7], v[64:67]
  v_mfma_f32_16x16x32_bf16 v[68:71], a[44:47], a[4:7], v[68:71]
  v_mfma_f32_16x16x32_bf16 v[72:75], a[48:51], a[4:7], v[72:75]
  v_mfma_f32_16x16x32_bf16 v[76:79], a[52:55], a[4:7], v[76:79]
  s_waitcnt lgkmcnt(0)
  s_barrier
  v_mfma_f32_16x16x32_bf16 v[0:3], a[72:75], a[56:59], v[0:3]
  v_mfma_f32_16x16x32_bf16 v[4:7], a[76:79], a[56:59], v[4:7]
  v_mfma_f32_16x16x32_bf16 v[8:11], a[80:83], a[56:59], v[8:11]
  v_mfma_f32_16x16x32_bf16 v[12:15], a[84:87], a[56:59], v[12:15]
  v_mfma_f32_16x16x32_bf16 v[16:19], a[88:91], a[56:59], v[16:19]
  v_mfma_f32_16x16x32_bf16 v[20:23], a[92:95], a[56:59], v[20:23]
  v_mfma_f32_16x16x32_bf16 v[24:27], a[96:99], a[56:59], v[24:27]
  v_mfma_f32_16x16x32_bf16 v[28:31], a[100:103], a[56:59], v[28:31]
  v_mfma_f32_16x16x32_bf16 v[32:35], a[104:107], a[56:59], v[32:35]
  v_mfma_f32_16x16x32_bf16 v[36:39], a[108:111], a[56:59], v[36:39]
  v_mfma_f32_16x16x32_bf16 v[160:163], a[116:119], a[56:59], v[160:163]
  v_mfma_f32_16x16x32_bf16 v[40:43], a[72:75], a[60:63], v[40:43]
  v_mfma_f32_16x16x32_bf16 v[44:47], a[76:79], a[60:63], v[44:47]
  s_nop 5
  v_mul_f32 v200, 3216550459, v160
  v_mfma_f32_16x16x32_bf16 v[48:51], a[80:83], a[60:63], v[48:51]
  v_exp_f32 v200, v200
  v_mfma_f32_16x16x32_bf16 v[52:55], a[84:87], a[60:63], v[52:55]
  v_add_f32 v200, 1.0, v200
  v_mfma_f32_16x16x32_bf16 v[56:59], a[88:91], a[60:63], v[56:59]
  v_rcp_f32 v200, v200
  v_mfma_f32_16x16x32_bf16 v[60:63], a[92:95], a[60:63], v[60:63]
  buffer_store_dword v200, v189, s[20:23], s54 offen sc1
  v_cvt_pk_bf16_f32 v208, v0, v1
  v_mfma_f32_16x16x32_bf16 v[64:67], a[96:99], a[60:63], v[64:67]
  v_cvt_pk_bf16_f32 v209, v2, v3
  v_cvt_pk_bf16_f32 v210, v4, v5
  v_mfma_f32_16x16x32_bf16 v[68:71], a[100:103], a[60:63], v[68:71]
  v_cvt_pk_bf16_f32 v211, v6, v7
  buffer_store_dwordx4 v[208:211], v185, s[20:23], s84 offen sc1
  v_mfma_f32_16x16x32_bf16 v[72:75], a[104:107], a[60:63], v[72:75]
  v_cvt_pk_bf16_f32 v212, v8, v9
  v_cvt_pk_bf16_f32 v213, v10, v11
  v_mfma_f32_16x16x32_bf16 v[76:79], a[108:111], a[60:63], v[76:79]
  v_cvt_pk_bf16_f32 v214, v12, v13
  v_cvt_pk_bf16_f32 v215, v14, v15
  v_mfma_f32_16x16x32_bf16 v[80:83], a[16:19], a[8:11], v[80:83]
  buffer_store_dwordx4 v[212:215], v185, s[20:23], s85 offen sc1
  v_cvt_pk_bf16_f32 v216, v16, v17
  v_mfma_f32_16x16x32_bf16 v[84:87], a[20:23], a[8:11], v[84:87]
  v_cvt_pk_bf16_f32 v217, v18, v19
  v_cvt_pk_bf16_f32 v218, v20, v21
  v_mfma_f32_16x16x32_bf16 v[88:91], a[24:27], a[8:11], v[88:91]
  v_cvt_pk_bf16_f32 v219, v22, v23
  buffer_store_dwordx4 v[216:219], v185, s[20:23], s86 offen sc1
  v_mfma_f32_16x16x32_bf16 v[92:95], a[28:31], a[8:11], v[92:95]
  v_cvt_pk_bf16_f32 v220, v24, v25
  v_cvt_pk_bf16_f32 v221, v26, v27
  v_mfma_f32_16x16x32_bf16 v[96:99], a[32:35], a[8:11], v[96:99]
  v_cvt_pk_bf16_f32 v222, v28, v29
  v_cvt_pk_bf16_f32 v223, v30, v31
  v_mfma_f32_16x16x32_bf16 v[100:103], a[36:39], a[8:11], v[100:103]
  buffer_store_dwordx4 v[220:223], v185, s[20:23], s87 offen sc1
  v_cvt_pk_bf16_f32 v224, v32, v33
  v_mfma_f32_16x16x32_bf16 v[104:107], a[40:43], a[8:11], v[104:107]
  v_cvt_pk_bf16_f32 v225, v34, v35
  v_cvt_pk_bf16_f32 v226, v36, v37
  v_mfma_f32_16x16x32_bf16 v[108:111], a[44:47], a[8:11], v[108:111]
  v_cvt_pk_bf16_f32 v227, v38, v39
  buffer_store_dwordx4 v[224:227], v185, s[20:23], s88 offen sc1
  v_mfma_f32_16x16x32_bf16 v[112:115], a[48:51], a[8:11], v[112:115]
  v_cvt_pk_bf16_f32 v228, v40, v41
  v_cvt_pk_bf16_f32 v229, v42, v43
  v_mfma_f32_16x16x32_bf16 v[116:119], a[52:55], a[8:11], v[116:119]
  v_cvt_pk_bf16_f32 v230, v44, v45
  v_cvt_pk_bf16_f32 v231, v46, v47
  v_mfma_f32_16x16x32_bf16 v[80:83], a[72:75], a[64:67], v[80:83]
  buffer_store_dwordx4 v[228:231], v186, s[20:23], s84 offen sc1
  v_cvt_pk_bf16_f32 v208, v48, v49
  v_mfma_f32_16x16x32_bf16 v[84:87], a[76:79], a[64:67], v[84:87]
  v_cvt_pk_bf16_f32 v209, v50, v51
  v_cvt_pk_bf16_f32 v210, v52, v53
  v_mfma_f32_16x16x32_bf16 v[88:91], a[80:83], a[64:67], v[88:91]
  v_cvt_pk_bf16_f32 v211, v54, v55
  buffer_store_dwordx4 v[208:211], v186, s[20:23], s85 offen sc1
  v_mfma_f32_16x16x32_bf16 v[92:95], a[84:87], a[64:67], v[92:95]
  v_cvt_pk_bf16_f32 v212, v56, v57
  v_cvt_pk_bf16_f32 v213, v58, v59
  v_mfma_f32_16x16x32_bf16 v[96:99], a[88:91], a[64:67], v[96:99]
  v_cvt_pk_bf16_f32 v214, v60, v61
  v_cvt_pk_bf16_f32 v215, v62, v63
  v_mfma_f32_16x16x32_bf16 v[100:103], a[92:95], a[64:67], v[100:103]
  buffer_store_dwordx4 v[212:215], v186, s[20:23], s86 offen sc1
  v_cvt_pk_bf16_f32 v216, v64, v65
  v_mfma_f32_16x16x32_bf16 v[104:107], a[96:99], a[64:67], v[104:107]
  v_cvt_pk_bf16_f32 v217, v66, v67
  v_cvt_pk_bf16_f32 v218, v68, v69
  v_mfma_f32_16x16x32_bf16 v[108:111], a[100:103], a[64:67], v[108:111]
  v_cvt_pk_bf16_f32 v219, v70, v71
  buffer_store_dwordx4 v[216:219], v186, s[20:23], s87 offen sc1
  v_mfma_f32_16x16x32_bf16 v[112:115], a[104:107], a[64:67], v[112:115]
  v_cvt_pk_bf16_f32 v220, v72, v73
  v_cvt_pk_bf16_f32 v221, v74, v75
  v_mfma_f32_16x16x32_bf16 v[116:119], a[108:111], a[64:67], v[116:119]
  v_cvt_pk_bf16_f32 v222, v76, v77
  v_cvt_pk_bf16_f32 v223, v78, v79
  v_mfma_f32_16x16x32_bf16 v[120:123], a[16:19], a[12:15], v[120:123]
  buffer_store_dwordx4 v[220:223], v186, s[20:23], s88 offen sc1
  v_mfma_f32_16x16x32_bf16 v[124:127], a[20:23], a[12:15], v[124:127]
  v_cvt_pk_bf16_f32 v224, v80, v81
  v_cvt_pk_bf16_f32 v225, v82, v83
  v_mfma_f32_16x16x32_bf16 v[128:131], a[24:27], a[12:15], v[128:131]
  v_cvt_pk_bf16_f32 v226, v84, v85
  v_cvt_pk_bf16_f32 v227, v86, v87
  v_mfma_f32_16x16x32_bf16 v[132:135], a[28:31], a[12:15], v[132:135]
  buffer_store_dwordx4 v[224:227], v187, s[20:23], s84 offen sc1
  v_cvt_pk_bf16_f32 v228, v88, v89
  v_mfma_f32_16x16x32_bf16 v[136:139], a[32:35], a[12:15], v[136:139]
  v_cvt_pk_bf16_f32 v229, v90, v91
  v_cvt_pk_bf16_f32 v230, v92, v93
  v_mfma_f32_16x16x32_bf16 v[140:143], a[36:39], a[12:15], v[140:143]
  v_cvt_pk_bf16_f32 v231, v94, v95
  buffer_store_dwordx4 v[228:231], v187, s[20:23], s85 offen sc1
  v_mfma_f32_16x16x32_bf16 v[144:147], a[40:43], a[12:15], v[144:147]
  v_cvt_pk_bf16_f32 v208, v96, v97
  v_cvt_pk_bf16_f32 v209, v98, v99
  v_mfma_f32_16x16x32_bf16 v[148:151], a[44:47], a[12:15], v[148:151]
  v_cvt_pk_bf16_f32 v210, v100, v101
  v_cvt_pk_bf16_f32 v211, v102, v103
  v_mfma_f32_16x16x32_bf16 v[152:155], a[48:51], a[12:15], v[152:155]
  buffer_store_dwordx4 v[208:211], v187, s[20:23], s86 offen sc1
  v_cvt_pk_bf16_f32 v212, v104, v105
  v_mfma_f32_16x16x32_bf16 v[156:159], a[52:55], a[12:15], v[156:159]
  v_cvt_pk_bf16_f32 v213, v106, v107
  v_cvt_pk_bf16_f32 v214, v108, v109
  v_mfma_f32_16x16x32_bf16 v[120:123], a[72:75], a[68:71], v[120:123]
  v_cvt_pk_bf16_f32 v215, v110, v111
  buffer_store_dwordx4 v[212:215], v187, s[20:23], s87 offen sc1
  v_mfma_f32_16x16x32_bf16 v[124:127], a[76:79], a[68:71], v[124:127]
  v_cvt_pk_bf16_f32 v216, v112, v113
  v_cvt_pk_bf16_f32 v217, v114, v115
  v_mfma_f32_16x16x32_bf16 v[128:131], a[80:83], a[68:71], v[128:131]
  v_cvt_pk_bf16_f32 v218, v116, v117
  v_cvt_pk_bf16_f32 v219, v118, v119
  v_mfma_f32_16x16x32_bf16 v[132:135], a[84:87], a[68:71], v[132:135]
  buffer_store_dwordx4 v[216:219], v187, s[20:23], s88 offen sc1
  v_mfma_f32_16x16x32_bf16 v[136:139], a[88:91], a[68:71], v[136:139]
  v_mfma_f32_16x16x32_bf16 v[140:143], a[92:95], a[68:71], v[140:143]
  v_mfma_f32_16x16x32_bf16 v[144:147], a[96:99], a[68:71], v[144:147]
  v_mfma_f32_16x16x32_bf16 v[148:151], a[100:103], a[68:71], v[148:151]
  v_mfma_f32_16x16x32_bf16 v[152:155], a[104:107], a[68:71], v[152:155]
  v_mfma_f32_16x16x32_bf16 v[156:159], a[108:111], a[68:71], v[156:159]
  v_cvt_pk_bf16_f32 v220, v120, v121
  v_cvt_pk_bf16_f32 v221, v122, v123
  v_cvt_pk_bf16_f32 v222, v124, v125
  v_cvt_pk_bf16_f32 v223, v126, v127
  buffer_store_dwordx4 v[220:223], v188, s[20:23], s84 offen sc1
  v_cvt_pk_bf16_f32 v224, v128, v129
  v_cvt_pk_bf16_f32 v225, v130, v131
  v_cvt_pk_bf16_f32 v226, v132, v133
  v_cvt_pk_bf16_f32 v227, v134, v135
  buffer_store_dwordx4 v[224:227], v188, s[20:23], s85 offen sc1
  v_cvt_pk_bf16_f32 v228, v136, v137
  v_cvt_pk_bf16_f32 v229, v138, v139
  v_cvt_pk_bf16_f32 v230, v140, v141
  v_cvt_pk_bf16_f32 v231, v142, v143
  buffer_store_dwordx4 v[228:231], v188, s[20:23], s86 offen sc1
  v_cvt_pk_bf16_f32 v208, v144, v145
  v_cvt_pk_bf16_f32 v209, v146, v147
  v_cvt_pk_bf16_f32 v210, v148, v149
  v_cvt_pk_bf16_f32 v211, v150, v151
  buffer_store_dwordx4 v[208:211], v188, s[20:23], s87 offen sc1
  v_cvt_pk_bf16_f32 v212, v152, v153
  v_cvt_pk_bf16_f32 v213, v154, v155
  v_cvt_pk_bf16_f32 v214, v156, v157
  v_cvt_pk_bf16_f32 v215, v158, v159
  buffer_store_dwordx4 v[212:215], v188, s[20:23], s88 offen sc1
  s_waitcnt vmcnt(0)
  s_barrier
  s_cmp_lg_u32 s42, 0
  s_cbranch_scc1 L_q_sigd
  s_mov_b64 exec, 1
  buffer_store_dword v196, off, s[20:23], s83 sc1
  s_mov_b64 exec, -1
L_q_sigd:
  s_add_u32 s83, s83, 128
  s_mul_i32 m0, s42, 30720
  s_nop 0
  buffer_load_dwordx4 v195, s[20:23], s82 offen offset:0 sc1 lds
  buffer_load_dwordx4 v195, s[20:23], s82 offen offset:1024 sc1 lds
  buffer_load_dwordx4 v195, s[20:23], s82 offen offset:2048 sc1 lds
  buffer_load_dwordx4 v195, s[20:23], s82 offen offset:3072 sc1 lds
  s_addk_i32 m0, 0x1000
  s_addk_i32 s82, 0x1000
  s_nop 0
  buffer_load_dwordx4 v195, s[20:23], s82 offen offset:0 sc1 lds
  buffer_load_dwordx4 v195, s[20:23], s82 offen offset:1024 sc1 lds
  buffer_load_dwordx4 v195, s[20:23], s82 offen offset:2048 sc1 lds
  buffer_load_dwordx4 v195, s[20:23], s82 offen offset:3072 sc1 lds
  s_addk_i32 m0, 0x1000
  s_addk_i32 s82, 0x1000
  s_nop 0
  buffer_load_dwordx4 v195, s[20:23], s82 offen offset:0 sc1 lds
  buffer_load_dwordx4 v195, s[20:23], s82 offen offset:1024 sc1 lds
  buffer_load_dwordx4 v195, s[20:23], s82 offen offset:2048 sc1 lds
  buffer_load_dwordx4 v195, s[20:23], s82 offen offset:3072 sc1 lds
  s_addk_i32 m0, 0x1000
  s_addk_i32 s82, 0x1000
  s_nop 0
  buffer_load_dwordx4 v195, s[20:23], s82 offen offset:0 sc1 lds
  buffer_load_dwordx4 v195, s[20:23], s82 offen offset:1024 sc1 lds
  buffer_load_dwordx4 v195, s[20:23], s82 offen offset:2048 sc1 lds
  buffer_load_dwordx4 v195, s[20:23], s82 offen offset:3072 sc1 lds
  s_addk_i32 m0, 0x1000
  s_addk_i32 s82, 0x1000
  s_nop 0
  buffer_load_dwordx4 v195, s[20:23], s82 offen offset:0 sc1 lds
  buffer_load_dwordx4 v195, s[20:23], s82 offen offset:1024 sc1 lds
  buffer_load_dwordx4 v195, s[20:23], s82 offen offset:2048 sc1 lds
  buffer_load_dwordx4 v195, s[20:23], s82 offen offset:3072 sc1 lds
  s_addk_i32 m0, 0x1000
  s_addk_i32 s82, 0x1000
  s_nop 0
  buffer_load_dwordx4 v195, s[20:23], s82 offen offset:0 sc1 lds
  buffer_load_dwordx4 v195, s[20:23], s82 offen offset:1024 sc1 lds
  buffer_load_dwordx4 v195, s[20:23], s82 offen offset:2048 sc1 lds
  buffer_load_dwordx4 v195, s[20:23], s82 offen offset:3072 sc1 lds
  s_addk_i32 m0, 0x1000
  s_addk_i32 s82, 0x1000
  s_nop 0
  buffer_load_dwordx4 v195, s[20:23], s82 offen offset:0 sc1 lds
  buffer_load_dwordx4 v195, s[20:23], s82 offen offset:1024 sc1 lds
  buffer_load_dwordx4 v195, s[20:23], s82 offen offset:2048 sc1 lds
  buffer_load_dwordx4 v195, s[20:23], s82 offen offset:3072 sc1 lds
  s_addk_i32 m0, 0x1000
  s_addk_i32 s82, 0x1000
  s_nop 0
  buffer_load_dwordx4 v195, s[20:23], s82 offen offset:0 sc1 lds
  buffer_load_dwordx4 v195, s[20:23], s82 offen offset:1024 sc1 lds
  s_branch L_p2
L_kv2:
  s_lshr_b32 s56, s42, 1
  s_and_b32 s55, s42, 1
  s_lshl_b32 s53, s56, 14
  v_and_b32 v200, 15, v164
  v_lshrrev_b32 v201, 4, v164
  v_lshrrev_b32 v202, 1, v200
  v_xor_b32 v202, v202, v201
  v_lshlrev_b32 v203, 7, v200
  v_add_u32 v203, s53, v203
  v_lshl_add_u32 v178, v202, 4, v203
  v_xor_b32 v179, 64, v178
  v_lshrrev_b32 v208, 4, v164
  v_bfe_u32 v209, v164, 2, 2
  v_and_b32 v210, 3, v164
  v_lshl_add_u32 v211, v208, 3, v209
  v_and_b32 v200, 1, v208
  v_lshlrev_b32 v200, 1, v200
  v_lshrrev_b32 v201, 1, v210
  s_mul_i32 s53, s55, 10
  v_add_u32 v201, s53, v201
  v_mul_u32_u24 v202, 320, v211
  v_and_b32 v203, 1, v210
  v_lshl_add_u32 v202, v203, 3, v202
  v_add_u32 v202, 32768, v202
  v_add_u32 v203, 0, v201
  v_xor_b32 v203, v203, v200
  v_lshl_add_u32 v180, v203, 4, v202
  v_add_u32 v203, 2, v201
  v_xor_b32 v203, v203, v200
  v_lshl_add_u32 v181, v203, 4, v202
  v_and_b32 v200, 15, v164
  v_cmp_gt_u32 vcc, 8, v200
  s_nop 1
  v_cndmask_b32 v160, 0, 1.0, vcc
  v_mov_b32 v201, 0xff7fffff
  v_mov_b32 v202, 897988541
  v_cndmask_b32 v161, v201, v202, vcc
  v_mov_b32 v202, 1065353224
  v_cndmask_b32 v162, 0, v202, vcc
  v_mov_b32 v163, v162
  s_mov_b32 s70, 1065353224
  s_mov_b32 s71, 1065353224
  v_mov_b64 v[0:1], s[70:71]
  v_mov_b64 v[2:3], s[70:71]
  v_mov_b64 v[4:5], s[70:71]
  v_mov_b64 v[6:7], s[70:71]
  v_mov_b64 v[8:9], v[162:163]
  v_mov_b64 v[10:11], v[162:163]
  v_mov_b64 v[12:13], 0
  v_mov_b64 v[14:15], 0
  v_mov_b64 v[16:17], 0
  v_mov_b64 v[18:19], 0
  v_mov_b64 v[20:21], s[70:71]
  v_mov_b64 v[22:23], s[70:71]
  v_mov_b64 v[24:25], s[70:71]
  v_mov_b64 v[26:27], s[70:71]
  v_mov_b64 v[28:29], v[162:163]
  v_mov_b64 v[30:31], v[162:163]
  v_mov_b64 v[32:33], 0
  v_mov_b64 v[34:35], 0
  v_mov_b64 v[36:37], 0
  v_mov_b64 v[38:39], 0
  v_mov_b64 v[40:41], s[70:71]
  v_mov_b64 v[42:43], s[70:71]
  v_mov_b64 v[44:45], s[70:71]
  v_mov_b64 v[46:47], s[70:71]
  v_mov_b64 v[48:49], v[162:163]
  v_mov_b64 v[50:51], v[162:163]
  v_mov_b64 v[52:53], 0
  v_mov_b64 v[54:55], 0
  v_mov_b64 v[56:57], 0
  v_mov_b64 v[58:59], 0
  v_mov_b64 v[60:61], s[70:71]
  v_mov_b64 v[62:63], s[70:71]
  v_mov_b64 v[64:65], s[70:71]
  v_mov_b64 v[66:67], s[70:71]
  v_mov_b64 v[68:69], v[162:163]
  v_mov_b64 v[70:71], v[162:163]
  v_mov_b64 v[72:73], 0
  v_mov_b64 v[74:75], 0
  v_mov_b64 v[76:77], 0
  v_mov_b64 v[78:79], 0
  v_mov_b64 v[80:81], s[70:71]
  v_mov_b64 v[82:83], s[70:71]
  v_mov_b64 v[84:85], s[70:71]
  v_mov_b64 v[86:87], s[70:71]
  v_mov_b64 v[88:89], v[162:163]
  v_mov_b64 v[90:91], v[162:163]
  v_mov_b64 v[92:93], 0
  v_mov_b64 v[94:95], 0
  v_mov_b64 v[96:97], 0
  v_mov_b64 v[98:99], 0
  v_mov_b64 v[100:101], s[70:71]
  v_mov_b64 v[102:103], s[70:71]
  v_mov_b64 v[104:105], s[70:71]
  v_mov_b64 v[106:107], s[70:71]
  v_mov_b64 v[108:109], v[162:163]
  v_mov_b64 v[110:111], v[162:163]
  v_mov_b64 v[112:113], 0
  v_mov_b64 v[114:115], 0
  v_mov_b64 v[116:117], 0
  v_mov_b64 v[118:119], 0
  v_mov_b64 v[120:121], s[70:71]
  v_mov_b64 v[122:123], s[70:71]
  v_mov_b64 v[124:125], s[70:71]
  v_mov_b64 v[126:127], s[70:71]
  v_mov_b64 v[128:129], v[162:163]
  v_mov_b64 v[130:131], v[162:163]
  v_mov_b64 v[132:133], 0
  v_mov_b64 v[134:135], 0
  v_mov_b64 v[136:137], 0
  v_mov_b64 v[138:139], 0
  v_mov_b64 v[140:141], s[70:71]
  v_mov_b64 v[142:143], s[70:71]
  v_mov_b64 v[144:145], s[70:71]
  v_mov_b64 v[146:147], s[70:71]
  v_mov_b64 v[148:149], v[162:163]
  v_mov_b64 v[150:151], v[162:163]
  v_mov_b64 v[152:153], 0
  v_mov_b64 v[154:155], 0
  v_mov_b64 v[156:157], 0
  v_mov_b64 v[158:159], 0
  s_add_u32 s44, s44, 128
  s_add_u32 s45, s45, 245760
  s_cmp_eq_u32 s44, 1280
  s_cselect_b32 s44, 0, s44
  s_cselect_b32 s45, 0, s45
  s_mov_b32 s46, 53248
  s_add_u32 m0, s46, s50
  s_nop 0
  buffer_load_dwordx4 v165, s[8:11], s44 offen lds
  s_addk_i32 m0, 0x400
  s_nop 0
  buffer_load_dwordx4 v166, s[8:11], s44 offen lds
  s_addk_i32 m0, 0x400
  s_nop 0
  buffer_load_dwordx4 v167, s[8:11], s44 offen lds
  s_addk_i32 m0, 0x400
  s_nop 0
  buffer_load_dwordx4 v168, s[8:11], s44 offen lds
  s_addk_i32 m0, 0x400
  s_nop 0
  buffer_load_dwordx4 v169, s[8:11], s44 offen lds
  s_addk_i32 m0, 0x400
  s_nop 0
  buffer_load_dwordx4 v170, s[8:11], s44 offen lds
  s_addk_i32 m0, 0x400
  s_nop 0
  buffer_load_dwordx4 v171, s[8:11], s44 offen lds
  s_addk_i32 m0, 0x400
  s_nop 0
  buffer_load_dwordx4 v172, s[8:11], s44 offen lds
  s_add_u32 m0, s46, s51
  s_nop 0
  buffer_load_dwordx4 v173, s[12:15], s45 offen lds
  s_addk_i32 m0, 0x400
  s_nop 0
  buffer_load_dwordx4 v174, s[12:15], s45 offen lds
  s_addk_i32 m0, 0x400
  s_nop 0
  buffer_load_dwordx4 v175, s[12:15], s45 offen lds
  s_addk_i32 m0, 0x400
  s_nop 0
  buffer_load_dwordx4 v176, s[12:15], s45 offen lds
  s_addk_i32 m0, 0x400
  s_nop 0
  buffer_load_dwordx4 v177, s[12:15], s45 offen lds
  s_add_u32 s44, s44, 128
  s_add_u32 s45, s45, 245760
  s_cmp_eq_u32 s44, 1280
  s_cselect_b32 s44, 0, s44
  s_cselect_b32 s45, 0, s45
  s_mul_i32 s53, s56, 7680
  s_mul_i32 s54, s55, 3840
  s_add_u32 s53, s53, s54
  s_add_u32 s53, s53, 131072
  v_add_u32 v207, 146432, v195
  v_add_u32 v201, 0, v200
  v_mul_u32_u24 v202, 96, v201
  v_cmp_lt_u32 vcc, 19, v201
  s_nop 1
  v_cndmask_b32 v203, 0, 5, vcc
  v_add_u32 v204, 4294967294, v208
  v_sub_u32 v204, v204, v203
  v_lshl_add_u32 v202, v204, 4, v202
  v_cmp_gt_u32 vcc, 5, v204
  v_add_u32 v202, s53, v202
  s_nop 0
  v_cndmask_b32 v202, v207, v202, vcc
  v_cmp_gt_u32 vcc, 40, v201
  s_nop 1
  v_cndmask_b32 v185, v207, v202, vcc
  v_add_u32 v201, 0, v200
  v_mul_u32_u24 v202, 96, v201
  v_cmp_lt_u32 vcc, 19, v201
  s_nop 1
  v_cndmask_b32 v203, 0, 5, vcc
  v_add_u32 v204, 2, v208
  v_sub_u32 v204, v204, v203
  v_lshl_add_u32 v202, v204, 4, v202
  v_cmp_gt_u32 vcc, 5, v204
  v_add_u32 v202, s53, v202
  s_nop 0
  v_cndmask_b32 v202, v207, v202, vcc
  v_cmp_gt_u32 vcc, 40, v201
  s_nop 1
  v_cndmask_b32 v186, v207, v202, vcc
  v_add_u32 v201, 16, v200
  v_mul_u32_u24 v202, 96, v201
  v_cmp_lt_u32 vcc, 19, v201
  s_nop 1
  v_cndmask_b32 v203, 0, 5, vcc
  v_add_u32 v204, 4294967294, v208
  v_sub_u32 v204, v204, v203
  v_lshl_add_u32 v202, v204, 4, v202
  v_cmp_gt_u32 vcc, 5, v204
  v_add_u32 v202, s53, v202
  s_nop 0
  v_cndmask_b32 v202, v207, v202, vcc
  v_cmp_gt_u32 vcc, 40, v201
  s_nop 1
  v_cndmask_b32 v187, v207, v202, vcc
  v_add_u32 v201, 16, v200
  v_mul_u32_u24 v202, 96, v201
  v_cmp_lt_u32 vcc, 19, v201
  s_nop 1
  v_cndmask_b32 v203, 0, 5, vcc
  v_add_u32 v204, 2, v208
  v_sub_u32 v204, v204, v203
  v_lshl_add_u32 v202, v204, 4, v202
  v_cmp_gt_u32 vcc, 5, v204
  v_add_u32 v202, s53, v202
  s_nop 0
  v_cndmask_b32 v202, v207, v202, vcc
  v_cmp_gt_u32 vcc, 40, v201
  s_nop 1
  v_cndmask_b32 v188, v207, v202, vcc
  v_add_u32 v201, 16, v200
  v_mul_u32_u24 v202, 96, v201
  v_cmp_lt_u32 vcc, 19, v201
  s_nop 1
  v_cndmask_b32 v203, 0, 5, vcc
  v_add_u32 v204, 6, v208
  v_sub_u32 v204, v204, v203
  v_lshl_add_u32 v202, v204, 4, v202
  v_cmp_gt_u32 vcc, 5, v204
  v_add_u32 v202, s53, v202
  s_nop 0
  v_cndmask_b32 v202, v207, v202, vcc
  v_cmp_gt_u32 vcc, 40, v201
  s_nop 1
  v_cndmask_b32 v189, v207, v202, vcc
  v_add_u32 v201, 32, v200
  v_mul_u32_u24 v202, 96, v201
  v_cmp_lt_u32 vcc, 19, v201
  s_nop 1
  v_cndmask_b32 v203, 0, 5, vcc
  v_add_u32 v204, 2, v208
  v_sub_u32 v204, v204, v203
  v_lshl_add_u32 v202, v204, 4, v202
  v_cmp_gt_u32 vcc, 5, v204
  v_add_u32 v202, s53, v202
  s_nop 0
  v_cndmask_b32 v202, v207, v202, vcc
  v_cmp_gt_u32 vcc, 40, v201
  s_nop 1
  v_cndmask_b32 v190, v207, v202, vcc
  v_add_u32 v201, 32, v200
  v_mul_u32_u24 v202, 96, v201
  v_cmp_lt_u32 vcc, 19, v201
  s_nop 1
  v_cndmask_b32 v203, 0, 5, vcc
  v_add_u32 v204, 6, v208
  v_sub_u32 v204, v204, v203
  v_lshl_add_u32 v202, v204, 4, v202
  v_cmp_gt_u32 vcc, 5, v204
  v_add_u32 v202, s53, v202
  s_nop 0
  v_cndmask_b32 v202, v207, v202, vcc
  v_cmp_gt_u32 vcc, 40, v201
  s_nop 1
  v_cndmask_b32 v191, v207, v202, vcc
  v_add_u32 v201, 0, v200
  v_mul_u32_u24 v202, 96, v201
  v_add_u32 v202, 80, v202
  v_cmp_eq_u32 vcc, 0, v208
  v_add_u32 v202, s53, v202
  s_nop 0
  v_cndmask_b32 v202, v207, v202, vcc
  v_cmp_gt_u32 vcc, 40, v201
  s_nop 1
  v_cndmask_b32 v192, v207, v202, vcc
  v_add_u32 v201, 16, v200
  v_mul_u32_u24 v202, 96, v201
  v_add_u32 v202, 80, v202
  v_cmp_eq_u32 vcc, 0, v208
  v_add_u32 v202, s53, v202
  s_nop 0
  v_cndmask_b32 v202, v207, v202, vcc
  v_cmp_gt_u32 vcc, 40, v201
  s_nop 1
  v_cndmask_b32 v193, v207, v202, vcc
  v_add_u32 v201, 32, v200
  v_mul_u32_u24 v202, 96, v201
  v_add_u32 v202, 80, v202
  v_cmp_eq_u32 vcc, 0, v208
  v_add_u32 v202, s53, v202
  s_nop 0
  v_cndmask_b32 v202, v207, v202, vcc
  v_cmp_gt_u32 vcc, 40, v201
  s_nop 1
  v_cndmask_b32 v194, v207, v202, vcc
  v_mov_b32 v202, 2147418112
  v_add_u32 v203, 0, v164
  v_mul_u32_u24 v204, 43, v203
  v_lshrrev_b32 v204, 8, v204
  v_mul_u32_u24 v205, 6, v204
  v_sub_u32 v205, v203, v205
  v_lshlrev_b32 v204, 2, v204
  v_cmp_eq_u32 vcc, 5, v205
  s_nop 1
  v_cndmask_b32 v204, v202, v204, vcc
  v_cmp_gt_u32 vcc, 120, v203
  s_nop 1
  v_cndmask_b32 v248, v202, v204, vcc
  v_add_u32 v203, 64, v164
  v_mul_u32_u24 v204, 43, v203
  v_lshrrev_b32 v204, 8, v204
  v_mul_u32_u24 v205, 6, v204
  v_sub_u32 v205, v203, v205
  v_lshlrev_b32 v204, 2, v204
  v_cmp_eq_u32 vcc, 5, v205
  s_nop 1
  v_cndmask_b32 v204, v202, v204, vcc
  v_cmp_gt_u32 vcc, 120, v203
  s_nop 1
  v_cndmask_b32 v249, v202, v204, vcc
  v_cmp_eq_u32 vcc, 0, v200
  v_mov_b32 v201, 0x3f803f80
  s_nop 0
  v_cndmask_b32 v232, 0, v201, vcc
  v_cndmask_b32 v233, 0, v201, vcc
  v_cndmask_b32 v234, 0, v201, vcc
  v_cndmask_b32 v235, 0, v201, vcc
  s_bfe_u32 s53, s2, 0x20001
  s_lshr_b32 s54, s2, 5
  s_lshl_b32 s53, s53, 3
  s_add_u32 s80, s53, s54
  s_and_b32 s53, s2, 1
  s_lshl_b32 s53, s53, 2
  s_bfe_u32 s54, s2, 0x20003
  s_add_u32 s81, s53, s54
  s_mul_i32 s53, s81, 48
  s_mul_i32 s54, s42, 12
  s_add_u32 s53, s53, s54
  s_mul_i32 s53, s53, 5120
  s_add_u32 s82, s53, 9437184
  s_and_b32 s53, s48, 127
  s_lshl_b32 s53, s53, 1
  s_lshr_b32 s54, s42, 1
  s_add_u32 s53, s53, s54
  s_mul_i32 s53, s53, 5120
  s_add_u32 s49, s53, 12386304
  s_lshl_b32 s53, s7, 3
  s_add_u32 s53, s53, s6
  s_lshl_b32 s53, s53, 8
  s_add_u32 s83, s53, 14712832
  s_waitcnt vmcnt(13)
  s_barrier
  ds_read_b128 a[0:3], v178 offset:0
  ds_read_b64_tr_b16 a[32:33], v180 offset:0
  ds_read_b64_tr_b16 a[34:35], v180 offset:1280
  ds_read_b64_tr_b16 a[36:37], v181 offset:0
  ds_read_b64_tr_b16 a[38:39], v181 offset:1280
  ds_read_b128 a[4:7], v178 offset:2048
  ds_read_b64_tr_b16 a[40:41], v180 offset:64
  ds_read_b64_tr_b16 a[42:43], v180 offset:1344
  ds_read_b64_tr_b16 a[44:45], v181 offset:64
  ds_read_b64_tr_b16 a[46:47], v181 offset:1344
  ds_read_b128 a[8:11], v178 offset:4096
  ds_read_b128 a[12:15], v178 offset:6144
  ds_read_b128 a[16:19], v178 offset:8192
  ds_read_b128 a[20:23], v178 offset:10240
  ds_read_b128 a[24:27], v178 offset:12288
  ds_read_b128 a[28:31], v178 offset:14336
  ds_read_b64_tr_b16 a[48:49], v180 offset:128
  ds_read_b64_tr_b16 a[50:51], v180 offset:1408
  s_mov_b32 s46, 106496
  s_add_u32 m0, s46, s50
  s_nop 0
  buffer_load_dwordx4 v165, s[8:11], s44 offen lds
  s_addk_i32 m0, 0x400
  s_nop 0
  buffer_load_dwordx4 v166, s[8:11], s44 offen lds
  s_addk_i32 m0, 0x400
  s_nop 0
  buffer_load_dwordx4 v167, s[8:11], s44 offen lds
  s_addk_i32 m0, 0x400
  s_nop 0
  buffer_load_dwordx4 v168, s[8:11], s44 offen lds
  s_addk_i32 m0, 0x400
  s_nop 0
  buffer_load_dwordx4 v169, s[8:11], s44 offen lds
  s_addk_i32 m0, 0x400
  s_nop 0
  buffer_load_dwordx4 v170, s[8:11], s44 offen lds
  s_addk_i32 m0, 0x400
  s_nop 0
  buffer_load_dwordx4 v171, s[8:11], s44 offen lds
  s_cmp_eq_u32 s42, 0
  s_cselect_b32 s91, 18, 0
  s_cselect_b32 s92, 64, 0
  s_mov_b32 s43, -1
  s_mov_b32 s59, 53248
  s_mov_b32 s47, 4294860800
  s_waitcnt lgkmcnt(0)
  s_mul_i32 s100, s100, 0x9E3779B1
  s_add_u32 s100, s100, 0x7F4A7C15
  v_mov_b32 v196, s100
  s_and_b32 s93, s2, 31
  s_lshl_b32 s93, s93, 8
  s_lshr_b32 s53, s2, 5
  s_lshl_b32 s53, s53, 2
  s_add_u32 s93, s93, s53
  s_add_u32 s93, s93, 14696448
  v_lshrrev_b32 v198, 1, v164
  v_lshlrev_b32 v198, 8, v198
  v_and_b32 v243, 16, v195
  s_mov_b32 s53, 14696448
  v_add3_u32 v198, v198, v243, s53
  s_branch L_kv_mid
L_kv_evT:
  buffer_load_dwordx4 v[244:247], v198, s[20:23], 0 offen sc1
  s_branch L_kv_evT_ret
L_kv_evE:
  s_cmp_lg_u32 s43, 4
  s_cbranch_scc1 L_kv_evE4
  v_lshlrev_b32 v240, 7, v164
  s_mul_i32 s53, s2, 3200
  s_add_u32 s53, s53, 11403264
  s_mov_b64 exec, 0x1ffffff
  buffer_load_dword v241, v240, s[20:23], s53 offen sc1
  s_mul_i32 s53, s2, 640
  s_add_u32 s53, s53, 14680064
  s_mov_b64 exec, 0x1f
  buffer_load_dword v241, v240, s[20:23], s53 offen sc1
  s_mov_b64 exec, -1
  s_branch L_kv_evE_ret
L_kv_evE4:
  s_mov_b64 exec, 1
  buffer_store_dword v196, off, s[20:23], s93 sc1
  s_mov_b64 exec, -1
  s_branch L_kv_evE_ret
L_kv_A:
  s_waitcnt vmcnt(13) lgkmcnt(0)
  s_barrier
  v_add_u32 v178, s47, v178
  v_add_u32 v179, s47, v179
  v_add_u32 v180, s47, v180
  v_add_u32 v181, s47, v181
  s_bitcmp1_b32 s92, s43
  s_cbranch_scc1 L_kv_evT
L_kv_evT_ret:
  v_mfma_f32_16x16x32_bf16 v[0:3], a[56:59], a[88:91], v[0:3]
  ds_read_b128 a[0:3], v178 offset:0
  v_mfma_f32_16x16x32_bf16 v[4:7], a[56:59], a[92:95], v[4:7]
  ds_read_b64_tr_b16 a[32:33], v180 offset:0
  s_add_u32 m0, s46, s50
  v_mfma_f32_16x16x32_bf16 v[8:11], a[56:59], a[96:99], v[8:11]
  buffer_load_dwordx4 v165, s[8:11], s44 offen lds
  v_mfma_f32_16x16x32_bf16 v[12:15], a[56:59], a[100:103], v[12:15]
  ds_read_b64_tr_b16 a[34:35], v180 offset:1280
  v_mfma_f32_16x16x32_bf16 v[16:19], a[56:59], a[104:107], v[16:19]
  v_mfma_f32_16x16x32_bf16 v[20:23], a[60:63], a[88:91], v[20:23]
  ds_read_b64_tr_b16 a[36:37], v181 offset:0
  v_mfma_f32_16x16x32_bf16 v[24:27], a[60:63], a[92:95], v[24:27]
  v_mfma_f32_16x16x32_bf16 v[28:31], a[60:63], a[96:99], v[28:31]
  ds_read_b64_tr_b16 a[38:39], v181 offset:1280
  s_addk_i32 m0, 0x400
  v_mfma_f32_16x16x32_bf16 v[32:35], a[60:63], a[100:103], v[32:35]
  ds_read_b128 a[4:7], v178 offset:2048
  buffer_load_dwordx4 v166, s[8:11], s44 offen lds
  v_mfma_f32_16x16x32_bf16 v[36:39], a[60:63], a[104:107], v[36:39]
  v_mfma_f32_16x16x32_bf16 v[40:43], a[64:67], a[88:91], v[40:43]
  ds_read_b64_tr_b16 a[40:41], v180 offset:64
  v_mfma_f32_16x16x32_bf16 v[44:47], a[64:67], a[92:95], v[44:47]
  v_mfma_f32_16x16x32_bf16 v[48:51], a[64:67], a[96:99], v[48:51]
  ds_read_b64_tr_b16 a[42:43], v180 offset:1344
  v_mfma_f32_16x16x32_bf16 v[52:55], a[64:67], a[100:103], v[52:55]
  s_addk_i32 m0, 0x400
  v_mfma_f32_16x16x32_bf16 v[56:59], a[64:67], a[104:107], v[56:59]
  ds_read_b64_tr_b16 a[44:45], v181 offset:64
  buffer_load_dwordx4 v167, s[8:11], s44 offen lds
  v_mfma_f32_16x16x32_bf16 v[60:63], a[68:71], a[88:91], v[60:63]
  v_mfma_f32_16x16x32_bf16 v[64:67], a[68:71], a[92:95], v[64:67]
  ds_read_b64_tr_b16 a[46:47], v181 offset:1344
  v_mfma_f32_16x16x32_bf16 v[68:71], a[68:71], a[96:99], v[68:71]
  ds_read_b128 a[8:11], v178 offset:4096
  v_mfma_f32_16x16x32_bf16 v[72:75], a[68:71], a[100:103], v[72:75]
  v_mfma_f32_16x16x32_bf16 v[76:79], a[68:71], a[104:107], v[76:79]
  ds_read_b128 a[12:15], v178 offset:6144
  s_addk_i32 m0, 0x400
  v_mfma_f32_16x16x32_bf16 v[80:83], a[72:75], a[88:91], v[80:83]
  buffer_load_dwordx4 v168, s[8:11], s44 offen lds
  v_mfma_f32_16x16x32_bf16 v[84:87], a[72:75], a[92:95], v[84:87]
  ds_read_b128 a[16:19], v178 offset:8192
  v_mfma_f32_16x16x32_bf16 v[88:91], a[72:75], a[96:99], v[88:91]
  v_mfma_f32_16x16x32_bf16 v[92:95], a[72:75], a[100:103], v[92:95]
  ds_read_b128 a[20:23], v178 offset:10240
  v_mfma_f32_16x16x32_bf16 v[96:99], a[72:75], a[104:107], v[96:99]
  ds_read_b128 a[24:27], v178 offset:12288
  v_mfma_f32_16x16x32_bf16 v[100:103], a[76:79], a[88:91], v[100:103]
  s_addk_i32 m0, 0x400
  v_mfma_f32_16x16x32_bf16 v[104:107], a[76:79], a[92:95], v[104:107]
  ds_read_b128 a[28:31], v178 offset:14336
  buffer_load_dwordx4 v169, s[8:11], s44 offen lds
  v_mfma_f32_16x16x32_bf16 v[108:111], a[76:79], a[96:99], v[108:111]
  v_mfma_f32_16x16x32_bf16 v[112:115], a[76:79], a[100:103], v[112:115]
  ds_read_b64_tr_b16 a[48:49], v180 offset:128
  v_mfma_f32_16x16x32_bf16 v[116:119], a[76:79], a[104:107], v[116:119]
  v_mfma_f32_16x16x32_bf16 v[120:123], a[80:83], a[88:91], v[120:123]
  ds_read_b64_tr_b16 a[50:51], v180 offset:1408
  v_mfma_f32_16x16x32_bf16 v[124:127], a[80:83], a[92:95], v[124:127]
  s_addk_i32 m0, 0x400
  v_mfma_f32_16x16x32_bf16 v[128:131], a[80:83], a[96:99], v[128:131]
  buffer_load_dwordx4 v170, s[8:11], s44 offen lds
  v_mfma_f32_16x16x32_bf16 v[132:135], a[80:83], a[100:103], v[132:135]
  v_mfma_f32_16x16x32_bf16 v[136:139], a[80:83], a[104:107], v[136:139]
  v_mfma_f32_16x16x32_bf16 v[140:143], a[84:87], a[88:91], v[140:143]
  v_mfma_f32_16x16x32_bf16 v[144:147], a[84:87], a[92:95], v[144:147]
  v_mfma_f32_16x16x32_bf16 v[148:151], a[84:87], a[96:99], v[148:151]
  s_addk_i32 m0, 0x400
  v_mfma_f32_16x16x32_bf16 v[152:155], a[84:87], a[100:103], v[152:155]
  buffer_load_dwordx4 v171, s[8:11], s44 offen lds
  v_mfma_f32_16x16x32_bf16 v[156:159], a[84:87], a[104:107], v[156:159]
L_kv_mid:
  s_waitcnt lgkmcnt(0)
  v_mfma_f32_16x16x32_bf16 v[0:3], a[0:3], a[32:35], v[0:3]
  ds_read_b128 a[56:59], v179 offset:0
  v_mfma_f32_16x16x32_bf16 v[4:7], a[0:3], a[36:39], v[4:7]
  ds_read_b64_tr_b16 a[88:89], v180 offset:10240
  v_mfma_f32_16x16x32_bf16 v[8:11], a[0:3], a[40:43], v[8:11]
  s_addk_i32 m0, 0x400
  v_mfma_f32_16x16x32_bf16 v[12:15], a[0:3], a[44:47], v[12:15]
  ds_read_b64_tr_b16 a[90:91], v180 offset:11520
  buffer_load_dwordx4 v172, s[8:11], s44 offen lds
  v_mfma_f32_16x16x32_bf16 v[16:19], a[0:3], a[48:51], v[16:19]
  v_mfma_f32_16x16x32_bf16 v[20:23], a[4:7], a[32:35], v[20:23]
  ds_read_b64_tr_b16 a[92:93], v181 offset:10240
  v_mfma_f32_16x16x32_bf16 v[24:27], a[4:7], a[36:39], v[24:27]
  v_mfma_f32_16x16x32_bf16 v[28:31], a[4:7], a[40:43], v[28:31]
  ds_read_b64_tr_b16 a[94:95], v181 offset:11520
  v_mfma_f32_16x16x32_bf16 v[32:35], a[4:7], a[44:47], v[32:35]
  ds_read_b128 a[60:63], v179 offset:2048
  s_add_u32 m0, s46, s51
  v_mfma_f32_16x16x32_bf16 v[36:39], a[4:7], a[48:51], v[36:39]
  buffer_load_dwordx4 v173, s[12:15], s45 offen lds
  v_mfma_f32_16x16x32_bf16 v[40:43], a[8:11], a[32:35], v[40:43]
  ds_read_b64_tr_b16 a[96:97], v180 offset:10304
  v_mfma_f32_16x16x32_bf16 v[44:47], a[8:11], a[36:39], v[44:47]
  v_mfma_f32_16x16x32_bf16 v[48:51], a[8:11], a[40:43], v[48:51]
  ds_read_b64_tr_b16 a[98:99], v180 offset:11584
  v_mfma_f32_16x16x32_bf16 v[52:55], a[8:11], a[44:47], v[52:55]
  v_mfma_f32_16x16x32_bf16 v[56:59], a[8:11], a[48:51], v[56:59]
  ds_read_b64_tr_b16 a[100:101], v181 offset:10304
  s_addk_i32 m0, 0x400
  v_mfma_f32_16x16x32_bf16 v[60:63], a[12:15], a[32:35], v[60:63]
  buffer_load_dwordx4 v174, s[12:15], s45 offen lds
  v_mfma_f32_16x16x32_bf16 v[64:67], a[12:15], a[36:39], v[64:67]
  ds_read_b64_tr_b16 a[102:103], v181 offset:11584
  v_mfma_f32_16x16x32_bf16 v[68:71], a[12:15], a[40:43], v[68:71]
  ds_read_b128 a[64:67], v179 offset:4096
  v_mfma_f32_16x16x32_bf16 v[72:75], a[12:15], a[44:47], v[72:75]
  v_mfma_f32_16x16x32_bf16 v[76:79], a[12:15], a[48:51], v[76:79]
  ds_read_b128 a[68:71], v179 offset:6144
  v_mfma_f32_16x16x32_bf16 v[80:83], a[16:19], a[32:35], v[80:83]
  s_addk_i32 m0, 0x400
  v_mfma_f32_16x16x32_bf16 v[84:87], a[16:19], a[36:39], v[84:87]
  ds_read_b128 a[72:75], v179 offset:8192
  buffer_load_dwordx4 v175, s[12:15], s45 offen lds
  v_mfma_f32_16x16x32_bf16 v[88:91], a[16:19], a[40:43], v[88:91]
  v_mfma_f32_16x16x32_bf16 v[92:95], a[16:19], a[44:47], v[92:95]
  ds_read_b128 a[76:79], v179 offset:10240
  v_mfma_f32_16x16x32_bf16 v[96:99], a[16:19], a[48:51], v[96:99]
  ds_read_b128 a[80:83], v179 offset:12288
  v_mfma_f32_16x16x32_bf16 v[100:103], a[20:23], a[32:35], v[100:103]
  v_mfma_f32_16x16x32_bf16 v[104:107], a[20:23], a[36:39], v[104:107]
  ds_read_b128 a[84:87], v179 offset:14336
  s_addk_i32 m0, 0x400
  v_mfma_f32_16x16x32_bf16 v[108:111], a[20:23], a[40:43], v[108:111]
  buffer_load_dwordx4 v176, s[12:15], s45 offen lds
  v_mfma_f32_16x16x32_bf16 v[112:115], a[20:23], a[44:47], v[112:115]
  ds_read_b64_tr_b16 a[104:105], v180 offset:10368
  v_mfma_f32_16x16x32_bf16 v[116:119], a[20:23], a[48:51], v[116:119]
  v_mfma_f32_16x16x32_bf16 v[120:123], a[24:27], a[32:35], v[120:123]
  ds_read_b64_tr_b16 a[106:107], v180 offset:11648
  v_mfma_f32_16x16x32_bf16 v[124:127], a[24:27], a[36:39], v[124:127]
  v_mfma_f32_16x16x32_bf16 v[128:131], a[24:27], a[40:43], v[128:131]
  s_addk_i32 m0, 0x400
  v_mfma_f32_16x16x32_bf16 v[132:135], a[24:27], a[44:47], v[132:135]
  buffer_load_dwordx4 v177, s[12:15], s45 offen lds
  v_mfma_f32_16x16x32_bf16 v[136:139], a[24:27], a[48:51], v[136:139]
  s_add_u32 s44, s44, 128
  s_add_u32 s45, s45, 245760
  s_cmp_eq_u32 s44, 1280
  s_cselect_b32 s44, 0, s44
  s_cselect_b32 s45, 0, s45
  v_mfma_f32_16x16x32_bf16 v[140:143], a[28:31], a[32:35], v[140:143]
  s_add_u32 s46, s46, s47
  s_add_u32 s43, s43, 1
  v_mfma_f32_16x16x32_bf16 v[144:147], a[28:31], a[36:39], v[144:147]
  s_cmp_eq_u32 s46, 106496
  s_cselect_b32 s47, 4294860800, s59
  v_mfma_f32_16x16x32_bf16 v[148:151], a[28:31], a[40:43], v[148:151]
  v_mfma_f32_16x16x32_bf16 v[152:155], a[28:31], a[44:47], v[152:155]
  s_bitcmp1_b32 s91, s43
  v_mfma_f32_16x16x32_bf16 v[156:159], a[28:31], a[48:51], v[156:159]
  s_cbranch_scc1 L_kv_evE
L_kv_evE_ret:
  s_cmp_lt_u32 s43, 7
  s_cbranch_scc1 L_kv_A
  s_waitcnt vmcnt(13) lgkmcnt(0)
  s_cmp_lg_u32 s42, 0
  s_cbranch_scc1 L_kvfw_done
  s_mov_b32 s57, 0
L_kvfw_poll:
  v_cmp_eq_u32 vcc, s100, v244
  v_cmp_eq_u32 s[76:77], s100, v245
  s_nop 0
  s_and_b64 vcc, vcc, s[76:77]
  v_cmp_eq_u32 s[76:77], s100, v246
  s_nop 0
  s_and_b64 vcc, vcc, s[76:77]
  v_cmp_eq_u32 s[76:77], s100, v247
  s_nop 0
  s_and_b64 vcc, vcc, s[76:77]
  s_cmp_eq_u64 vcc, -1
  s_cbranch_scc1 L_kvfw_ok
  s_add_u32 s57, s57, 1
  s_cmp_gt_u32 s57, 131072
  s_cbranch_scc1 L_kvfw_ok
  s_sleep 8
  buffer_load_dwordx4 v[244:247], v198, s[20:23], 0 offen sc1
  s_waitcnt vmcnt(0)
  s_branch L_kvfw_poll
L_kvfw_ok:
  s_cmp_lg_u32 s2, 0
  s_cbranch_scc1 L_kvfw_done
  s_mov_b32 s53, 14688256
  s_mov_b64 exec, 1
  buffer_store_dword v196, off, s[20:23], s53 sc1
  s_mov_b64 exec, -1
L_kvfw_done:
  s_barrier
  v_add_u32 v178, 53248, v178
  v_add_u32 v179, 53248, v179
  v_add_u32 v180, 53248, v180
  v_add_u32 v181, 53248, v181
  v_mfma_f32_16x16x32_bf16 v[0:3], a[56:59], a[88:91], v[0:3]
  ds_read_b128 a[0:3], v178 offset:0
  v_mfma_f32_16x16x32_bf16 v[4:7], a[56:59], a[92:95], v[4:7]
  ds_read_b64_tr_b16 a[32:33], v180 offset:0
  buffer_load_dwordx4 a[120:123], v195, s[20:23], s82 offen offset:0 sc1
  v_mfma_f32_16x16x32_bf16 v[8:11], a[56:59], a[96:99], v[8:11]
  v_mfma_f32_16x16x32_bf16 v[12:15], a[56:59], a[100:103], v[12:15]
  ds_read_b64_tr_b16 a[34:35], v180 offset:1280
  v_mfma_f32_16x16x32_bf16 v[16:19], a[56:59], a[104:107], v[16:19]
  v_mfma_f32_16x16x32_bf16 v[20:23], a[60:63], a[88:91], v[20:23]
  ds_read_b64_tr_b16 a[36:37], v181 offset:0
  buffer_load_dwordx4 a[124:127], v195, s[20:23], s82 offen offset:1024 sc1
  v_mfma_f32_16x16x32_bf16 v[24:27], a[60:63], a[92:95], v[24:27]
  v_mfma_f32_16x16x32_bf16 v[28:31], a[60:63], a[96:99], v[28:31]
  ds_read_b64_tr_b16 a[38:39], v181 offset:1280
  v_mfma_f32_16x16x32_bf16 v[32:35], a[60:63], a[100:103], v[32:35]
  ds_read_b128 a[4:7], v178 offset:2048
  v_mfma_f32_16x16x32_bf16 v[36:39], a[60:63], a[104:107], v[36:39]
  v_mfma_f32_16x16x32_bf16 v[40:43], a[64:67], a[88:91], v[40:43]
  ds_read_b64_tr_b16 a[40:41], v180 offset:64
  buffer_load_dwordx4 a[128:131], v195, s[20:23], s82 offen offset:2048 sc1
  v_mfma_f32_16x16x32_bf16 v[44:47], a[64:67], a[92:95], v[44:47]
  v_mfma_f32_16x16x32_bf16 v[48:51], a[64:67], a[96:99], v[48:51]
  ds_read_b64_tr_b16 a[42:43], v180 offset:1344
  v_mfma_f32_16x16x32_bf16 v[52:55], a[64:67], a[100:103], v[52:55]
  v_mfma_f32_16x16x32_bf16 v[56:59], a[64:67], a[104:107], v[56:59]
  ds_read_b64_tr_b16 a[44:45], v181 offset:64
  buffer_load_dwordx4 a[132:135], v195, s[20:23], s82 offen offset:3072 sc1
  v_mfma_f32_16x16x32_bf16 v[60:63], a[68:71], a[88:91], v[60:63]
  v_mfma_f32_16x16x32_bf16 v[64:67], a[68:71], a[92:95], v[64:67]
  ds_read_b64_tr_b16 a[46:47], v181 offset:1344
  v_mfma_f32_16x16x32_bf16 v[68:71], a[68:71], a[96:99], v[68:71]
  ds_read_b128 a[8:11], v178 offset:4096
  v_mfma_f32_16x16x32_bf16 v[72:75], a[68:71], a[100:103], v[72:75]
  v_mfma_f32_16x16x32_bf16 v[76:79], a[68:71], a[104:107], v[76:79]
  ds_read_b128 a[12:15], v178 offset:6144
  s_addk_i32 s82, 0x1000
  buffer_load_dwordx4 a[136:139], v195, s[20:23], s82 offen offset:0 sc1
  v_mfma_f32_16x16x32_bf16 v[80:83], a[72:75], a[88:91], v[80:83]
  v_mfma_f32_16x16x32_bf16 v[84:87], a[72:75], a[92:95], v[84:87]
  ds_read_b128 a[16:19], v178 offset:8192
  v_mfma_f32_16x16x32_bf16 v[88:91], a[72:75], a[96:99], v[88:91]
  v_mfma_f32_16x16x32_bf16 v[92:95], a[72:75], a[100:103], v[92:95]
  ds_read_b128 a[20:23], v178 offset:10240
  v_mfma_f32_16x16x32_bf16 v[96:99], a[72:75], a[104:107], v[96:99]
  ds_read_b128 a[24:27], v178 offset:12288
  buffer_load_dwordx4 a[140:143], v195, s[20:23], s82 offen offset:1024 sc1
  v_mfma_f32_16x16x32_bf16 v[100:103], a[76:79], a[88:91], v[100:103]
  v_mfma_f32_16x16x32_bf16 v[104:107], a[76:79], a[92:95], v[104:107]
  ds_read_b128 a[28:31], v178 offset:14336
  v_mfma_f32_16x16x32_bf16 v[108:111], a[76:79], a[96:99], v[108:111]
  v_mfma_f32_16x16x32_bf16 v[112:115], a[76:79], a[100:103], v[112:115]
  ds_read_b64_tr_b16 a[48:49], v180 offset:128
  buffer_load_dwordx4 a[144:147], v195, s[20:23], s82 offen offset:2048 sc1
  v_mfma_f32_16x16x32_bf16 v[116:119], a[76:79], a[104:107], v[116:119]
  v_mfma_f32_16x16x32_bf16 v[120:123], a[80:83], a[88:91], v[120:123]
  ds_read_b64_tr_b16 a[50:51], v180 offset:1408
  v_mfma_f32_16x16x32_bf16 v[124:127], a[80:83], a[92:95], v[124:127]
  v_mfma_f32_16x16x32_bf16 v[128:131], a[80:83], a[96:99], v[128:131]
  v_mfma_f32_16x16x32_bf16 v[132:135], a[80:83], a[100:103], v[132:135]
  buffer_load_dwordx4 a[148:151], v195, s[20:23], s82 offen offset:3072 sc1
  v_mfma_f32_16x16x32_bf16 v[136:139], a[80:83], a[104:107], v[136:139]
  v_mfma_f32_16x16x32_bf16 v[140:143], a[84:87], a[88:91], v[140:143]
  v_mfma_f32_16x16x32_bf16 v[144:147], a[84:87], a[92:95], v[144:147]
  v_mfma_f32_16x16x32_bf16 v[148:151], a[84:87], a[96:99], v[148:151]
  v_mfma_f32_16x16x32_bf16 v[152:155], a[84:87], a[100:103], v[152:155]
  s_addk_i32 s82, 0x1000
  v_mfma_f32_16x16x32_bf16 v[156:159], a[84:87], a[104:107], v[156:159]
  s_waitcnt lgkmcnt(0)
  v_mfma_f32_16x16x32_bf16 v[0:3], a[0:3], a[32:35], v[0:3]
  ds_read_b128 a[56:59], v179 offset:0
  v_mfma_f32_16x16x32_bf16 v[4:7], a[0:3], a[36:39], v[4:7]
  ds_read_b64_tr_b16 a[88:89], v180 offset:10240
  buffer_load_dwordx4 a[152:155], v195, s[20:23], s82 offen offset:0 sc1
  v_mfma_f32_16x16x32_bf16 v[8:11], a[0:3], a[40:43], v[8:11]
  v_mfma_f32_16x16x32_bf16 v[12:15], a[0:3], a[44:47], v[12:15]
  ds_read_b64_tr_b16 a[90:91], v180 offset:11520
  v_mfma_f32_16x16x32_bf16 v[16:19], a[0:3], a[48:51], v[16:19]
  buffer_load_dwordx4 a[156:159], v195, s[20:23], s82 offen offset:1024 sc1
  v_mfma_f32_16x16x32_bf16 v[20:23], a[4:7], a[32:35], v[20:23]
  ds_read_b64_tr_b16 a[92:93], v181 offset:10240
  v_mfma_f32_16x16x32_bf16 v[24:27], a[4:7], a[36:39], v[24:27]
  v_mfma_f32_16x16x32_bf16 v[28:31], a[4:7], a[40:43], v[28:31]
  ds_read_b64_tr_b16 a[94:95], v181 offset:11520
  buffer_load_dwordx4 a[160:163], v195, s[20:23], s82 offen offset:2048 sc1
  v_mfma_f32_16x16x32_bf16 v[32:35], a[4:7], a[44:47], v[32:35]
  ds_read_b128 a[60:63], v179 offset:2048
  v_mfma_f32_16x16x32_bf16 v[36:39], a[4:7], a[48:51], v[36:39]
  v_mfma_f32_16x16x32_bf16 v[40:43], a[8:11], a[32:35], v[40:43]
  ds_read_b64_tr_b16 a[96:97], v180 offset:10304
  v_mfma_f32_16x16x32_bf16 v[44:47], a[8:11], a[36:39], v[44:47]
  buffer_load_dwordx4 a[164:167], v195, s[20:23], s82 offen offset:3072 sc1
  v_mfma_f32_16x16x32_bf16 v[48:51], a[8:11], a[40:43], v[48:51]
  ds_read_b64_tr_b16 a[98:99], v180 offset:11584
  v_mfma_f32_16x16x32_bf16 v[52:55], a[8:11], a[44:47], v[52:55]
  v_mfma_f32_16x16x32_bf16 v[56:59], a[8:11], a[48:51], v[56:59]
  ds_read_b64_tr_b16 a[100:101], v181 offset:10304
  s_addk_i32 s82, 0x1000
  buffer_load_dwordx4 a[168:171], v195, s[20:23], s82 offen offset:0 sc1
  v_mfma_f32_16x16x32_bf16 v[60:63], a[12:15], a[32:35], v[60:63]
  v_mfma_f32_16x16x32_bf16 v[64:67], a[12:15], a[36:39], v[64:67]
  ds_read_b64_tr_b16 a[102:103], v181 offset:11584
  v_mfma_f32_16x16x32_bf16 v[68:71], a[12:15], a[40:43], v[68:71]
  ds_read_b128 a[64:67], v179 offset:4096
  buffer_load_dwordx4 a[172:175], v195, s[20:23], s82 offen offset:1024 sc1
  v_mfma_f32_16x16x32_bf16 v[72:75], a[12:15], a[44:47], v[72:75]
  v_mfma_f32_16x16x32_bf16 v[76:79], a[12:15], a[48:51], v[76:79]
  ds_read_b128 a[68:71], v179 offset:6144
  v_mfma_f32_16x16x32_bf16 v[80:83], a[16:19], a[32:35], v[80:83]
  v_mfma_f32_16x16x32_bf16 v[84:87], a[16:19], a[36:39], v[84:87]
  ds_read_b128 a[72:75], v179 offset:8192
  buffer_load_dwordx4 a[176:179], v195, s[20:23], s82 offen offset:2048 sc1
  v_mfma_f32_16x16x32_bf16 v[88:91], a[16:19], a[40:43], v[88:91]
  v_mfma_f32_16x16x32_bf16 v[92:95], a[16:19], a[44:47], v[92:95]
  ds_read_b128 a[76:79], v179 offset:10240
  v_mfma_f32_16x16x32_bf16 v[96:99], a[16:19], a[48:51], v[96:99]
  ds_read_b128 a[80:83], v179 offset:12288
  buffer_load_dwordx4 a[180:183], v195, s[20:23], s82 offen offset:3072 sc1
  v_mfma_f32_16x16x32_bf16 v[100:103], a[20:23], a[32:35], v[100:103]
  v_mfma_f32_16x16x32_bf16 v[104:107], a[20:23], a[36:39], v[104:107]
  ds_read_b128 a[84:87], v179 offset:14336
  v_mfma_f32_16x16x32_bf16 v[108:111], a[20:23], a[40:43], v[108:111]
  s_addk_i32 s82, 0x1000
  buffer_load_dwordx4 a[184:187], v195, s[20:23], s82 offen offset:0 sc1
  v_mfma_f32_16x16x32_bf16 v[112:115], a[20:23], a[44:47], v[112:115]
  ds_read_b64_tr_b16 a[104:105], v180 offset:10368
  v_mfma_f32_16x16x32_bf16 v[116:119], a[20:23], a[48:51], v[116:119]
  v_mfma_f32_16x16x32_bf16 v[120:123], a[24:27], a[32:35], v[120:123]
  ds_read_b64_tr_b16 a[106:107], v180 offset:11648
  v_mfma_f32_16x16x32_bf16 v[124:127], a[24:27], a[36:39], v[124:127]
  buffer_load_dwordx4 a[188:191], v195, s[20:23], s82 offen offset:1024 sc1
  v_mfma_f32_16x16x32_bf16 v[128:131], a[24:27], a[40:43], v[128:131]
  v_mfma_f32_16x16x32_bf16 v[132:135], a[24:27], a[44:47], v[132:135]
  v_mfma_f32_16x16x32_bf16 v[136:139], a[24:27], a[48:51], v[136:139]
  buffer_load_dwordx4 a[192:195], v195, s[20:23], s82 offen offset:2048 sc1
  v_mfma_f32_16x16x32_bf16 v[140:143], a[28:31], a[32:35], v[140:143]
  v_mfma_f32_16x16x32_bf16 v[144:147], a[28:31], a[36:39], v[144:147]
  v_mfma_f32_16x16x32_bf16 v[148:151], a[28:31], a[40:43], v[148:151]
  v_mfma_f32_16x16x32_bf16 v[152:155], a[28:31], a[44:47], v[152:155]
  v_mfma_f32_16x16x32_bf16 v[156:159], a[28:31], a[48:51], v[156:159]
  s_waitcnt vmcnt(19) lgkmcnt(0)
  s_barrier
  v_add_u32 v178, 4294860800, v178
  v_add_u32 v179, 4294860800, v179
  v_add_u32 v180, 4294860800, v180
  v_add_u32 v181, 4294860800, v181
  v_mfma_f32_16x16x32_bf16 v[0:3], a[56:59], a[88:91], v[0:3]
  ds_read_b128 a[0:3], v178 offset:0
  v_mfma_f32_16x16x32_bf16 v[4:7], a[56:59], a[92:95], v[4:7]
  ds_read_b64_tr_b16 a[32:33], v180 offset:0
  buffer_load_dwordx4 a[196:199], v195, s[20:23], s82 offen offset:3072 sc1
  v_mfma_f32_16x16x32_bf16 v[8:11], a[56:59], a[96:99], v[8:11]
  v_mfma_f32_16x16x32_bf16 v[12:15], a[56:59], a[100:103], v[12:15]
  ds_read_b64_tr_b16 a[34:35], v180 offset:1280
  v_mfma_f32_16x16x32_bf16 v[16:19], a[56:59], a[104:107], v[16:19]
  s_addk_i32 s82, 0x1000
  buffer_load_dwordx4 a[200:203], v195, s[20:23], s82 offen offset:0 sc1
  v_mfma_f32_16x16x32_bf16 v[20:23], a[60:63], a[88:91], v[20:23]
  ds_read_b64_tr_b16 a[36:37], v181 offset:0
  v_mfma_f32_16x16x32_bf16 v[24:27], a[60:63], a[92:95], v[24:27]
  v_mfma_f32_16x16x32_bf16 v[28:31], a[60:63], a[96:99], v[28:31]
  ds_read_b64_tr_b16 a[38:39], v181 offset:1280
  buffer_load_dwordx4 a[204:207], v195, s[20:23], s82 offen offset:1024 sc1
  v_mfma_f32_16x16x32_bf16 v[32:35], a[60:63], a[100:103], v[32:35]
  ds_read_b128 a[4:7], v178 offset:2048
  v_mfma_f32_16x16x32_bf16 v[36:39], a[60:63], a[104:107], v[36:39]
  v_mfma_f32_16x16x32_bf16 v[40:43], a[64:67], a[88:91], v[40:43]
  ds_read_b64_tr_b16 a[40:41], v180 offset:64
  v_mfma_f32_16x16x32_bf16 v[44:47], a[64:67], a[92:95], v[44:47]
  buffer_load_dwordx4 a[208:211], v195, s[20:23], s82 offen offset:2048 sc1
  v_mfma_f32_16x16x32_bf16 v[48:51], a[64:67], a[96:99], v[48:51]
  ds_read_b64_tr_b16 a[42:43], v180 offset:1344
  v_mfma_f32_16x16x32_bf16 v[52:55], a[64:67], a[100:103], v[52:55]
  v_mfma_f32_16x16x32_bf16 v[56:59], a[64:67], a[104:107], v[56:59]
  ds_read_b64_tr_b16 a[44:45], v181 offset:64
  buffer_load_dwordx4 a[212:215], v195, s[20:23], s82 offen offset:3072 sc1
  v_mfma_f32_16x16x32_bf16 v[60:63], a[68:71], a[88:91], v[60:63]
  v_mfma_f32_16x16x32_bf16 v[64:67], a[68:71], a[92:95], v[64:67]
  ds_read_b64_tr_b16 a[46:47], v181 offset:1344
  v_mfma_f32_16x16x32_bf16 v[68:71], a[68:71], a[96:99], v[68:71]
  ds_read_b128 a[8:11], v178 offset:4096
  s_addk_i32 s82, 0x1000
  buffer_load_dwordx4 a[216:219], v195, s[20:23], s82 offen offset:0 sc1
  v_mfma_f32_16x16x32_bf16 v[72:75], a[68:71], a[100:103], v[72:75]
  v_mfma_f32_16x16x32_bf16 v[76:79], a[68:71], a[104:107], v[76:79]
  ds_read_b128 a[12:15], v178 offset:6144
  v_mfma_f32_16x16x32_bf16 v[80:83], a[72:75], a[88:91], v[80:83]
  v_mfma_f32_16x16x32_bf16 v[84:87], a[72:75], a[92:95], v[84:87]
  ds_read_b128 a[16:19], v178 offset:8192
  buffer_load_dwordx4 a[220:223], v195, s[20:23], s82 offen offset:1024 sc1
  v_mfma_f32_16x16x32_bf16 v[88:91], a[72:75], a[96:99], v[88:91]
  v_mfma_f32_16x16x32_bf16 v[92:95], a[72:75], a[100:103], v[92:95]
  ds_read_b128 a[20:23], v178 offset:10240
  v_mfma_f32_16x16x32_bf16 v[96:99], a[72:75], a[104:107], v[96:99]
  ds_read_b128 a[24:27], v178 offset:12288
  buffer_load_dwordx4 a[224:227], v195, s[20:23], s82 offen offset:2048 sc1
  v_mfma_f32_16x16x32_bf16 v[100:103], a[76:79], a[88:91], v[100:103]
  v_mfma_f32_16x16x32_bf16 v[104:107], a[76:79], a[92:95], v[104:107]
  ds_read_b128 a[28:31], v178 offset:14336
  v_mfma_f32_16x16x32_bf16 v[108:111], a[76:79], a[96:99], v[108:111]
  buffer_load_dwordx4 a[228:231], v195, s[20:23], s82 offen offset:3072 sc1
  v_mfma_f32_16x16x32_bf16 v[112:115], a[76:79], a[100:103], v[112:115]
  ds_read_b64_tr_b16 a[48:49], v180 offset:128
  v_mfma_f32_16x16x32_bf16 v[116:119], a[76:79], a[104:107], v[116:119]
  v_mfma_f32_16x16x32_bf16 v[120:123], a[80:83], a[88:91], v[120:123]
  ds_read_b64_tr_b16 a[50:51], v180 offset:1408
  v_mfma_f32_16x16x32_bf16 v[124:127], a[80:83], a[92:95], v[124:127]
  s_addk_i32 s82, 0x1000
  buffer_load_dwordx4 a[232:235], v195, s[20:23], s82 offen offset:0 sc1
  v_mfma_f32_16x16x32_bf16 v[128:131], a[80:83], a[96:99], v[128:131]
  v_mfma_f32_16x16x32_bf16 v[132:135], a[80:83], a[100:103], v[132:135]
  v_mfma_f32_16x16x32_bf16 v[136:139], a[80:83], a[104:107], v[136:139]
  buffer_load_dwordx4 a[236:239], v195, s[20:23], s82 offen offset:1024 sc1
  v_mfma_f32_16x16x32_bf16 v[140:143], a[84:87], a[88:91], v[140:143]
  v_mfma_f32_16x16x32_bf16 v[144:147], a[84:87], a[92:95], v[144:147]
  v_mfma_f32_16x16x32_bf16 v[148:151], a[84:87], a[96:99], v[148:151]
  v_mfma_f32_16x16x32_bf16 v[152:155], a[84:87], a[100:103], v[152:155]
  s_addk_i32 s82, 0x800
  v_mfma_f32_16x16x32_bf16 v[156:159], a[84:87], a[104:107], v[156:159]
  s_waitcnt lgkmcnt(0)
  v_mfma_f32_16x16x32_bf16 v[0:3], a[0:3], a[32:35], v[0:3]
  ds_read_b128 a[56:59], v179 offset:0
  ds_read_b64_tr_b16 a[88:89], v180 offset:10240
  s_mov_b32 s70, 1069066811
  s_mov_b32 s71, 1069066811
  v_mfma_f32_16x16x32_bf16 v[4:7], a[0:3], a[36:39], v[4:7]
  ds_read_b64_tr_b16 a[90:91], v180 offset:11520
  v_mov_b32 v238, 3216550471
  v_mov_b32 v239, 3216550471
  v_mfma_f32_16x16x32_bf16 v[8:11], a[0:3], a[40:43], v[8:11]
  ds_read_b64_tr_b16 a[92:93], v181 offset:10240
  s_mov_b32 s74, 897988541
  s_mov_b32 s75, 897988541
  v_mfma_f32_16x16x32_bf16 v[12:15], a[0:3], a[44:47], v[12:15]
  ds_read_b64_tr_b16 a[94:95], v181 offset:11520
  s_lshl_b32 s53, s6, 5
  s_lshl_b32 s54, s7, 2
  v_mfma_f32_16x16x32_bf16 v[16:19], a[0:3], a[48:51], v[16:19]
  ds_read_b128 a[60:63], v179 offset:2048
  s_add_u32 s53, s53, s54
  s_add_u32 s53, s53, s42
  v_mfma_f32_16x16x32_bf16 v[20:23], a[4:7], a[32:35], v[20:23]
  ds_read_b64_tr_b16 a[96:97], v180 offset:10304
  s_mul_i32 s53, s53, 1920
  s_add_u32 s84, s53, 13697024
  v_mfma_f32_16x16x32_bf16 v[24:27], a[4:7], a[36:39], v[24:27]
  ds_read_b64_tr_b16 a[98:99], v180 offset:11584
  s_mul_i32 s85, s42, 1920
  s_add_u32 s85, s85, 131072
  v_mfma_f32_16x16x32_bf16 v[28:31], a[4:7], a[40:43], v[28:31]
  ds_read_b64_tr_b16 a[100:101], v181 offset:10304
  v_mfma_f32_16x16x32_bf16 v[32:35], a[4:7], a[44:47], v[32:35]
  ds_read_b64_tr_b16 a[102:103], v181 offset:11584
  ds_read_b128 a[64:67], v179 offset:4096
  v_mfma_f32_16x16x32_bf16 v[36:39], a[4:7], a[48:51], v[36:39]
  ds_read_b128 a[68:71], v179 offset:6144
  v_mfma_f32_16x16x32_bf16 v[40:43], a[8:11], a[32:35], v[40:43]
  ds_read_b128 a[72:75], v179 offset:8192
  v_mfma_f32_16x16x32_bf16 v[44:47], a[8:11], a[36:39], v[44:47]
  ds_read_b128 a[76:79], v179 offset:10240
  v_mfma_f32_16x16x32_bf16 v[48:51], a[8:11], a[40:43], v[48:51]
  ds_read_b128 a[80:83], v179 offset:12288
  v_mfma_f32_16x16x32_bf16 v[52:55], a[8:11], a[44:47], v[52:55]
  ds_read_b128 a[84:87], v179 offset:14336
  v_mfma_f32_16x16x32_bf16 v[56:59], a[8:11], a[48:51], v[56:59]
  ds_read_b64_tr_b16 a[104:105], v180 offset:10368
  v_mfma_f32_16x16x32_bf16 v[60:63], a[12:15], a[32:35], v[60:63]
  ds_read_b64_tr_b16 a[106:107], v180 offset:11648
  v_mfma_f32_16x16x32_bf16 v[64:67], a[12:15], a[36:39], v[64:67]
  v_mfma_f32_16x16x32_bf16 v[68:71], a[12:15], a[40:43], v[68:71]
  v_mfma_f32_16x16x32_bf16 v[72:75], a[12:15], a[44:47], v[72:75]
  v_mfma_f32_16x16x32_bf16 v[76:79], a[12:15], a[48:51], v[76:79]
  s_waitcnt lgkmcnt(0)
  s_barrier
  v_mfma_f32_16x16x32_bf16 v[0:3], a[56:59], a[88:91], v[0:3]
  s_mul_i32 m0, s42, 30720
  s_nop 0
  buffer_load_dwordx4 v195, s[20:23], s82 offen offset:0 sc1 lds
  v_mfma_f32_16x16x32_bf16 v[4:7], a[56:59], a[92:95], v[4:7]
  v_mfma_f32_16x16x32_bf16 v[8:11], a[56:59], a[96:99], v[8:11]
  v_mfma_f32_16x16x32_bf16 v[12:15], a[56:59], a[100:103], v[12:15]
  v_mfma_f32_16x16x32_bf16 v[16:19], a[56:59], a[104:107], v[16:19]
  v_mfma_f32_16x16x32_bf16 v[20:23], a[60:63], a[88:91], v[20:23]
  v_mfma_f32_16x16x32_bf16 v[24:27], a[60:63], a[92:95], v[24:27]
  buffer_load_dwordx4 v195, s[20:23], s82 offen offset:1024 sc1 lds
  v_mfma_f32_16x16x32_bf16 v[28:31], a[60:63], a[96:99], v[28:31]
  v_mfma_f32_16x16x32_bf16 v[32:35], a[60:63], a[100:103], v[32:35]
  v_mfma_f32_16x16x32_bf16 v[36:39], a[60:63], a[104:107], v[36:39]
  v_mfma_f32_16x16x32_bf16 v[40:43], a[64:67], a[88:91], v[40:43]
  v_mfma_f32_16x16x32_bf16 v[44:47], a[64:67], a[92:95], v[44:47]
  v_pk_fma_f32 v[200:201], v[0:1], s[70:71], v[238:239]
  v_pk_fma_f32 v[202:203], v[2:3], s[70:71], v[238:239]
  v_mfma_f32_16x16x32_bf16 v[48:51], a[64:67], a[96:99], v[48:51]
  buffer_load_dwordx4 v195, s[20:23], s82 offen offset:2048 sc1 lds
  v_pk_fma_f32 v[204:205], v[4:5], s[70:71], v[238:239]
  v_pk_fma_f32 v[206:207], v[6:7], s[70:71], v[238:239]
  v_mfma_f32_16x16x32_bf16 v[52:55], a[64:67], a[100:103], v[52:55]
  v_exp_f32 v200, v200 clamp
  v_mfma_f32_16x16x32_bf16 v[56:59], a[64:67], a[104:107], v[56:59]
  v_exp_f32 v201, v201 clamp
  v_mfma_f32_16x16x32_bf16 v[60:63], a[68:71], a[88:91], v[60:63]
  v_exp_f32 v202, v202 clamp
  v_mfma_f32_16x16x32_bf16 v[64:67], a[68:71], a[92:95], v[64:67]
  v_exp_f32 v203, v203 clamp
  v_mfma_f32_16x16x32_bf16 v[68:71], a[68:71], a[96:99], v[68:71]
  v_exp_f32 v204, v204 clamp
  v_mfma_f32_16x16x32_bf16 v[72:75], a[68:71], a[100:103], v[72:75]
  buffer_load_dwordx4 v195, s[20:23], s82 offen offset:3072 sc1 lds
  v_exp_f32 v205, v205 clamp
  v_mfma_f32_16x16x32_bf16 v[76:79], a[68:71], a[104:107], v[76:79]
  v_exp_f32 v206, v206 clamp
  v_mfma_f32_16x16x32_bf16 v[80:83], a[16:19], a[32:35], v[80:83]
  v_exp_f32 v207, v207 clamp
  v_mfma_f32_16x16x32_bf16 v[84:87], a[16:19], a[36:39], v[84:87]
  v_pk_add_f32 v[200:201], v[200:201], s[74:75]
  v_pk_add_f32 v[202:203], v[202:203], s[74:75]
  v_mfma_f32_16x16x32_bf16 v[88:91], a[16:19], a[40:43], v[88:91]
  v_pk_add_f32 v[204:205], v[204:205], s[74:75]
  v_pk_add_f32 v[206:207], v[206:207], s[74:75]
  v_mfma_f32_16x16x32_bf16 v[92:95], a[16:19], a[44:47], v[92:95]
  v_max_f32 v0, v0, v200
  v_max_f32 v1, v1, v201
  v_mfma_f32_16x16x32_bf16 v[96:99], a[16:19], a[48:51], v[96:99]
  s_addk_i32 m0, 0x1000
  s_addk_i32 s82, 0x1000
  buffer_load_dwordx4 v195, s[20:23], s82 offen offset:0 sc1 lds
  v_max_f32 v2, v2, v202
  v_max_f32 v3, v3, v203
  v_mfma_f32_16x16x32_bf16 v[100:103], a[20:23], a[32:35], v[100:103]
  v_max_f32 v4, v4, v204
  v_max_f32 v5, v5, v205
  v_mfma_f32_16x16x32_bf16 v[104:107], a[20:23], a[36:39], v[104:107]
  v_max_f32 v6, v6, v206
  v_max_f32 v7, v7, v207
  v_mfma_f32_16x16x32_bf16 v[108:111], a[20:23], a[40:43], v[108:111]
  v_pk_fma_f32 v[208:209], v[8:9], s[70:71], v[238:239]
  v_pk_fma_f32 v[210:211], v[10:11], s[70:71], v[238:239]
  v_mfma_f32_16x16x32_bf16 v[112:115], a[20:23], a[44:47], v[112:115]
  v_exp_f32 v208, v208 clamp
  v_mfma_f32_16x16x32_bf16 v[116:119], a[20:23], a[48:51], v[116:119]
  v_exp_f32 v209, v209 clamp
  v_mfma_f32_16x16x32_bf16 v[80:83], a[72:75], a[88:91], v[80:83]
  buffer_load_dwordx4 v195, s[20:23], s82 offen offset:1024 sc1 lds
  v_exp_f32 v210, v210 clamp
  v_mfma_f32_16x16x32_bf16 v[84:87], a[72:75], a[92:95], v[84:87]
  v_exp_f32 v211, v211 clamp
  v_mfma_f32_16x16x32_bf16 v[88:91], a[72:75], a[96:99], v[88:91]
  v_fma_f32 v208, v208, v160, v161
  v_fma_f32 v209, v209, v160, v161
  v_mfma_f32_16x16x32_bf16 v[92:95], a[72:75], a[100:103], v[92:95]
  v_fma_f32 v210, v210, v160, v161
  v_fma_f32 v211, v211, v160, v161
  v_mfma_f32_16x16x32_bf16 v[96:99], a[72:75], a[104:107], v[96:99]
  v_max_f32 v8, v8, v208
  v_max_f32 v9, v9, v209
  v_mfma_f32_16x16x32_bf16 v[100:103], a[76:79], a[88:91], v[100:103]
  v_max_f32 v10, v10, v210
  v_max_f32 v11, v11, v211
  v_mfma_f32_16x16x32_bf16 v[104:107], a[76:79], a[92:95], v[104:107]
  buffer_load_dwordx4 v195, s[20:23], s82 offen offset:2048 sc1 lds
  v_cvt_pk_bf16_f32 v212, v0, v1
  v_cvt_pk_bf16_f32 v213, v2, v3
  v_mfma_f32_16x16x32_bf16 v[108:111], a[76:79], a[96:99], v[108:111]
  v_cvt_pk_bf16_f32 v216, v4, v5
  v_cvt_pk_bf16_f32 v217, v6, v7
  v_mfma_f32_16x16x32_bf16 v[112:115], a[76:79], a[100:103], v[112:115]
  v_cvt_pk_bf16_f32 v220, v8, v9
  v_cvt_pk_bf16_f32 v221, v10, v11
  v_mfma_f32_16x16x32_bf16 v[116:119], a[76:79], a[104:107], v[116:119]
  v_cvt_pk_bf16_f32 v224, v12, v13
  v_cvt_pk_bf16_f32 v225, v14, v15
  v_mfma_f32_16x16x32_bf16 v[120:123], a[24:27], a[32:35], v[120:123]
  v_cvt_pk_bf16_f32 v228, v16, v17
  v_cvt_pk_bf16_f32 v229, v18, v19
  v_mfma_f32_16x16x32_bf16 v[124:127], a[24:27], a[36:39], v[124:127]
  v_pk_fma_f32 v[200:201], v[20:21], s[70:71], v[238:239]
  v_pk_fma_f32 v[202:203], v[22:23], s[70:71], v[238:239]
  v_mfma_f32_16x16x32_bf16 v[128:131], a[24:27], a[40:43], v[128:131]
  buffer_load_dwordx4 v195, s[20:23], s82 offen offset:3072 sc1 lds
  v_pk_fma_f32 v[204:205], v[24:25], s[70:71], v[238:239]
  v_pk_fma_f32 v[206:207], v[26:27], s[70:71], v[238:239]
  v_mfma_f32_16x16x32_bf16 v[132:135], a[24:27], a[44:47], v[132:135]
  v_exp_f32 v200, v200 clamp
  v_mfma_f32_16x16x32_bf16 v[136:139], a[24:27], a[48:51], v[136:139]
  v_exp_f32 v201, v201 clamp
  v_mfma_f32_16x16x32_bf16 v[140:143], a[28:31], a[32:35], v[140:143]
  v_exp_f32 v202, v202 clamp
  v_mfma_f32_16x16x32_bf16 v[144:147], a[28:31], a[36:39], v[144:147]
  v_exp_f32 v203, v203 clamp
  v_mfma_f32_16x16x32_bf16 v[148:151], a[28:31], a[40:43], v[148:151]
  v_exp_f32 v204, v204 clamp
  v_mfma_f32_16x16x32_bf16 v[152:155], a[28:31], a[44:47], v[152:155]
  s_addk_i32 m0, 0x1000
  s_addk_i32 s82, 0x1000
  buffer_load_dwordx4 v195, s[20:23], s82 offen offset:0 sc1 lds
  v_exp_f32 v205, v205 clamp
  v_mfma_f32_16x16x32_bf16 v[156:159], a[28:31], a[48:51], v[156:159]
  v_exp_f32 v206, v206 clamp
  v_mfma_f32_16x16x32_bf16 v[120:123], a[80:83], a[88:91], v[120:123]
  v_exp_f32 v207, v207 clamp
  v_mfma_f32_16x16x32_bf16 v[124:127], a[80:83], a[92:95], v[124:127]
  v_pk_add_f32 v[200:201], v[200:201], s[74:75]
  v_pk_add_f32 v[202:203], v[202:203], s[74:75]
  v_mfma_f32_16x16x32_bf16 v[128:131], a[80:83], a[96:99], v[128:131]
  v_pk_add_f32 v[204:205], v[204:205], s[74:75]
  v_pk_add_f32 v[206:207], v[206:207], s[74:75]
  v_mfma_f32_16x16x32_bf16 v[132:135], a[80:83], a[100:103], v[132:135]
  v_max_f32 v20, v20, v200
  v_max_f32 v21, v21, v201
  v_mfma_f32_16x16x32_bf16 v[136:139], a[80:83], a[104:107], v[136:139]
  buffer_load_dwordx4 v195, s[20:23], s82 offen offset:1024 sc1 lds
  v_max_f32 v22, v22, v202
  v_max_f32 v23, v23, v203
  v_mfma_f32_16x16x32_bf16 v[140:143], a[84:87], a[88:91], v[140:143]
  v_max_f32 v24, v24, v204
  v_max_f32 v25, v25, v205
  v_mfma_f32_16x16x32_bf16 v[144:147], a[84:87], a[92:95], v[144:147]
  v_max_f32 v26, v26, v206
  v_max_f32 v27, v27, v207
  v_mfma_f32_16x16x32_bf16 v[148:151], a[84:87], a[96:99], v[148:151]
  v_pk_fma_f32 v[208:209], v[28:29], s[70:71], v[238:239]
  v_pk_fma_f32 v[210:211], v[30:31], s[70:71], v[238:239]
  v_mfma_f32_16x16x32_bf16 v[152:155], a[84:87], a[100:103], v[152:155]
  v_exp_f32 v208, v208 clamp
  v_mfma_f32_16x16x32_bf16 v[156:159], a[84:87], a[104:107], v[156:159]
  v_exp_f32 v209, v209 clamp
  v_exp_f32 v210, v210 clamp
  v_exp_f32 v211, v211 clamp
  buffer_load_dwordx4 v195, s[20:23], s82 offen offset:2048 sc1 lds
  v_fma_f32 v208, v208, v160, v161
  v_fma_f32 v209, v209, v160, v161
  v_fma_f32 v210, v210, v160, v161
  v_fma_f32 v211, v211, v160, v161
  v_max_f32 v28, v28, v208
  v_max_f32 v29, v29, v209
  v_max_f32 v30, v30, v210
  v_max_f32 v31, v31, v211
  v_cvt_pk_bf16_f32 v214, v20, v21
  v_cvt_pk_bf16_f32 v215, v22, v23
  v_cvt_pk_bf16_f32 v218, v24, v25
  v_cvt_pk_bf16_f32 v219, v26, v27
  v_cvt_pk_bf16_f32 v222, v28, v29
  v_cvt_pk_bf16_f32 v223, v30, v31
  v_cvt_pk_bf16_f32 v226, v32, v33
  v_cvt_pk_bf16_f32 v227, v34, v35
  v_cvt_pk_bf16_f32 v230, v36, v37
  v_cvt_pk_bf16_f32 v231, v38, v39
  v_mfma_f32_16x16x32_bf16 v[0:3], v[220:223], v[212:215], 0
  v_pk_fma_f32 v[200:201], v[40:41], s[70:71], v[238:239]
  v_pk_fma_f32 v[202:203], v[42:43], s[70:71], v[238:239]
  v_mfma_f32_16x16x32_bf16 v[4:7], v[224:227], v[212:215], 0
  buffer_load_dwordx4 v195, s[20:23], s82 offen offset:3072 sc1 lds
  v_pk_fma_f32 v[204:205], v[44:45], s[70:71], v[238:239]
  v_pk_fma_f32 v[206:207], v[46:47], s[70:71], v[238:239]
  v_mfma_f32_16x16x32_bf16 v[8:11], v[220:223], v[216:219], 0
  v_exp_f32 v200, v200 clamp
  v_mfma_f32_16x16x32_bf16 v[12:15], v[224:227], v[216:219], 0
  v_exp_f32 v201, v201 clamp
  v_mfma_f32_16x16x32_bf16 v[16:19], v[228:231], v[216:219], 0
  v_exp_f32 v202, v202 clamp
  v_mfma_f32_16x16x32_bf16 v[20:23], v[224:227], v[220:223], 0
  v_exp_f32 v203, v203 clamp
  v_mfma_f32_16x16x32_bf16 v[24:27], v[228:231], v[220:223], 0
  v_exp_f32 v204, v204 clamp
  v_mfma_f32_16x16x32_bf16 v[28:31], v[232:235], v[212:215], 0
  s_addk_i32 m0, 0x1000
  s_addk_i32 s82, 0x1000
  buffer_load_dwordx4 v195, s[20:23], s82 offen offset:0 sc1 lds
  v_exp_f32 v205, v205 clamp
  v_mfma_f32_16x16x32_bf16 v[32:35], v[232:235], v[216:219], 0
  v_exp_f32 v206, v206 clamp
  v_mfma_f32_16x16x32_bf16 v[36:39], v[232:235], v[220:223], 0
  v_exp_f32 v207, v207 clamp
  v_pk_add_f32 v[200:201], v[200:201], s[74:75]
  v_pk_add_f32 v[202:203], v[202:203], s[74:75]
  v_pk_add_f32 v[204:205], v[204:205], s[74:75]
  v_pk_add_f32 v[206:207], v[206:207], s[74:75]
  v_max_f32 v40, v40, v200
  v_max_f32 v41, v41, v201
  v_max_f32 v42, v42, v202
  v_max_f32 v43, v43, v203
  v_max_f32 v44, v44, v204
  v_max_f32 v45, v45, v205
  v_max_f32 v46, v46, v206
  v_max_f32 v47, v47, v207
  v_pk_fma_f32 v[208:209], v[48:49], s[70:71], v[238:239]
  v_pk_fma_f32 v[210:211], v[50:51], s[70:71], v[238:239]
  buffer_load_dwordx4 v195, s[20:23], s82 offen offset:1024 sc1 lds
  v_exp_f32 v208, v208 clamp
  v_exp_f32 v209, v209 clamp
  v_exp_f32 v210, v210 clamp
  v_exp_f32 v211, v211 clamp
  v_fma_f32 v208, v208, v160, v161
  v_fma_f32 v209, v209, v160, v161
  v_fma_f32 v210, v210, v160, v161
  v_fma_f32 v211, v211, v160, v161
  v_max_f32 v48, v48, v208
  v_max_f32 v49, v49, v209
  v_max_f32 v50, v50, v210
  v_max_f32 v51, v51, v211
  v_cvt_pk_bf16_f32 v212, v40, v41
  v_cvt_pk_bf16_f32 v213, v42, v43
  v_cvt_pk_bf16_f32 v216, v44, v45
  v_cvt_pk_bf16_f32 v217, v46, v47
  v_cvt_pk_bf16_f32 v220, v48, v49
  v_cvt_pk_bf16_f32 v221, v50, v51
  v_cvt_pk_bf16_f32 v224, v52, v53
  v_cvt_pk_bf16_f32 v225, v54, v55
  buffer_load_dwordx4 v195, s[20:23], s82 offen offset:2048 sc1 lds
  v_cvt_pk_bf16_f32 v228, v56, v57
  v_cvt_pk_bf16_f32 v229, v58, v59
  v_pk_fma_f32 v[200:201], v[60:61], s[70:71], v[238:239]
  v_pk_fma_f32 v[202:203], v[62:63], s[70:71], v[238:239]
  v_pk_fma_f32 v[204:205], v[64:65], s[70:71], v[238:239]
  v_pk_fma_f32 v[206:207], v[66:67], s[70:71], v[238:239]
  v_exp_f32 v200, v200 clamp
  v_exp_f32 v201, v201 clamp
  v_exp_f32 v202, v202 clamp
  v_exp_f32 v203, v203 clamp
  v_exp_f32 v204, v204 clamp
  v_exp_f32 v205, v205 clamp
  v_exp_f32 v206, v206 clamp
  v_exp_f32 v207, v207 clamp
  v_pk_add_f32 v[200:201], v[200:201], s[74:75]
  v_pk_add_f32 v[202:203], v[202:203], s[74:75]
  buffer_load_dwordx4 v195, s[20:23], s82 offen offset:3072 sc1 lds
  v_pk_add_f32 v[204:205], v[204:205], s[74:75]
  v_pk_add_f32 v[206:207], v[206:207], s[74:75]
  v_max_f32 v60, v60, v200
  v_max_f32 v61, v61, v201
  v_max_f32 v62, v62, v202
  v_max_f32 v63, v63, v203
  v_max_f32 v64, v64, v204
  v_max_f32 v65, v65, v205
  v_max_f32 v66, v66, v206
  v_max_f32 v67, v67, v207
  v_pk_fma_f32 v[208:209], v[68:69], s[70:71], v[238:239]
  v_pk_fma_f32 v[210:211], v[70:71], s[70:71], v[238:239]
  v_exp_f32 v208, v208 clamp
  v_exp_f32 v209, v209 clamp
  v_exp_f32 v210, v210 clamp
  v_exp_f32 v211, v211 clamp
  v_fma_f32 v208, v208, v160, v161
  v_fma_f32 v209, v209, v160, v161
  v_fma_f32 v210, v210, v160, v161
  v_fma_f32 v211, v211, v160, v161
  s_addk_i32 m0, 0x1000
  s_addk_i32 s82, 0x1000
  buffer_load_dwordx4 v195, s[20:23], s82 offen offset:0 sc1 lds
  v_max_f32 v68, v68, v208
  v_max_f32 v69, v69, v209
  v_max_f32 v70, v70, v210
  v_max_f32 v71, v71, v211
  v_cvt_pk_bf16_f32 v214, v60, v61
  v_cvt_pk_bf16_f32 v215, v62, v63
  v_cvt_pk_bf16_f32 v218, v64, v65
  v_cvt_pk_bf16_f32 v219, v66, v67
  v_cvt_pk_bf16_f32 v222, v68, v69
  v_cvt_pk_bf16_f32 v223, v70, v71
  v_cvt_pk_bf16_f32 v226, v72, v73
  v_cvt_pk_bf16_f32 v227, v74, v75
  v_cvt_pk_bf16_f32 v230, v76, v77
  v_cvt_pk_bf16_f32 v231, v78, v79
  v_mfma_f32_16x16x32_bf16 v[0:3], v[220:223], v[212:215], v[0:3]
  v_pk_fma_f32 v[200:201], v[80:81], s[70:71], v[238:239]
  v_pk_fma_f32 v[202:203], v[82:83], s[70:71], v[238:239]
  v_mfma_f32_16x16x32_bf16 v[4:7], v[224:227], v[212:215], v[4:7]
  v_pk_fma_f32 v[204:205], v[84:85], s[70:71], v[238:239]
  v_pk_fma_f32 v[206:207], v[86:87], s[70:71], v[238:239]
  v_mfma_f32_16x16x32_bf16 v[8:11], v[220:223], v[216:219], v[8:11]
  buffer_load_dwordx4 v195, s[20:23], s82 offen offset:1024 sc1 lds
  v_exp_f32 v200, v200 clamp
  v_mfma_f32_16x16x32_bf16 v[12:15], v[224:227], v[216:219], v[12:15]
  v_exp_f32 v201, v201 clamp
  v_mfma_f32_16x16x32_bf16 v[16:19], v[228:231], v[216:219], v[16:19]
  v_exp_f32 v202, v202 clamp
  v_mfma_f32_16x16x32_bf16 v[20:23], v[224:227], v[220:223], v[20:23]
  v_exp_f32 v203, v203 clamp
  v_mfma_f32_16x16x32_bf16 v[24:27], v[228:231], v[220:223], v[24:27]
  v_exp_f32 v204, v204 clamp
  v_mfma_f32_16x16x32_bf16 v[28:31], v[232:235], v[212:215], v[28:31]
  v_exp_f32 v205, v205 clamp
  v_mfma_f32_16x16x32_bf16 v[32:35], v[232:235], v[216:219], v[32:35]
  buffer_load_dwordx4 v195, s[20:23], s82 offen offset:2048 sc1 lds
  v_exp_f32 v206, v206 clamp
  v_mfma_f32_16x16x32_bf16 v[36:39], v[232:235], v[220:223], v[36:39]
  v_exp_f32 v207, v207 clamp
  v_pk_add_f32 v[200:201], v[200:201], s[74:75]
  v_pk_add_f32 v[202:203], v[202:203], s[74:75]
  v_pk_add_f32 v[204:205], v[204:205], s[74:75]
  v_pk_add_f32 v[206:207], v[206:207], s[74:75]
  v_max_f32 v80, v80, v200
  v_max_f32 v81, v81, v201
  v_max_f32 v82, v82, v202
  v_max_f32 v83, v83, v203
  v_max_f32 v84, v84, v204
  v_max_f32 v85, v85, v205
  v_max_f32 v86, v86, v206
  v_max_f32 v87, v87, v207
  v_pk_fma_f32 v[208:209], v[88:89], s[70:71], v[238:239]
  v_pk_fma_f32 v[210:211], v[90:91], s[70:71], v[238:239]
  v_exp_f32 v208, v208 clamp
  v_exp_f32 v209, v209 clamp
  buffer_load_dwordx4 v195, s[20:23], s82 offen offset:3072 sc1 lds
  v_exp_f32 v210, v210 clamp
  v_exp_f32 v211, v211 clamp
  v_fma_f32 v208, v208, v160, v161
  v_fma_f32 v209, v209, v160, v161
  v_fma_f32 v210, v210, v160, v161
  v_fma_f32 v211, v211, v160, v161
  v_max_f32 v88, v88, v208
  v_max_f32 v89, v89, v209
  v_max_f32 v90, v90, v210
  v_max_f32 v91, v91, v211
  v_cvt_pk_bf16_f32 v212, v80, v81
  v_cvt_pk_bf16_f32 v213, v82, v83
  v_cvt_pk_bf16_f32 v216, v84, v85
  v_cvt_pk_bf16_f32 v217, v86, v87
  v_cvt_pk_bf16_f32 v220, v88, v89
  v_cvt_pk_bf16_f32 v221, v90, v91
  v_cvt_pk_bf16_f32 v224, v92, v93
  v_cvt_pk_bf16_f32 v225, v94, v95
  v_cvt_pk_bf16_f32 v228, v96, v97
  v_cvt_pk_bf16_f32 v229, v98, v99
  v_pk_fma_f32 v[200:201], v[100:101], s[70:71], v[238:239]
  v_pk_fma_f32 v[202:203], v[102:103], s[70:71], v[238:239]
  s_addk_i32 m0, 0x1000
  s_addk_i32 s82, 0x1000
  buffer_load_dwordx4 v195, s[20:23], s82 offen offset:0 sc1 lds
  v_pk_fma_f32 v[204:205], v[104:105], s[70:71], v[238:239]
  v_pk_fma_f32 v[206:207], v[106:107], s[70:71], v[238:239]
  v_exp_f32 v200, v200 clamp
  v_exp_f32 v201, v201 clamp
  v_exp_f32 v202, v202 clamp
  v_exp_f32 v203, v203 clamp
  v_exp_f32 v204, v204 clamp
  v_exp_f32 v205, v205 clamp
  v_exp_f32 v206, v206 clamp
  v_exp_f32 v207, v207 clamp
  v_pk_add_f32 v[200:201], v[200:201], s[74:75]
  v_pk_add_f32 v[202:203], v[202:203], s[74:75]
  v_pk_add_f32 v[204:205], v[204:205], s[74:75]
  v_pk_add_f32 v[206:207], v[206:207], s[74:75]
  v_max_f32 v100, v100, v200
  v_max_f32 v101, v101, v201
  buffer_load_dwordx4 v195, s[20:23], s82 offen offset:1024 sc1 lds
  v_max_f32 v102, v102, v202
  v_max_f32 v103, v103, v203
  v_max_f32 v104, v104, v204
  v_max_f32 v105, v105, v205
  v_max_f32 v106, v106, v206
  v_max_f32 v107, v107, v207
  v_pk_fma_f32 v[208:209], v[108:109], s[70:71], v[238:239]
  v_pk_fma_f32 v[210:211], v[110:111], s[70:71], v[238:239]
  v_exp_f32 v208, v208 clamp
  v_exp_f32 v209, v209 clamp
  v_exp_f32 v210, v210 clamp
  v_exp_f32 v211, v211 clamp
  v_fma_f32 v208, v208, v160, v161
  v_fma_f32 v209, v209, v160, v161
  v_fma_f32 v210, v210, v160, v161
  v_fma_f32 v211, v211, v160, v161
  v_max_f32 v108, v108, v208
  v_max_f32 v109, v109, v209
  v_max_f32 v110, v110, v210
  v_max_f32 v111, v111, v211
  buffer_load_dwordx4 v195, s[20:23], s82 offen offset:2048 sc1 lds
  v_cvt_pk_bf16_f32 v214, v100, v101
  v_cvt_pk_bf16_f32 v215, v102, v103
  v_cvt_pk_bf16_f32 v218, v104, v105
  v_cvt_pk_bf16_f32 v219, v106, v107
  v_cvt_pk_bf16_f32 v222, v108, v109
  v_cvt_pk_bf16_f32 v223, v110, v111
  v_cvt_pk_bf16_f32 v226, v112, v113
  v_cvt_pk_bf16_f32 v227, v114, v115
  v_cvt_pk_bf16_f32 v230, v116, v117
  v_cvt_pk_bf16_f32 v231, v118, v119
  v_mfma_f32_16x16x32_bf16 v[0:3], v[220:223], v[212:215], v[0:3]
  v_pk_fma_f32 v[200:201], v[120:121], s[70:71], v[238:239]
  v_pk_fma_f32 v[202:203], v[122:123], s[70:71], v[238:239]
  v_mfma_f32_16x16x32_bf16 v[4:7], v[224:227], v[212:215], v[4:7]
  v_pk_fma_f32 v[204:205], v[124:125], s[70:71], v[238:239]
  v_pk_fma_f32 v[206:207], v[126:127], s[70:71], v[238:239]
  v_mfma_f32_16x16x32_bf16 v[8:11], v[220:223], v[216:219], v[8:11]
  v_exp_f32 v200, v200 clamp
  v_mfma_f32_16x16x32_bf16 v[12:15], v[224:227], v[216:219], v[12:15]
  buffer_load_dwordx4 v195, s[20:23], s82 offen offset:3072 sc1 lds
  v_exp_f32 v201, v201 clamp
  v_mfma_f32_16x16x32_bf16 v[16:19], v[228:231], v[216:219], v[16:19]
  v_exp_f32 v202, v202 clamp
  v_mfma_f32_16x16x32_bf16 v[20:23], v[224:227], v[220:223], v[20:23]
  v_exp_f32 v203, v203 clamp
  v_mfma_f32_16x16x32_bf16 v[24:27], v[228:231], v[220:223], v[24:27]
  v_exp_f32 v204, v204 clamp
  v_mfma_f32_16x16x32_bf16 v[28:31], v[232:235], v[212:215], v[28:31]
  v_exp_f32 v205, v205 clamp
  v_mfma_f32_16x16x32_bf16 v[32:35], v[232:235], v[216:219], v[32:35]
  v_exp_f32 v206, v206 clamp
  v_mfma_f32_16x16x32_bf16 v[36:39], v[232:235], v[220:223], v[36:39]
  v_exp_f32 v207, v207 clamp
  v_pk_add_f32 v[200:201], v[200:201], s[74:75]
  v_pk_add_f32 v[202:203], v[202:203], s[74:75]
  v_pk_add_f32 v[204:205], v[204:205], s[74:75]
  v_pk_add_f32 v[206:207], v[206:207], s[74:75]
  v_max_f32 v120, v120, v200
  v_max_f32 v121, v121, v201
  v_max_f32 v122, v122, v202
  v_max_f32 v123, v123, v203
  v_max_f32 v124, v124, v204
  v_max_f32 v125, v125, v205
  v_max_f32 v126, v126, v206
  v_max_f32 v127, v127, v207
  v_pk_fma_f32 v[208:209], v[128:129], s[70:71], v[238:239]
  v_pk_fma_f32 v[210:211], v[130:131], s[70:71], v[238:239]
  v_exp_f32 v208, v208 clamp
  v_exp_f32 v209, v209 clamp
  v_exp_f32 v210, v210 clamp
  v_exp_f32 v211, v211 clamp
  v_fma_f32 v208, v208, v160, v161
  v_fma_f32 v209, v209, v160, v161
  v_fma_f32 v210, v210, v160, v161
  v_fma_f32 v211, v211, v160, v161
  v_max_f32 v128, v128, v208
  v_max_f32 v129, v129, v209
  v_max_f32 v130, v130, v210
  v_max_f32 v131, v131, v211
  v_cvt_pk_bf16_f32 v212, v120, v121
  v_cvt_pk_bf16_f32 v213, v122, v123
  v_cvt_pk_bf16_f32 v216, v124, v125
  v_cvt_pk_bf16_f32 v217, v126, v127
  v_cvt_pk_bf16_f32 v220, v128, v129
  v_cvt_pk_bf16_f32 v221, v130, v131
  v_cvt_pk_bf16_f32 v224, v132, v133
  v_cvt_pk_bf16_f32 v225, v134, v135
  v_cvt_pk_bf16_f32 v228, v136, v137
  v_cvt_pk_bf16_f32 v229, v138, v139
  v_pk_fma_f32 v[200:201], v[140:141], s[70:71], v[238:239]
  v_pk_fma_f32 v[202:203], v[142:143], s[70:71], v[238:239]
  v_pk_fma_f32 v[204:205], v[144:145], s[70:71], v[238:239]
  v_pk_fma_f32 v[206:207], v[146:147], s[70:71], v[238:239]
  v_exp_f32 v200, v200 clamp
  v_exp_f32 v201, v201 clamp
  v_exp_f32 v202, v202 clamp
  v_exp_f32 v203, v203 clamp
  v_exp_f32 v204, v204 clamp
  v_exp_f32 v205, v205 clamp
  v_exp_f32 v206, v206 clamp
  v_exp_f32 v207, v207 clamp
  v_pk_add_f32 v[200:201], v[200:201], s[74:75]
  v_pk_add_f32 v[202:203], v[202:203], s[74:75]
  v_pk_add_f32 v[204:205], v[204:205], s[74:75]
  v_pk_add_f32 v[206:207], v[206:207], s[74:75]
  v_max_f32 v140, v140, v200
  v_max_f32 v141, v141, v201
  v_max_f32 v142, v142, v202
  v_max_f32 v143, v143, v203
  v_max_f32 v144, v144, v204
  v_max_f32 v145, v145, v205
  v_max_f32 v146, v146, v206
  v_max_f32 v147, v147, v207
  v_pk_fma_f32 v[208:209], v[148:149], s[70:71], v[238:239]
  v_pk_fma_f32 v[210:211], v[150:151], s[70:71], v[238:239]
  v_exp_f32 v208, v208 clamp
  v_exp_f32 v209, v209 clamp
  v_exp_f32 v210, v210 clamp
  v_exp_f32 v211, v211 clamp
  v_fma_f32 v208, v208, v160, v161
  v_fma_f32 v209, v209, v160, v161
  v_fma_f32 v210, v210, v160, v161
  v_fma_f32 v211, v211, v160, v161
  v_max_f32 v148, v148, v208
  v_max_f32 v149, v149, v209
  v_max_f32 v150, v150, v210
  v_max_f32 v151, v151, v211
  v_cvt_pk_bf16_f32 v214, v140, v141
  v_cvt_pk_bf16_f32 v215, v142, v143
  v_cvt_pk_bf16_f32 v218, v144, v145
  v_cvt_pk_bf16_f32 v219, v146, v147
  v_cvt_pk_bf16_f32 v222, v148, v149
  v_cvt_pk_bf16_f32 v223, v150, v151
  v_cvt_pk_bf16_f32 v226, v152, v153
  v_cvt_pk_bf16_f32 v227, v154, v155
  v_cvt_pk_bf16_f32 v230, v156, v157
  v_cvt_pk_bf16_f32 v231, v158, v159
  v_mfma_f32_16x16x32_bf16 v[0:3], v[220:223], v[212:215], v[0:3]
  v_mfma_f32_16x16x32_bf16 v[4:7], v[224:227], v[212:215], v[4:7]
  v_mfma_f32_16x16x32_bf16 v[8:11], v[220:223], v[216:219], v[8:11]
  v_mfma_f32_16x16x32_bf16 v[12:15], v[224:227], v[216:219], v[12:15]
  v_mfma_f32_16x16x32_bf16 v[16:19], v[228:231], v[216:219], v[16:19]
  v_mfma_f32_16x16x32_bf16 v[20:23], v[224:227], v[220:223], v[20:23]
  v_mfma_f32_16x16x32_bf16 v[24:27], v[228:231], v[220:223], v[24:27]
  v_mfma_f32_16x16x32_bf16 v[28:31], v[232:235], v[212:215], v[28:31]
  v_mfma_f32_16x16x32_bf16 v[32:35], v[232:235], v[216:219], v[32:35]
  v_mfma_f32_16x16x32_bf16 v[36:39], v[232:235], v[220:223], v[36:39]
  v_add_u32 v200, s85, v195
  v_mov_b32 v202, 2147418112
  v_cmp_gt_u32 vcc, 56, v164
  s_nop 1
  v_cndmask_b32 v201, v202, v195, vcc
  ds_write_b128 v185, v[0:3]
  ds_write_b128 v186, v[4:7]
  ds_write_b128 v187, v[8:11]
  ds_write_b128 v188, v[12:15]
  ds_write_b128 v189, v[16:19]
  ds_write_b128 v190, v[20:23]
  ds_write_b128 v191, v[24:27]
  ds_write_b128 v192, v[28:31]
  ds_write_b128 v193, v[32:35]
  ds_write_b128 v194, v[36:39]
  s_lshl_b32 s53, s7, 2
  s_add_u32 s53, s53, s42
  s_mul_i32 s53, s53, 80
  s_add_u32 s53, s53, 14692352
  s_waitcnt lgkmcnt(0)
  s_barrier
  ds_read_b128 v[40:43], v200 offset:0
  ds_read_b128 v[44:47], v200 offset:1024
  ds_read_b128 v[48:51], v200 offset:7680
  ds_read_b128 v[52:55], v200 offset:8704
  s_waitcnt lgkmcnt(0)
  v_pk_add_f32 v[40:41], v[40:41], v[48:49]
  v_pk_add_f32 v[42:43], v[42:43], v[50:51]
  v_pk_add_f32 v[44:45], v[44:45], v[52:53]
  v_pk_add_f32 v[46:47], v[46:47], v[54:55]
  buffer_atomic_add_f32 v40, v248, s[20:23], s53 offen sc1
  buffer_atomic_add_f32 v44, v249, s[20:23], s53 offen sc1
  buffer_store_dwordx4 v[40:43], v195, s[20:23], s84 offen sc1
  buffer_store_dwordx4 v[44:47], v201, s[20:23], s84 offen offset:1024 sc1
  s_addk_i32 m0, 0x1000
  s_addk_i32 s82, 0x1000
  s_nop 0
  buffer_load_dwordx4 v195, s[20:23], s82 offen offset:0 sc1 lds
  buffer_load_dwordx4 v195, s[20:23], s82 offen offset:1024 sc1 lds
  buffer_load_dwordx4 v195, s[20:23], s82 offen offset:2048 sc1 lds
  buffer_load_dwordx4 v195, s[20:23], s82 offen offset:3072 sc1 lds
  s_addk_i32 m0, 0x1000
  s_addk_i32 s82, 0x1000
  s_nop 0
  buffer_load_dwordx4 v195, s[20:23], s82 offen offset:0 sc1 lds
  buffer_load_dwordx4 v195, s[20:23], s82 offen offset:1024 sc1 lds
L_p2:
  s_lshl_b32 s54, s80, 1
  s_mul_i32 s3, s54, 205
  s_lshr_b32 s3, s3, 10
  s_add_u32 s54, s54, 1
  s_mul_i32 s4, s54, 205
  s_lshr_b32 s4, s4, 10
  s_mul_i32 s3, s3, 12
  s_add_u32 s3, s3, 96
  s_mul_i32 s4, s4, 12
  s_add_u32 s4, s4, 84
  v_min_u32 v244, 23, v164
  v_add_u32 v245, s4, v244
  v_add_u32 v246, s3, v244
  v_cmp_gt_u32 vcc, 12, v164
  s_nop 1
  v_cndmask_b32 v246, v245, v246, vcc
  s_sub_u32 s79, s48, 128
  s_lshr_b32 s95, s48, 4
  s_lshl_b32 s95, s95, 3
  s_and_b32 s53, s79, 3
  s_lshl_b32 s53, s53, 4
  s_lshr_b32 s54, s79, 4
  s_lshl_b32 s54, s54, 2
  s_add_u32 s54, s54, 64
  s_cmp_lt_u32 s48, 128
  s_cselect_b32 s94, 7, 15
  s_cselect_b32 s95, s95, s53
  v_and_b32 v245, 3, v164
  v_add_u32 v245, s54, v245
  v_lshlrev_b32 v198, 8, v245
  v_add_u32 v198, 14712832, v198
  v_and_b32 v245, s94, v164
  v_add_u32 v245, s95, v245
  v_cmp_gt_u32 vcc, 32, v164
  s_nop 1
  v_cndmask_b32 v246, v245, v246, vcc
  v_lshlrev_b32 v174, 8, v246
  v_add_u32 v174, 14712832, v174
  s_cmp_lt_u32 s48, 128
  s_cbranch_scc1 L_p2_lq0
  s_cmp_lg_u32 s42, 1
  s_cbranch_scc1 L_p2_lq0
  buffer_load_dword v175, v198, s[20:23], 0 offen sc1
L_p2_lq0:
  s_mov_b32 s8, s96
  s_mov_b32 s9, s97
  s_mov_b32 s10, 2621440
  s_mov_b32 s11, 0x00020000
  s_xor_b32 s53, s42, 0
  s_lshl_b32 s53, s53, 10
  v_add_u32 v165, s53, v195
  s_xor_b32 s53, s42, 1
  s_lshl_b32 s53, s53, 10
  v_add_u32 v166, s53, v195
  s_xor_b32 s53, s42, 2
  s_lshl_b32 s53, s53, 10
  v_add_u32 v167, s53, v195
  s_xor_b32 s53, s42, 3
  s_lshl_b32 s53, s53, 10
  v_add_u32 v168, s53, v195
  s_mul_i32 s53, s80, 68
  s_mul_i32 s54, s42, 12
  s_add_u32 s54, s54, s53
  s_lshl_b32 s44, s54, 12
  s_mul_i32 s54, s42, 5
  s_add_u32 s54, s54, s53
  s_add_u32 s54, s54, 48
  s_lshl_b32 s45, s54, 12
  s_waitcnt vmcnt(6)
  s_barrier
  s_cmp_lg_u32 s42, 0
  s_cbranch_scc1 L_p2_sig1
  s_mov_b64 exec, 1
  buffer_store_dword v196, off, s[20:23], s83 sc1
  s_mov_b64 exec, -1
L_p2_sig1:
  s_cmp_ge_u32 s48, 128
  s_cbranch_scc1 L_p2_lh
  s_cmp_lg_u32 s42, 1
  s_cbranch_scc1 L_p2_lh
  buffer_load_dword v175, v174, s[20:23], 0 offen sc1
L_p2_lh:
  s_lshr_b32 s54, s81, 1
  s_lshl_b32 s54, s54, 13
  s_add_u32 s54, s54, 14778368
  v_and_b32 v244, 31, v164
  v_lshl_add_u32 v194, v244, 8, s54
  s_lshl_b32 s53, s80, 10
  s_add_u32 s53, s53, 14811136
  v_and_b32 v245, 3, v164
  v_lshl_add_u32 v193, v245, 8, s53
  v_cmp_gt_u32 vcc, 32, v164
  s_nop 1
  v_cndmask_b32 v194, v193, v194, vcc
  s_mul_i32 s3, s81, 20
  s_mul_i32 s4, s42, 5
  s_add_u32 s3, s3, s4
  s_mul_i32 s3, s3, 5120
  s_add_u32 s88, s3, 11403264
  s_add_u32 s89, s88, 4096
  s_mov_b32 s3, 0
  s_lshl_b32 s4, s3, 12
  s_add_u32 s84, s45, s4
  s_mul_i32 s4, s3, 5120
  s_add_u32 s82, s88, s4
  s_add_u32 s3, s3, 1
  s_cmp_eq_u32 s3, 5
  s_cselect_b32 s3, 0, s3
  s_lshl_b32 s4, s3, 12
  s_add_u32 s85, s45, s4
  s_mul_i32 s4, s3, 5120
  s_add_u32 s58, s88, s4
  s_add_u32 s3, s3, 1
  s_cmp_eq_u32 s3, 5
  s_cselect_b32 s3, 0, s3
  s_lshl_b32 s4, s3, 12
  s_add_u32 s86, s45, s4
  s_mul_i32 s4, s3, 5120
  s_add_u32 s59, s88, s4
  s_add_u32 s3, s3, 1
  s_cmp_eq_u32 s3, 5
  s_cselect_b32 s3, 0, s3
  s_lshl_b32 s4, s3, 12
  s_add_u32 s87, s45, s4
  s_mul_i32 s4, s3, 5120
  s_add_u32 s6, s88, s4
  s_add_u32 s3, s3, 1
  s_cmp_eq_u32 s3, 5
  s_cselect_b32 s3, 0, s3
  s_lshl_b32 s4, s3, 12
  s_add_u32 s49, s45, s4
  s_mul_i32 s4, s3, 5120
  s_add_u32 s7, s88, s4
  v_add_u32 v199, 4096, v195
  s_mul_i32 s3, s42, 30720
  v_add_u32 v192, s3, v195
  v_and_b32 v197, 15, v164
  v_lshlrev_b32 v197, 2, v197
  s_lshl_b32 s3, s80, 2
  s_xor_b32 s5, s42, 0
  s_add_u32 s5, s5, s3
  s_lshl_b32 s5, s5, 6
  s_add_u32 s90, s5, 14680064
  s_xor_b32 s5, s42, 1
  s_add_u32 s5, s5, s3
  s_lshl_b32 s5, s5, 6
  s_add_u32 s91, s5, 14680064
  s_xor_b32 s5, s42, 2
  s_add_u32 s5, s5, s3
  s_lshl_b32 s5, s5, 6
  s_add_u32 s92, s5, 14680064
  s_xor_b32 s5, s42, 3
  s_add_u32 s5, s5, s3
  s_lshl_b32 s5, s5, 6
  s_add_u32 s93, s5, 14680064
  s_xor_b32 s3, s42, 1
  s_mul_i32 s3, s3, 30720
  v_add_u32 v161, s3, v195
  s_xor_b32 s3, s42, 2
  s_mul_i32 s3, s3, 30720
  v_add_u32 v162, s3, v195
  s_xor_b32 s3, s42, 3
  s_mul_i32 s3, s3, 30720
  v_add_u32 v163, s3, v195
  v_mov_b32 v173, 2147418112
  v_mov_b32 v203, 2147418112
  s_cmp_ge_u32 s48, 128
  s_cbranch_scc1 L_p2_nomset
  s_lshr_b32 s79, s48, 2
  s_lshr_b32 s50, s79, 3
  s_bfe_u32 s51, s79, 0x20001
  s_and_b32 s52, s79, 1
  s_and_b32 s54, s42, 1
  v_mov_b32 v207, 2147418112
  v_cmp_gt_u32 vcc, 56, v164
  s_nop 1
  v_cndmask_b32 v203, v207, v195, vcc
  v_and_b32 v200, 15, v164
  v_lshrrev_b32 v201, 4, v164
  s_lshl_b32 s3, s42, 11
  s_add_u32 s3, s3, 122880
  v_add_u32 v208, s3, v195
  s_lshl_b32 s3, s54, 4
  v_add_u32 v202, s3, v200
  v_mul_u32_u24 v209, 96, v202
  v_lshl_add_u32 v209, v201, 5, v209
  v_cmp_gt_u32 vcc, 20, v202
  v_cmp_gt_u32 s[76:77], 3, v201
  s_nop 0
  s_and_b64 s[76:77], s[76:77], vcc
  v_mov_b32 v210, 1920
  v_cndmask_b32 v209, v210, v209, s[76:77]
  v_add_u32 v209, 122880, v209
  s_lshl_b32 s3, s54, 2
  v_add_u32 v204, s3, v201
  s_mul_i32 s4, s52, 5
  v_add_u32 v205, s4, v204
  v_lshrrev_b32 v206, 1, v205
  v_mul_u32_u24 v206, 5120, v206
  v_xor_b32 v205, s51, v205
  v_and_b32 v205, 1, v205
  v_lshl_add_u32 v206, v205, 3, v206
  v_lshl_add_u32 v206, v200, 4, v206
  v_cmp_gt_u32 vcc, 5, v204
  s_nop 1
  v_cndmask_b32 v173, v207, v206, vcc
  s_and_b32 s5, s48, 3
  s_lshl_b32 s3, s5, 1
  s_lshr_b32 s4, s42, 1
  s_add_u32 s3, s3, s4
  s_mul_i32 s3, s3, 20
  s_mul_i32 s4, s50, 5
  s_add_u32 s3, s3, s4
  s_mul_i32 s3, s3, 5120
  s_lshl_b32 s4, s51, 8
  s_add_u32 s3, s3, s4
  s_add_u32 s55, s3, 11403264
  s_add_u32 s46, s55, 4096
  s_lshl_b32 s3, s5, 5
  s_add_u32 s3, s3, s79
  s_lshl_b32 s3, s3, 8
  s_add_u32 s56, s3, 14778368
  s_lshl_b32 s3, s42, 6
  s_add_u32 s3, s3, s79
  s_mul_i32 s3, s3, 1920
  s_add_u32 s47, s3, 13697024
  s_add_u32 s43, s47, 61440
  s_branch L_p2_setdone
L_p2_nomset:
  v_lshrrev_b32 v200, 4, v164
  s_lshl_b32 s3, s42, 11
  s_add_u32 s3, s3, 122880
  v_mul_u32_u24 v202, 160, v200
  v_add_u32 v202, s3, v202
  v_and_b32 v200, 1, v200
  v_cmp_eq_u32 s[76:77], 1, v200
  v_lshl_add_u32 v252, v200, 4, v202
  v_xor_b32 v253, 16, v252
  v_add_u32 v208, s3, v195
  v_mov_b32 v209, 2147418112
  v_cmp_gt_u32 vcc, 40, v164
  s_nop 1
  v_cndmask_b32 v203, v209, v195, vcc
  s_mov_b32 s78, 0xffff0000
  s_and_b32 s5, s79, 3
  s_lshr_b32 s4, s79, 2
  s_mul_i32 s43, s5, 640
  s_add_u32 s43, s43, 14692352
  s_mul_i32 s5, s5, 5
  s_lshl_b32 s54, s42, 10
  s_mul_i32 s3, s4, 20
  s_add_u32 s3, s3, s5
  s_lshl_b32 s3, s3, 12
  s_add_u32 s3, s3, s54
  s_add_u32 s46, s3, 16777216
  s_mul_i32 s3, s4, 68
  s_add_u32 s3, s3, s5
  s_add_u32 s3, s3, 48
  s_lshl_b32 s3, s3, 12
  s_add_u32 s47, s3, s54
  s_lshl_b32 s3, s4, 2
  s_add_u32 s3, s3, s42
  s_lshl_b32 s3, s3, 6
  s_add_u32 s55, s3, 14680064
  s_lshl_b32 s3, s48, 8
  s_add_u32 s56, s3, 14778368
  s_cmp_lg_u32 s42, 1
  s_cbranch_scc1 L_fq_ok
  s_waitcnt vmcnt(0)
  s_mov_b32 s57, 0
L_fq_poll:
  v_cmp_eq_u32 vcc, s100, v175
  s_nop 0
  s_cmp_eq_u64 vcc, -1
  s_cbranch_scc1 L_fq_ok
  s_add_u32 s57, s57, 1
  s_cmp_gt_u32 s57, 131072
  s_cbranch_scc1 L_fq_ok
  s_sleep 1
  buffer_load_dword v175, v198, s[20:23], 0 offen sc1
  s_waitcnt vmcnt(0)
  s_branch L_fq_poll
L_fq_ok:
  s_barrier
  buffer_load_dword v184, v197, s[20:23], s55 offen sc1
  buffer_load_dwordx4 v[140:143], v195, s[20:23], s46 offen sc1
  s_addk_i32 s46, 0x1000
  buffer_load_dwordx4 v[144:147], v195, s[20:23], s46 offen sc1
  s_addk_i32 s46, 0x1000
  buffer_load_dwordx4 v[148:151], v195, s[20:23], s46 offen sc1
  s_addk_i32 s46, 0x1000
  buffer_load_dwordx4 v[152:155], v195, s[20:23], s46 offen sc1
  s_addk_i32 s46, 0x1000
  buffer_load_dwordx4 v[156:159], v195, s[20:23], s46 offen sc1
  s_addk_i32 s46, 0x1000
  s_mov_b32 s70, 1069066811
  s_mov_b32 s71, 1069066811
  s_mov_b32 s72, 1065353224
  s_mov_b32 s73, 1065353224
  s_mov_b32 s74, 897988541
  s_mov_b32 s75, 897988541
  s_waitcnt vmcnt(4)
  v_lshlrev_b32 v0, 16, v140
  v_and_b32 v1, s78, v140
  v_lshlrev_b32 v2, 16, v141
  v_and_b32 v3, s78, v141
  v_lshlrev_b32 v4, 16, v142
  v_and_b32 v5, s78, v142
  v_lshlrev_b32 v6, 16, v143
  v_and_b32 v7, s78, v143
  v_pk_mul_f32 v[40:41], v[0:1], s[70:71]
  v_pk_mul_f32 v[42:43], v[2:3], s[70:71]
  v_pk_mul_f32 v[44:45], v[4:5], s[70:71]
  v_pk_mul_f32 v[46:47], v[6:7], s[70:71]
  v_exp_f32 v40, v40 clamp
  v_exp_f32 v41, v41 clamp
  v_exp_f32 v42, v42 clamp
  v_exp_f32 v43, v43 clamp
  v_exp_f32 v44, v44 clamp
  v_exp_f32 v45, v45 clamp
  v_exp_f32 v46, v46 clamp
  v_exp_f32 v47, v47 clamp
  v_pk_add_f32 v[0:1], v[0:1], s[72:73]
  v_pk_add_f32 v[2:3], v[2:3], s[72:73]
  v_pk_add_f32 v[4:5], v[4:5], s[72:73]
  v_pk_add_f32 v[6:7], v[6:7], s[72:73]
  v_pk_add_f32 v[40:41], v[40:41], s[74:75]
  v_pk_add_f32 v[42:43], v[42:43], s[74:75]
  v_pk_add_f32 v[44:45], v[44:45], s[74:75]
  v_pk_add_f32 v[46:47], v[46:47], s[74:75]
  v_max_f32 v0, v0, v40
  v_max_f32 v1, v1, v41
  v_max_f32 v2, v2, v42
  v_max_f32 v3, v3, v43
  v_max_f32 v4, v4, v44
  v_max_f32 v5, v5, v45
  v_max_f32 v6, v6, v46
  v_max_f32 v7, v7, v47
  s_waitcnt vmcnt(3)
  v_lshlrev_b32 v8, 16, v144
  v_and_b32 v9, s78, v144
  v_lshlrev_b32 v10, 16, v145
  v_and_b32 v11, s78, v145
  v_lshlrev_b32 v12, 16, v146
  v_and_b32 v13, s78, v146
  v_lshlrev_b32 v14, 16, v147
  v_and_b32 v15, s78, v147
  v_pk_mul_f32 v[48:49], v[8:9], s[70:71]
  v_pk_mul_f32 v[50:51], v[10:11], s[70:71]
  v_pk_mul_f32 v[52:53], v[12:13], s[70:71]
  v_pk_mul_f32 v[54:55], v[14:15], s[70:71]
  v_exp_f32 v48, v48 clamp
  v_exp_f32 v49, v49 clamp
  v_exp_f32 v50, v50 clamp
  v_exp_f32 v51, v51 clamp
  v_exp_f32 v52, v52 clamp
  v_exp_f32 v53, v53 clamp
  v_exp_f32 v54, v54 clamp
  v_exp_f32 v55, v55 clamp
  v_pk_add_f32 v[8:9], v[8:9], s[72:73]
  v_pk_add_f32 v[10:11], v[10:11], s[72:73]
  v_pk_add_f32 v[12:13], v[12:13], s[72:73]
  v_pk_add_f32 v[14:15], v[14:15], s[72:73]
  v_pk_add_f32 v[48:49], v[48:49], s[74:75]
  v_pk_add_f32 v[50:51], v[50:51], s[74:75]
  v_pk_add_f32 v[52:53], v[52:53], s[74:75]
  v_pk_add_f32 v[54:55], v[54:55], s[74:75]
  v_max_f32 v8, v8, v48
  v_max_f32 v9, v9, v49
  v_max_f32 v10, v10, v50
  v_max_f32 v11, v11, v51
  v_max_f32 v12, v12, v52
  v_max_f32 v13, v13, v53
  v_max_f32 v14, v14, v54
  v_max_f32 v15, v15, v55
  s_waitcnt vmcnt(2)
  v_lshlrev_b32 v16, 16, v148
  v_and_b32 v17, s78, v148
  v_lshlrev_b32 v18, 16, v149
  v_and_b32 v19, s78, v149
  v_lshlrev_b32 v20, 16, v150
  v_and_b32 v21, s78, v150
  v_lshlrev_b32 v22, 16, v151
  v_and_b32 v23, s78, v151
  v_pk_mul_f32 v[56:57], v[16:17], s[70:71]
  v_pk_mul_f32 v[58:59], v[18:19], s[70:71]
  v_pk_mul_f32 v[60:61], v[20:21], s[70:71]
  v_pk_mul_f32 v[62:63], v[22:23], s[70:71]
  v_exp_f32 v56, v56 clamp
  v_exp_f32 v57, v57 clamp
  v_exp_f32 v58, v58 clamp
  v_exp_f32 v59, v59 clamp
  v_exp_f32 v60, v60 clamp
  v_exp_f32 v61, v61 clamp
  v_exp_f32 v62, v62 clamp
  v_exp_f32 v63, v63 clamp
  v_pk_add_f32 v[16:17], v[16:17], s[72:73]
  v_pk_add_f32 v[18:19], v[18:19], s[72:73]
  v_pk_add_f32 v[20:21], v[20:21], s[72:73]
  v_pk_add_f32 v[22:23], v[22:23], s[72:73]
  v_pk_add_f32 v[56:57], v[56:57], s[74:75]
  v_pk_add_f32 v[58:59], v[58:59], s[74:75]
  v_pk_add_f32 v[60:61], v[60:61], s[74:75]
  v_pk_add_f32 v[62:63], v[62:63], s[74:75]
  v_max_f32 v16, v16, v56
  v_max_f32 v17, v17, v57
  v_max_f32 v18, v18, v58
  v_max_f32 v19, v19, v59
  v_max_f32 v20, v20, v60
  v_max_f32 v21, v21, v61
  v_max_f32 v22, v22, v62
  v_max_f32 v23, v23, v63
  s_waitcnt vmcnt(1)
  v_lshlrev_b32 v24, 16, v152
  v_and_b32 v25, s78, v152
  v_lshlrev_b32 v26, 16, v153
  v_and_b32 v27, s78, v153
  v_lshlrev_b32 v28, 16, v154
  v_and_b32 v29, s78, v154
  v_lshlrev_b32 v30, 16, v155
  v_and_b32 v31, s78, v155
  v_pk_mul_f32 v[64:65], v[24:25], s[70:71]
  v_pk_mul_f32 v[66:67], v[26:27], s[70:71]
  v_pk_mul_f32 v[68:69], v[28:29], s[70:71]
  v_pk_mul_f32 v[70:71], v[30:31], s[70:71]
  v_exp_f32 v64, v64 clamp
  v_exp_f32 v65, v65 clamp
  v_exp_f32 v66, v66 clamp
  v_exp_f32 v67, v67 clamp
  v_exp_f32 v68, v68 clamp
  v_exp_f32 v69, v69 clamp
  v_exp_f32 v70, v70 clamp
  v_exp_f32 v71, v71 clamp
  v_pk_add_f32 v[24:25], v[24:25], s[72:73]
  v_pk_add_f32 v[26:27], v[26:27], s[72:73]
  v_pk_add_f32 v[28:29], v[28:29], s[72:73]
  v_pk_add_f32 v[30:31], v[30:31], s[72:73]
  v_pk_add_f32 v[64:65], v[64:65], s[74:75]
  v_pk_add_f32 v[66:67], v[66:67], s[74:75]
  v_pk_add_f32 v[68:69], v[68:69], s[74:75]
  v_pk_add_f32 v[70:71], v[70:71], s[74:75]
  v_max_f32 v24, v24, v64
  v_max_f32 v25, v25, v65
  v_max_f32 v26, v26, v66
  v_max_f32 v27, v27, v67
  v_max_f32 v28, v28, v68
  v_max_f32 v29, v29, v69
  v_max_f32 v30, v30, v70
  v_max_f32 v31, v31, v71
  s_waitcnt vmcnt(0)
  s_cmp_lg_u32 s42, 1
  s_cbranch_scc1 L_p2_lh2
  buffer_load_dword v175, v174, s[20:23], 0 offen sc1
L_p2_lh2:
  v_lshlrev_b32 v32, 16, v156
  v_and_b32 v33, s78, v156
  v_lshlrev_b32 v34, 16, v157
  v_and_b32 v35, s78, v157
  v_lshlrev_b32 v36, 16, v158
  v_and_b32 v37, s78, v158
  v_lshlrev_b32 v38, 16, v159
  v_and_b32 v39, s78, v159
  v_pk_mul_f32 v[72:73], v[32:33], s[70:71]
  v_pk_mul_f32 v[74:75], v[34:35], s[70:71]
  v_pk_mul_f32 v[76:77], v[36:37], s[70:71]
  v_pk_mul_f32 v[78:79], v[38:39], s[70:71]
  v_exp_f32 v72, v72 clamp
  v_exp_f32 v73, v73 clamp
  v_exp_f32 v74, v74 clamp
  v_exp_f32 v75, v75 clamp
  v_exp_f32 v76, v76 clamp
  v_exp_f32 v77, v77 clamp
  v_exp_f32 v78, v78 clamp
  v_exp_f32 v79, v79 clamp
  v_pk_add_f32 v[32:33], v[32:33], s[72:73]
  v_pk_add_f32 v[34:35], v[34:35], s[72:73]
  v_pk_add_f32 v[36:37], v[36:37], s[72:73]
  v_pk_add_f32 v[38:39], v[38:39], s[72:73]
  v_pk_add_f32 v[72:73], v[72:73], s[74:75]
  v_pk_add_f32 v[74:75], v[74:75], s[74:75]
  v_pk_add_f32 v[76:77], v[76:77], s[74:75]
  v_pk_add_f32 v[78:79], v[78:79], s[74:75]
  v_max_f32 v32, v32, v72
  v_max_f32 v33, v33, v73
  v_max_f32 v34, v34, v74
  v_max_f32 v35, v35, v75
  v_max_f32 v36, v36, v76
  v_max_f32 v37, v37, v77
  v_max_f32 v38, v38, v78
  v_max_f32 v39, v39, v79
L_p2_setdone:
  s_cmp_lg_u32 s42, 1
  s_cbranch_scc1 L_fh_ok
  s_waitcnt vmcnt(0)
  s_mov_b32 s57, 0
L_fh_poll:
  v_cmp_eq_u32 vcc, s100, v175
  s_nop 0
  s_cmp_eq_u64 vcc, -1
  s_cbranch_scc1 L_fh_ok
  s_add_u32 s57, s57, 1
  s_cmp_gt_u32 s57, 131072
  s_cbranch_scc1 L_fh_ok
  s_sleep 1
  buffer_load_dword v175, v174, s[20:23], 0 offen sc1
  s_waitcnt vmcnt(0)
  s_branch L_fh_poll
L_fh_ok:
  s_barrier
  s_cmp_ge_u32 s48, 128
  s_cbranch_scc1 L_p2_sblk
  buffer_load_dwordx4 v[80:83], v195, s[20:23], s47 offen sc1
  buffer_load_dwordx4 v[84:87], v203, s[20:23], s47 offen offset:1024 sc1
  buffer_load_dwordx4 v[88:91], v195, s[20:23], s43 offen sc1
  buffer_load_dwordx4 v[92:95], v203, s[20:23], s43 offen offset:1024 sc1
  buffer_load_dwordx4 a[0:3], v165, s[20:23], s44 offen sc1
  buffer_load_dwordx4 a[4:7], v166, s[20:23], s44 offen sc1
  buffer_load_dwordx4 a[8:11], v167, s[20:23], s44 offen sc1
  buffer_load_dwordx4 a[12:15], v168, s[20:23], s44 offen sc1
  s_addk_i32 s44, 0x1000
  buffer_load_dwordx4 a[16:19], v165, s[20:23], s44 offen sc1
  buffer_load_dwordx4 a[20:23], v166, s[20:23], s44 offen sc1
  buffer_load_dwordx4 a[24:27], v167, s[20:23], s44 offen sc1
  buffer_load_dwordx4 a[28:31], v168, s[20:23], s44 offen sc1
  s_addk_i32 s44, 0x1000
  s_waitcnt vmcnt(8)
  v_pk_add_f32 v[80:81], v[80:81], v[88:89]
  v_pk_add_f32 v[82:83], v[82:83], v[90:91]
  v_pk_add_f32 v[84:85], v[84:85], v[92:93]
  v_pk_add_f32 v[86:87], v[86:87], v[94:95]
  ds_write_b128 v208, v[80:83]
  ds_write_b128 v208, v[84:87] offset:1024
  buffer_load_dwordx4 a[32:35], v165, s[20:23], s44 offen sc1
  buffer_load_dwordx4 a[36:39], v166, s[20:23], s44 offen sc1
  s_waitcnt lgkmcnt(0)
  s_barrier
  ds_read_b128 v[80:83], v209 offset:0
  ds_read_b128 v[84:87], v209 offset:16
  ds_read_b128 v[88:91], v209 offset:2048
  ds_read_b128 v[92:95], v209 offset:2064
  ds_read_b128 v[96:99], v209 offset:4096
  ds_read_b128 v[100:103], v209 offset:4112
  ds_read_b128 v[104:107], v209 offset:6144
  ds_read_b128 v[108:111], v209 offset:6160
  buffer_load_dwordx4 a[40:43], v167, s[20:23], s44 offen sc1
  buffer_load_dwordx4 a[44:47], v168, s[20:23], s44 offen sc1
  s_addk_i32 s44, 0x1000
  s_waitcnt lgkmcnt(0)
  v_pk_add_f32 v[80:81], v[80:81], v[88:89]
  v_pk_add_f32 v[96:97], v[96:97], v[104:105]
  v_pk_add_f32 v[82:83], v[82:83], v[90:91]
  v_pk_add_f32 v[98:99], v[98:99], v[106:107]
  v_pk_add_f32 v[84:85], v[84:85], v[92:93]
  v_pk_add_f32 v[100:101], v[100:101], v[108:109]
  v_pk_add_f32 v[86:87], v[86:87], v[94:95]
  v_pk_add_f32 v[102:103], v[102:103], v[110:111]
  v_pk_add_f32 v[80:81], v[80:81], v[96:97]
  v_pk_add_f32 v[82:83], v[82:83], v[98:99]
  v_pk_add_f32 v[84:85], v[84:85], v[100:101]
  v_pk_add_f32 v[86:87], v[86:87], v[102:103]
  v_cvt_pk_bf16_f32 v204, v80, v81
  v_cvt_pk_bf16_f32 v205, v82, v83
  v_cvt_pk_bf16_f32 v206, v84, v85
  v_cvt_pk_bf16_f32 v207, v86, v87
  s_nop 1
  v_mfma_f32_16x16x32_bf16 v[80:83], v[204:207], a[240:243], 0
  v_mfma_f32_16x16x32_bf16 v[84:87], v[204:207], a[244:247], 0
  v_mfma_f32_16x16x32_bf16 v[88:91], v[204:207], a[248:251], 0
  v_mfma_f32_16x16x32_bf16 v[92:95], v[204:207], a[252:255], 0
  v_mfma_f32_16x16x32_bf16 v[96:99], v[204:207], a[112:115], 0
  s_nop 3
  v_cvt_pk_bf16_f32 v176, v80, v81
  v_cvt_pk_bf16_f32 v177, v82, v83
  buffer_store_dwordx2 v[176:177], v173, s[20:23], s55 offen offset:0 sc1
  v_cvt_pk_bf16_f32 v178, v84, v85
  v_cvt_pk_bf16_f32 v179, v86, v87
  buffer_store_dwordx2 v[178:179], v173, s[20:23], s55 offen offset:1024 sc1
  v_cvt_pk_bf16_f32 v180, v88, v89
  v_cvt_pk_bf16_f32 v181, v90, v91
  buffer_store_dwordx2 v[180:181], v173, s[20:23], s55 offen offset:2048 sc1
  v_cvt_pk_bf16_f32 v182, v92, v93
  v_cvt_pk_bf16_f32 v183, v94, v95
  buffer_store_dwordx2 v[182:183], v173, s[20:23], s55 offen offset:3072 sc1
  v_cvt_pk_bf16_f32 v184, v96, v97
  v_cvt_pk_bf16_f32 v185, v98, v99
  buffer_store_dwordx2 v[184:185], v173, s[20:23], s46 offen offset:0 sc1
  s_branch L_p2_blk_done
L_p2_sblk:
  buffer_load_dwordx4 v[140:143], v203, s[20:23], s43 offen sc1
  buffer_load_dwordx4 a[0:3], v165, s[20:23], s44 offen sc1
  buffer_load_dwordx4 a[4:7], v166, s[20:23], s44 offen sc1
  buffer_load_dwordx4 a[8:11], v167, s[20:23], s44 offen sc1
  buffer_load_dwordx4 a[12:15], v168, s[20:23], s44 offen sc1
  s_addk_i32 s44, 0x1000
  buffer_load_dwordx4 a[16:19], v165, s[20:23], s44 offen sc1
  buffer_load_dwordx4 a[20:23], v166, s[20:23], s44 offen sc1
  s_waitcnt vmcnt(6)
  ds_write_b128 v208, v[140:143]
  ds_read_b128 v[80:83], v252 offset:0
  ds_read_b128 v[84:87], v253 offset:0
  ds_read_b128 v[88:91], v252 offset:32
  ds_read_b128 v[92:95], v253 offset:32
  ds_read_b128 v[96:99], v252 offset:64
  ds_read_b128 v[100:103], v253 offset:64
  ds_read_b128 v[104:107], v252 offset:96
  ds_read_b128 v[108:111], v253 offset:96
  ds_read_b128 v[112:115], v252 offset:128
  ds_read_b128 v[116:119], v253 offset:128
  buffer_load_dwordx4 a[24:27], v167, s[20:23], s44 offen sc1
  buffer_load_dwordx4 a[28:31], v168, s[20:23], s44 offen sc1
  s_addk_i32 s44, 0x1000
  buffer_load_dwordx4 a[32:35], v165, s[20:23], s44 offen sc1
  buffer_load_dwordx4 a[36:39], v166, s[20:23], s44 offen sc1
  buffer_load_dwordx4 a[40:43], v167, s[20:23], s44 offen sc1
  buffer_load_dwordx4 a[44:47], v168, s[20:23], s44 offen sc1
  s_addk_i32 s44, 0x1000
  s_waitcnt lgkmcnt(0)
  v_pk_mul_f32 v[176:177], v[0:1], v[80:81]
  v_pk_mul_f32 v[182:183], v[24:25], v[104:105]
  v_pk_mul_f32 v[178:179], v[16:17], v[96:97]
  v_pk_mul_f32 v[180:181], v[20:21], v[100:101]
  v_pk_fma_f32 v[176:177], v[4:5], v[84:85], v[176:177]
  v_pk_fma_f32 v[182:183], v[28:29], v[108:109], v[182:183]
  v_pk_fma_f32 v[176:177], v[8:9], v[88:89], v[176:177]
  v_pk_fma_f32 v[182:183], v[32:33], v[112:113], v[182:183]
  v_pk_fma_f32 v[176:177], v[12:13], v[92:93], v[176:177]
  v_pk_fma_f32 v[182:183], v[36:37], v[116:117], v[182:183]
  v_pk_fma_f32 v[176:177], v[2:3], v[82:83], v[176:177]
  v_pk_fma_f32 v[182:183], v[26:27], v[106:107], v[182:183]
  v_pk_fma_f32 v[178:179], v[18:19], v[98:99], v[178:179]
  v_pk_fma_f32 v[180:181], v[22:23], v[102:103], v[180:181]
  v_pk_fma_f32 v[176:177], v[6:7], v[86:87], v[176:177]
  v_pk_fma_f32 v[182:183], v[30:31], v[110:111], v[182:183]
  v_pk_fma_f32 v[176:177], v[10:11], v[90:91], v[176:177]
  v_pk_fma_f32 v[182:183], v[34:35], v[114:115], v[182:183]
  v_pk_fma_f32 v[176:177], v[14:15], v[94:95], v[176:177]
  v_pk_fma_f32 v[182:183], v[38:39], v[118:119], v[182:183]
  v_add_f32 v176, v176, v177
  v_add_f32 v178, v178, v179
  v_add_f32 v180, v180, v181
  v_add_f32 v182, v182, v183
  v_cndmask_b32 v177, v178, v180, s[76:77]
  v_cndmask_b32 v179, v180, v178, s[76:77]
  v_add_f32 v176, v176, v177
  v_add_f32 v182, v182, v179
  v_add_f32 v176, 897988541, v176
  v_add_f32 v182, 897988541, v182
  v_rcp_f32 v178, v176
  v_rcp_f32 v180, v182
  v_mul_f32 v176, v178, v184
  v_mul_f32 v182, v180, v184
  v_mul_f32 v177, v178, v184
  v_mul_f32 v183, v180, v184
  v_cndmask_b32 v178, v176, v182, s[76:77]
  v_cndmask_b32 v180, v182, v176, s[76:77]
  v_cndmask_b32 v179, v176, v182, s[76:77]
  v_cndmask_b32 v181, v182, v176, s[76:77]
  v_pk_mul_f32 v[0:1], v[0:1], v[176:177]
  v_pk_mul_f32 v[2:3], v[2:3], v[176:177]
  v_pk_mul_f32 v[4:5], v[4:5], v[176:177]
  v_pk_mul_f32 v[6:7], v[6:7], v[176:177]
  v_cvt_pk_bf16_f32 v140, v0, v1
  v_cvt_pk_bf16_f32 v141, v2, v3
  v_cvt_pk_bf16_f32 v142, v4, v5
  v_cvt_pk_bf16_f32 v143, v6, v7
  buffer_store_dwordx4 v[140:143], v195, s[20:23], s47 offen sc1
  s_addk_i32 s47, 0x1000
  v_pk_mul_f32 v[8:9], v[8:9], v[176:177]
  v_pk_mul_f32 v[10:11], v[10:11], v[176:177]
  v_pk_mul_f32 v[12:13], v[12:13], v[176:177]
  v_pk_mul_f32 v[14:15], v[14:15], v[176:177]
  v_cvt_pk_bf16_f32 v144, v8, v9
  v_cvt_pk_bf16_f32 v145, v10, v11
  v_cvt_pk_bf16_f32 v146, v12, v13
  v_cvt_pk_bf16_f32 v147, v14, v15
  buffer_store_dwordx4 v[144:147], v195, s[20:23], s47 offen sc1
  s_addk_i32 s47, 0x1000
  v_pk_mul_f32 v[16:17], v[16:17], v[178:179]
  v_pk_mul_f32 v[18:19], v[18:19], v[178:179]
  v_pk_mul_f32 v[20:21], v[20:21], v[180:181]
  v_pk_mul_f32 v[22:23], v[22:23], v[180:181]
  v_cvt_pk_bf16_f32 v148, v16, v17
  v_cvt_pk_bf16_f32 v149, v18, v19
  v_cvt_pk_bf16_f32 v150, v20, v21
  v_cvt_pk_bf16_f32 v151, v22, v23
  buffer_store_dwordx4 v[148:151], v195, s[20:23], s47 offen sc1
  s_addk_i32 s47, 0x1000
  v_pk_mul_f32 v[24:25], v[24:25], v[182:183]
  v_pk_mul_f32 v[26:27], v[26:27], v[182:183]
  v_pk_mul_f32 v[28:29], v[28:29], v[182:183]
  v_pk_mul_f32 v[30:31], v[30:31], v[182:183]
  v_cvt_pk_bf16_f32 v152, v24, v25
  v_cvt_pk_bf16_f32 v153, v26, v27
  v_cvt_pk_bf16_f32 v154, v28, v29
  v_cvt_pk_bf16_f32 v155, v30, v31
  buffer_store_dwordx4 v[152:155], v195, s[20:23], s47 offen sc1
  s_addk_i32 s47, 0x1000
  v_pk_mul_f32 v[32:33], v[32:33], v[182:183]
  v_pk_mul_f32 v[34:35], v[34:35], v[182:183]
  v_pk_mul_f32 v[36:37], v[36:37], v[182:183]
  v_pk_mul_f32 v[38:39], v[38:39], v[182:183]
  v_cvt_pk_bf16_f32 v156, v32, v33
  v_cvt_pk_bf16_f32 v157, v34, v35
  v_cvt_pk_bf16_f32 v158, v36, v37
  v_cvt_pk_bf16_f32 v159, v38, v39
  buffer_store_dwordx4 v[156:159], v195, s[20:23], s47 offen sc1
  s_addk_i32 s47, 0x1000
L_p2_blk_done:
  s_waitcnt vmcnt(13)
  v_mfma_f32_16x16x32_bf16 v[0:3], a[120:123], a[0:3], 0
  buffer_load_dwordx4 a[48:51], v165, s[20:23], s44 offen sc1
  v_mfma_f32_16x16x32_bf16 v[4:7], a[124:127], a[0:3], 0
  v_mfma_f32_16x16x32_bf16 v[8:11], a[128:131], a[0:3], 0
  buffer_load_dwordx4 a[52:55], v166, s[20:23], s44 offen sc1
  v_mfma_f32_16x16x32_bf16 v[12:15], a[132:135], a[0:3], 0
  v_mfma_f32_16x16x32_bf16 v[16:19], a[136:139], a[0:3], 0
  v_mfma_f32_16x16x32_bf16 v[20:23], a[120:123], a[4:7], 0
  buffer_load_dwordx4 a[56:59], v167, s[20:23], s44 offen sc1
  v_mfma_f32_16x16x32_bf16 v[24:27], a[124:127], a[4:7], 0
  v_mfma_f32_16x16x32_bf16 v[28:31], a[128:131], a[4:7], 0
  buffer_load_dwordx4 a[60:63], v168, s[20:23], s44 offen sc1
  s_addk_i32 s44, 0x1000
  v_mfma_f32_16x16x32_bf16 v[32:35], a[132:135], a[4:7], 0
  v_mfma_f32_16x16x32_bf16 v[36:39], a[136:139], a[4:7], 0
  v_mfma_f32_16x16x32_bf16 v[40:43], a[120:123], a[8:11], 0
  buffer_load_dwordx4 a[64:67], v165, s[20:23], s44 offen sc1
  v_mfma_f32_16x16x32_bf16 v[44:47], a[124:127], a[8:11], 0
  v_mfma_f32_16x16x32_bf16 v[48:51], a[128:131], a[8:11], 0
  buffer_load_dwordx4 a[68:71], v166, s[20:23], s44 offen sc1
  v_mfma_f32_16x16x32_bf16 v[52:55], a[132:135], a[8:11], 0
  v_mfma_f32_16x16x32_bf16 v[56:59], a[136:139], a[8:11], 0
  v_mfma_f32_16x16x32_bf16 v[60:63], a[120:123], a[12:15], 0
  buffer_load_dwordx4 a[72:75], v167, s[20:23], s44 offen sc1
  v_mfma_f32_16x16x32_bf16 v[64:67], a[124:127], a[12:15], 0
  v_mfma_f32_16x16x32_bf16 v[68:71], a[128:131], a[12:15], 0
  buffer_load_dwordx4 a[76:79], v168, s[20:23], s44 offen sc1
  s_addk_i32 s44, 0x1000
  v_mfma_f32_16x16x32_bf16 v[72:75], a[132:135], a[12:15], 0
  v_mfma_f32_16x16x32_bf16 v[76:79], a[136:139], a[12:15], 0
  s_waitcnt vmcnt(8)
  s_barrier
  s_cmp_lg_u32 s42, 0
  s_cbranch_scc1 L_p2_sig2
  s_mov_b64 exec, 1
  buffer_store_dword v196, off, s[20:23], s56 sc1
  s_mov_b64 exec, -1
L_p2_sig2:
  s_waitcnt vmcnt(17)
  v_mfma_f32_16x16x32_bf16 v[0:3], a[140:143], a[16:19], v[0:3]
  buffer_load_dwordx4 a[80:83], v165, s[20:23], s44 offen sc1
  v_mfma_f32_16x16x32_bf16 v[4:7], a[144:147], a[16:19], v[4:7]
  v_mfma_f32_16x16x32_bf16 v[8:11], a[148:151], a[16:19], v[8:11]
  buffer_load_dwordx4 a[84:87], v166, s[20:23], s44 offen sc1
  v_mfma_f32_16x16x32_bf16 v[12:15], a[152:155], a[16:19], v[12:15]
  v_mfma_f32_16x16x32_bf16 v[16:19], a[156:159], a[16:19], v[16:19]
  v_mfma_f32_16x16x32_bf16 v[20:23], a[140:143], a[20:23], v[20:23]
  buffer_load_dwordx4 a[88:91], v167, s[20:23], s44 offen sc1
  v_mfma_f32_16x16x32_bf16 v[24:27], a[144:147], a[20:23], v[24:27]
  v_mfma_f32_16x16x32_bf16 v[28:31], a[148:151], a[20:23], v[28:31]
  buffer_load_dwordx4 a[92:95], v168, s[20:23], s44 offen sc1
  s_addk_i32 s44, 0x1000
  v_mfma_f32_16x16x32_bf16 v[32:35], a[152:155], a[20:23], v[32:35]
  v_mfma_f32_16x16x32_bf16 v[36:39], a[156:159], a[20:23], v[36:39]
  v_mfma_f32_16x16x32_bf16 v[40:43], a[140:143], a[24:27], v[40:43]
  buffer_load_dwordx4 a[0:3], v165, s[20:23], s44 offen sc1
  v_mfma_f32_16x16x32_bf16 v[44:47], a[144:147], a[24:27], v[44:47]
  v_mfma_f32_16x16x32_bf16 v[48:51], a[148:151], a[24:27], v[48:51]
  buffer_load_dwordx4 a[4:7], v166, s[20:23], s44 offen sc1
  v_mfma_f32_16x16x32_bf16 v[52:55], a[152:155], a[24:27], v[52:55]
  v_mfma_f32_16x16x32_bf16 v[56:59], a[156:159], a[24:27], v[56:59]
  v_mfma_f32_16x16x32_bf16 v[60:63], a[140:143], a[28:31], v[60:63]
  buffer_load_dwordx4 a[8:11], v167, s[20:23], s44 offen sc1
  v_mfma_f32_16x16x32_bf16 v[64:67], a[144:147], a[28:31], v[64:67]
  v_mfma_f32_16x16x32_bf16 v[68:71], a[148:151], a[28:31], v[68:71]
  buffer_load_dwordx4 a[12:15], v168, s[20:23], s44 offen sc1
  s_addk_i32 s44, 0x1000
  v_mfma_f32_16x16x32_bf16 v[72:75], a[152:155], a[28:31], v[72:75]
  v_mfma_f32_16x16x32_bf16 v[76:79], a[156:159], a[28:31], v[76:79]
  s_waitcnt vmcnt(21)
  v_mfma_f32_16x16x32_bf16 v[0:3], a[160:163], a[32:35], v[0:3]
  buffer_load_dwordx4 a[16:19], v165, s[20:23], s44 offen sc1
  v_mfma_f32_16x16x32_bf16 v[4:7], a[164:167], a[32:35], v[4:7]
  v_mfma_f32_16x16x32_bf16 v[8:11], a[168:171], a[32:35], v[8:11]
  v_mfma_f32_16x16x32_bf16 v[12:15], a[172:175], a[32:35], v[12:15]
  v_mfma_f32_16x16x32_bf16 v[16:19], a[176:179], a[32:35], v[16:19]
  v_mfma_f32_16x16x32_bf16 v[20:23], a[160:163], a[36:39], v[20:23]
  buffer_load_dwordx4 a[20:23], v166, s[20:23], s44 offen sc1
  v_mfma_f32_16x16x32_bf16 v[24:27], a[164:167], a[36:39], v[24:27]
  v_mfma_f32_16x16x32_bf16 v[28:31], a[168:171], a[36:39], v[28:31]
  v_mfma_f32_16x16x32_bf16 v[32:35], a[172:175], a[36:39], v[32:35]
  v_mfma_f32_16x16x32_bf16 v[36:39], a[176:179], a[36:39], v[36:39]
  v_mfma_f32_16x16x32_bf16 v[40:43], a[160:163], a[40:43], v[40:43]
  buffer_load_dwordx4 a[24:27], v167, s[20:23], s44 offen sc1
  v_mfma_f32_16x16x32_bf16 v[44:47], a[164:167], a[40:43], v[44:47]
  v_mfma_f32_16x16x32_bf16 v[48:51], a[168:171], a[40:43], v[48:51]
  v_mfma_f32_16x16x32_bf16 v[52:55], a[172:175], a[40:43], v[52:55]
  v_mfma_f32_16x16x32_bf16 v[56:59], a[176:179], a[40:43], v[56:59]
  v_mfma_f32_16x16x32_bf16 v[60:63], a[160:163], a[44:47], v[60:63]
  buffer_load_dwordx4 a[28:31], v168, s[20:23], s44 offen sc1
  s_addk_i32 s44, 0x1000
  v_mfma_f32_16x16x32_bf16 v[64:67], a[164:167], a[44:47], v[64:67]
  v_mfma_f32_16x16x32_bf16 v[68:71], a[168:171], a[44:47], v[68:71]
  v_mfma_f32_16x16x32_bf16 v[72:75], a[172:175], a[44:47], v[72:75]
  v_mfma_f32_16x16x32_bf16 v[76:79], a[176:179], a[44:47], v[76:79]
  s_waitcnt vmcnt(16)
  v_mfma_f32_16x16x32_bf16 v[0:3], a[180:183], a[48:51], v[0:3]
  buffer_load_dwordx4 a[32:35], v165, s[20:23], s44 offen sc1
  v_mfma_f32_16x16x32_bf16 v[4:7], a[184:187], a[48:51], v[4:7]
  v_mfma_f32_16x16x32_bf16 v[8:11], a[188:191], a[48:51], v[8:11]
  v_mfma_f32_16x16x32_bf16 v[12:15], a[192:195], a[48:51], v[12:15]
  v_mfma_f32_16x16x32_bf16 v[16:19], a[196:199], a[48:51], v[16:19]
  v_mfma_f32_16x16x32_bf16 v[20:23], a[180:183], a[52:55], v[20:23]
  buffer_load_dwordx4 a[36:39], v166, s[20:23], s44 offen sc1
  v_mfma_f32_16x16x32_bf16 v[24:27], a[184:187], a[52:55], v[24:27]
  v_mfma_f32_16x16x32_bf16 v[28:31], a[188:191], a[52:55], v[28:31]
  v_mfma_f32_16x16x32_bf16 v[32:35], a[192:195], a[52:55], v[32:35]
  v_mfma_f32_16x16x32_bf16 v[36:39], a[196:199], a[52:55], v[36:39]
  v_mfma_f32_16x16x32_bf16 v[40:43], a[180:183], a[56:59], v[40:43]
  buffer_load_dwordx4 a[40:43], v167, s[20:23], s44 offen sc1
  v_mfma_f32_16x16x32_bf16 v[44:47], a[184:187], a[56:59], v[44:47]
  v_mfma_f32_16x16x32_bf16 v[48:51], a[188:191], a[56:59], v[48:51]
  v_mfma_f32_16x16x32_bf16 v[52:55], a[192:195], a[56:59], v[52:55]
  v_mfma_f32_16x16x32_bf16 v[56:59], a[196:199], a[56:59], v[56:59]
  v_mfma_f32_16x16x32_bf16 v[60:63], a[180:183], a[60:63], v[60:63]
  buffer_load_dwordx4 a[44:47], v168, s[20:23], s44 offen sc1
  s_addk_i32 s44, 0x1000
  v_mfma_f32_16x16x32_bf16 v[64:67], a[184:187], a[60:63], v[64:67]
  v_mfma_f32_16x16x32_bf16 v[68:71], a[188:191], a[60:63], v[68:71]
  v_mfma_f32_16x16x32_bf16 v[72:75], a[192:195], a[60:63], v[72:75]
  v_mfma_f32_16x16x32_bf16 v[76:79], a[196:199], a[60:63], v[76:79]
  s_waitcnt vmcnt(16)
  v_mfma_f32_16x16x32_bf16 v[0:3], a[200:203], a[64:67], v[0:3]
  ds_read_b128 a[96:99], v192 offset:0
  v_mfma_f32_16x16x32_bf16 v[4:7], a[204:207], a[64:67], v[4:7]
  v_mfma_f32_16x16x32_bf16 v[8:11], a[208:211], a[64:67], v[8:11]
  ds_read_b128 a[100:103], v192 offset:1024
  v_mfma_f32_16x16x32_bf16 v[12:15], a[212:215], a[64:67], v[12:15]
  v_mfma_f32_16x16x32_bf16 v[16:19], a[216:219], a[64:67], v[16:19]
  ds_read_b128 a[104:107], v192 offset:2048
  v_mfma_f32_16x16x32_bf16 v[20:23], a[200:203], a[68:71], v[20:23]
  v_mfma_f32_16x16x32_bf16 v[24:27], a[204:207], a[68:71], v[24:27]
  ds_read_b128 a[108:111], v192 offset:3072
  v_mfma_f32_16x16x32_bf16 v[28:31], a[208:211], a[68:71], v[28:31]
  v_mfma_f32_16x16x32_bf16 v[32:35], a[212:215], a[68:71], v[32:35]
  ds_read_b128 a[116:119], v192 offset:4096
  v_mfma_f32_16x16x32_bf16 v[36:39], a[216:219], a[68:71], v[36:39]
  v_mfma_f32_16x16x32_bf16 v[40:43], a[200:203], a[72:75], v[40:43]
  v_mfma_f32_16x16x32_bf16 v[44:47], a[204:207], a[72:75], v[44:47]
  buffer_load_dwordx4 a[48:51], v165, s[20:23], s44 offen sc1
  v_mfma_f32_16x16x32_bf16 v[48:51], a[208:211], a[72:75], v[48:51]
  v_mfma_f32_16x16x32_bf16 v[52:55], a[212:215], a[72:75], v[52:55]
  buffer_load_dwordx4 a[52:55], v166, s[20:23], s44 offen sc1
  v_mfma_f32_16x16x32_bf16 v[56:59], a[216:219], a[72:75], v[56:59]
  v_mfma_f32_16x16x32_bf16 v[60:63], a[200:203], a[76:79], v[60:63]
  buffer_load_dwordx4 a[56:59], v167, s[20:23], s44 offen sc1
  v_mfma_f32_16x16x32_bf16 v[64:67], a[204:207], a[76:79], v[64:67]
  v_mfma_f32_16x16x32_bf16 v[68:71], a[208:211], a[76:79], v[68:71]
  buffer_load_dwordx4 a[60:63], v168, s[20:23], s44 offen sc1
  s_addk_i32 s44, 0x1000
  v_mfma_f32_16x16x32_bf16 v[72:75], a[212:215], a[76:79], v[72:75]
  v_mfma_f32_16x16x32_bf16 v[76:79], a[216:219], a[76:79], v[76:79]
  s_cmp_lg_u32 s42, 1
  s_cbranch_scc1 L_p2_lm
  buffer_load_dword v175, v194, s[20:23], 0 offen sc1
L_p2_lm:
  s_waitcnt vmcnt(16)
  v_mfma_f32_16x16x32_bf16 v[0:3], a[220:223], a[80:83], v[0:3]
  ds_read_b128 a[112:115], v192 offset:5120
  v_mfma_f32_16x16x32_bf16 v[4:7], a[224:227], a[80:83], v[4:7]
  v_mfma_f32_16x16x32_bf16 v[8:11], a[228:231], a[80:83], v[8:11]
  ds_read_b128 a[240:243], v192 offset:6144
  v_mfma_f32_16x16x32_bf16 v[12:15], a[232:235], a[80:83], v[12:15]
  v_mfma_f32_16x16x32_bf16 v[16:19], a[236:239], a[80:83], v[16:19]
  ds_read_b128 a[244:247], v192 offset:7168
  v_mfma_f32_16x16x32_bf16 v[20:23], a[220:223], a[84:87], v[20:23]
  v_mfma_f32_16x16x32_bf16 v[24:27], a[224:227], a[84:87], v[24:27]
  ds_read_b128 a[248:251], v192 offset:8192
  v_mfma_f32_16x16x32_bf16 v[28:31], a[228:231], a[84:87], v[28:31]
  v_mfma_f32_16x16x32_bf16 v[32:35], a[232:235], a[84:87], v[32:35]
  ds_read_b128 a[252:255], v192 offset:9216
  v_mfma_f32_16x16x32_bf16 v[36:39], a[236:239], a[84:87], v[36:39]
  v_mfma_f32_16x16x32_bf16 v[40:43], a[220:223], a[88:91], v[40:43]
  v_mfma_f32_16x16x32_bf16 v[44:47], a[224:227], a[88:91], v[44:47]
  buffer_load_dwordx4 a[64:67], v165, s[20:23], s44 offen sc1
  v_mfma_f32_16x16x32_bf16 v[48:51], a[228:231], a[88:91], v[48:51]
  v_mfma_f32_16x16x32_bf16 v[52:55], a[232:235], a[88:91], v[52:55]
  buffer_load_dwordx4 a[68:71], v166, s[20:23], s44 offen sc1
  v_mfma_f32_16x16x32_bf16 v[56:59], a[236:239], a[88:91], v[56:59]
  v_mfma_f32_16x16x32_bf16 v[60:63], a[220:223], a[92:95], v[60:63]
  buffer_load_dwordx4 a[72:75], v167, s[20:23], s44 offen sc1
  v_mfma_f32_16x16x32_bf16 v[64:67], a[224:227], a[92:95], v[64:67]
  v_mfma_f32_16x16x32_bf16 v[68:71], a[228:231], a[92:95], v[68:71]
  buffer_load_dwordx4 a[76:79], v168, s[20:23], s44 offen sc1
  s_addk_i32 s44, 0x1000
  v_mfma_f32_16x16x32_bf16 v[72:75], a[232:235], a[92:95], v[72:75]
  v_mfma_f32_16x16x32_bf16 v[76:79], a[236:239], a[92:95], v[76:79]
  s_waitcnt vmcnt(16) lgkmcnt(5)
  v_mfma_f32_16x16x32_bf16 v[0:3], a[96:99], a[0:3], v[0:3]
  buffer_load_dwordx4 a[80:83], v165, s[20:23], s44 offen sc1
  v_mfma_f32_16x16x32_bf16 v[4:7], a[100:103], a[0:3], v[4:7]
  v_mfma_f32_16x16x32_bf16 v[8:11], a[104:107], a[0:3], v[8:11]
  v_mfma_f32_16x16x32_bf16 v[12:15], a[108:111], a[0:3], v[12:15]
  v_mfma_f32_16x16x32_bf16 v[16:19], a[116:119], a[0:3], v[16:19]
  v_mfma_f32_16x16x32_bf16 v[20:23], a[96:99], a[4:7], v[20:23]
  buffer_load_dwordx4 a[84:87], v166, s[20:23], s44 offen sc1
  v_mfma_f32_16x16x32_bf16 v[24:27], a[100:103], a[4:7], v[24:27]
  v_mfma_f32_16x16x32_bf16 v[28:31], a[104:107], a[4:7], v[28:31]
  v_mfma_f32_16x16x32_bf16 v[32:35], a[108:111], a[4:7], v[32:35]
  v_mfma_f32_16x16x32_bf16 v[36:39], a[116:119], a[4:7], v[36:39]
  v_mfma_f32_16x16x32_bf16 v[40:43], a[96:99], a[8:11], v[40:43]
  buffer_load_dwordx4 a[88:91], v167, s[20:23], s44 offen sc1
  v_mfma_f32_16x16x32_bf16 v[44:47], a[100:103], a[8:11], v[44:47]
  v_mfma_f32_16x16x32_bf16 v[48:51], a[104:107], a[8:11], v[48:51]
  v_mfma_f32_16x16x32_bf16 v[52:55], a[108:111], a[8:11], v[52:55]
  v_mfma_f32_16x16x32_bf16 v[56:59], a[116:119], a[8:11], v[56:59]
  v_mfma_f32_16x16x32_bf16 v[60:63], a[96:99], a[12:15], v[60:63]
  buffer_load_dwordx4 a[92:95], v168, s[20:23], s44 offen sc1
  s_addk_i32 s44, 0x1000
  v_mfma_f32_16x16x32_bf16 v[64:67], a[100:103], a[12:15], v[64:67]
  v_mfma_f32_16x16x32_bf16 v[68:71], a[104:107], a[12:15], v[68:71]
  v_mfma_f32_16x16x32_bf16 v[72:75], a[108:111], a[12:15], v[72:75]
  v_mfma_f32_16x16x32_bf16 v[76:79], a[116:119], a[12:15], v[76:79]
  s_cmp_lg_u32 s42, 1
  s_cbranch_scc1 L_fm_ok
  s_waitcnt vmcnt(8)
  s_mov_b32 s57, 0
L_fm_poll:
  v_cmp_eq_u32 vcc, s100, v175
  s_nop 0
  s_cmp_eq_u64 vcc, -1
  s_cbranch_scc1 L_fm_ok
  s_add_u32 s57, s57, 1
  s_cmp_gt_u32 s57, 131072
  s_cbranch_scc1 L_fm_ok
  s_sleep 1
  buffer_load_dword v175, v194, s[20:23], 0 offen sc1
  s_waitcnt vmcnt(0)
  s_branch L_fm_poll
L_fm_ok:
  s_barrier
  buffer_load_dword v169, v197, s[20:23], s90 offen sc1
  buffer_load_dword v170, v197, s[20:23], s91 offen sc1
  buffer_load_dword v171, v197, s[20:23], s92 offen sc1
  buffer_load_dword v172, v197, s[20:23], s93 offen sc1
  buffer_load_dwordx4 a[120:123], v195, s[20:23], s82 offen offset:0 sc1
  buffer_load_dwordx4 a[124:127], v195, s[20:23], s82 offen offset:1024 sc1
  buffer_load_dwordx4 a[128:131], v195, s[20:23], s82 offen offset:2048 sc1
  buffer_load_dwordx4 a[132:135], v195, s[20:23], s82 offen offset:3072 sc1
  s_waitcnt vmcnt(24) lgkmcnt(0)
  v_mfma_f32_16x16x32_bf16 v[0:3], a[112:115], a[16:19], v[0:3]
  ds_read_b128 a[96:99], v192 offset:10240
  v_mfma_f32_16x16x32_bf16 v[4:7], a[240:243], a[16:19], v[4:7]
  ds_read_b128 a[100:103], v192 offset:11264
  v_mfma_f32_16x16x32_bf16 v[8:11], a[244:247], a[16:19], v[8:11]
  v_mfma_f32_16x16x32_bf16 v[12:15], a[248:251], a[16:19], v[12:15]
  ds_read_b128 a[104:107], v192 offset:12288
  v_mfma_f32_16x16x32_bf16 v[16:19], a[252:255], a[16:19], v[16:19]
  v_mfma_f32_16x16x32_bf16 v[20:23], a[112:115], a[20:23], v[20:23]
  ds_read_b128 a[108:111], v192 offset:13312
  v_mfma_f32_16x16x32_bf16 v[24:27], a[240:243], a[20:23], v[24:27]
  v_mfma_f32_16x16x32_bf16 v[28:31], a[244:247], a[20:23], v[28:31]
  ds_read_b128 a[116:119], v192 offset:14336
  v_mfma_f32_16x16x32_bf16 v[32:35], a[248:251], a[20:23], v[32:35]
  v_mfma_f32_16x16x32_bf16 v[36:39], a[252:255], a[20:23], v[36:39]
  buffer_load_dwordx4 a[136:139], v199, s[20:23], s82 offen sc1
  v_mfma_f32_16x16x32_bf16 v[40:43], a[112:115], a[24:27], v[40:43]
  buffer_load_dwordx4 a[0:3], v165, s[20:23], s84 offen sc1
  v_mfma_f32_16x16x32_bf16 v[44:47], a[240:243], a[24:27], v[44:47]
  v_mfma_f32_16x16x32_bf16 v[48:51], a[244:247], a[24:27], v[48:51]
  buffer_load_dwordx4 a[4:7], v166, s[20:23], s84 offen sc1
  v_mfma_f32_16x16x32_bf16 v[52:55], a[248:251], a[24:27], v[52:55]
  v_mfma_f32_16x16x32_bf16 v[56:59], a[252:255], a[24:27], v[56:59]
  buffer_load_dwordx4 a[8:11], v167, s[20:23], s84 offen sc1
  v_mfma_f32_16x16x32_bf16 v[60:63], a[112:115], a[28:31], v[60:63]
  v_mfma_f32_16x16x32_bf16 v[64:67], a[240:243], a[28:31], v[64:67]
  buffer_load_dwordx4 a[12:15], v168, s[20:23], s84 offen sc1
  v_mfma_f32_16x16x32_bf16 v[68:71], a[244:247], a[28:31], v[68:71]
  v_mfma_f32_16x16x32_bf16 v[72:75], a[248:251], a[28:31], v[72:75]
  buffer_load_dwordx4 a[140:143], v195, s[20:23], s58 offen offset:0 sc1
  v_mfma_f32_16x16x32_bf16 v[76:79], a[252:255], a[28:31], v[76:79]
  s_waitcnt vmcnt(26) lgkmcnt(0)
  v_mfma_f32_16x16x32_bf16 v[0:3], a[96:99], a[32:35], v[0:3]
  ds_read_b128 a[112:115], v192 offset:15360
  v_mfma_f32_16x16x32_bf16 v[4:7], a[100:103], a[32:35], v[4:7]
  ds_read_b128 a[240:243], v192 offset:16384
  v_mfma_f32_16x16x32_bf16 v[8:11], a[104:107], a[32:35], v[8:11]
  v_mfma_f32_16x16x32_bf16 v[12:15], a[108:111], a[32:35], v[12:15]
  ds_read_b128 a[244:247], v192 offset:17408
  v_mfma_f32_16x16x32_bf16 v[16:19], a[116:119], a[32:35], v[16:19]
  v_mfma_f32_16x16x32_bf16 v[20:23], a[96:99], a[36:39], v[20:23]
  ds_read_b128 a[248:251], v192 offset:18432
  v_mfma_f32_16x16x32_bf16 v[24:27], a[100:103], a[36:39], v[24:27]
  v_mfma_f32_16x16x32_bf16 v[28:31], a[104:107], a[36:39], v[28:31]
  ds_read_b128 a[252:255], v192 offset:19456
  v_mfma_f32_16x16x32_bf16 v[32:35], a[108:111], a[36:39], v[32:35]
  v_mfma_f32_16x16x32_bf16 v[36:39], a[116:119], a[36:39], v[36:39]
  buffer_load_dwordx4 a[144:147], v195, s[20:23], s58 offen offset:1024 sc1
  v_mfma_f32_16x16x32_bf16 v[40:43], a[96:99], a[40:43], v[40:43]
  buffer_load_dwordx4 a[148:151], v195, s[20:23], s58 offen offset:2048 sc1
  v_mfma_f32_16x16x32_bf16 v[44:47], a[100:103], a[40:43], v[44:47]
  v_mfma_f32_16x16x32_bf16 v[48:51], a[104:107], a[40:43], v[48:51]
  buffer_load_dwordx4 a[152:155], v195, s[20:23], s58 offen offset:3072 sc1
  v_mfma_f32_16x16x32_bf16 v[52:55], a[108:111], a[40:43], v[52:55]
  v_mfma_f32_16x16x32_bf16 v[56:59], a[116:119], a[40:43], v[56:59]
  buffer_load_dwordx4 a[156:159], v199, s[20:23], s58 offen sc1
  v_mfma_f32_16x16x32_bf16 v[60:63], a[96:99], a[44:47], v[60:63]
  v_mfma_f32_16x16x32_bf16 v[64:67], a[100:103], a[44:47], v[64:67]
  buffer_load_dwordx4 a[16:19], v165, s[20:23], s85 offen sc1
  v_mfma_f32_16x16x32_bf16 v[68:71], a[104:107], a[44:47], v[68:71]
  v_mfma_f32_16x16x32_bf16 v[72:75], a[108:111], a[44:47], v[72:75]
  buffer_load_dwordx4 a[20:23], v166, s[20:23], s85 offen sc1
  v_mfma_f32_16x16x32_bf16 v[76:79], a[116:119], a[44:47], v[76:79]
  s_waitcnt vmcnt(28) lgkmcnt(0)
  v_mfma_f32_16x16x32_bf16 v[0:3], a[112:115], a[48:51], v[0:3]
  ds_read_b128 a[96:99], v192 offset:20480
  v_mfma_f32_16x16x32_bf16 v[4:7], a[240:243], a[48:51], v[4:7]
  ds_read_b128 a[100:103], v192 offset:21504
  v_mfma_f32_16x16x32_bf16 v[8:11], a[244:247], a[48:51], v[8:11]
  v_mfma_f32_16x16x32_bf16 v[12:15], a[248:251], a[48:51], v[12:15]
  ds_read_b128 a[104:107], v192 offset:22528
  v_mfma_f32_16x16x32_bf16 v[16:19], a[252:255], a[48:51], v[16:19]
  v_mfma_f32_16x16x32_bf16 v[20:23], a[112:115], a[52:55], v[20:23]
  ds_read_b128 a[108:111], v192 offset:23552
  v_mfma_f32_16x16x32_bf16 v[24:27], a[240:243], a[52:55], v[24:27]
  v_mfma_f32_16x16x32_bf16 v[28:31], a[244:247], a[52:55], v[28:31]
  ds_read_b128 a[116:119], v192 offset:24576
  v_mfma_f32_16x16x32_bf16 v[32:35], a[248:251], a[52:55], v[32:35]
  v_mfma_f32_16x16x32_bf16 v[36:39], a[252:255], a[52:55], v[36:39]
  buffer_load_dwordx4 a[24:27], v167, s[20:23], s85 offen sc1
  v_mfma_f32_16x16x32_bf16 v[40:43], a[112:115], a[56:59], v[40:43]
  buffer_load_dwordx4 a[28:31], v168, s[20:23], s85 offen sc1
  v_mfma_f32_16x16x32_bf16 v[44:47], a[240:243], a[56:59], v[44:47]
  v_mfma_f32_16x16x32_bf16 v[48:51], a[244:247], a[56:59], v[48:51]
  buffer_load_dwordx4 a[160:163], v195, s[20:23], s59 offen offset:0 sc1
  v_mfma_f32_16x16x32_bf16 v[52:55], a[248:251], a[56:59], v[52:55]
  v_mfma_f32_16x16x32_bf16 v[56:59], a[252:255], a[56:59], v[56:59]
  buffer_load_dwordx4 a[164:167], v195, s[20:23], s59 offen offset:1024 sc1
  v_mfma_f32_16x16x32_bf16 v[60:63], a[112:115], a[60:63], v[60:63]
  v_mfma_f32_16x16x32_bf16 v[64:67], a[240:243], a[60:63], v[64:67]
  buffer_load_dwordx4 a[168:171], v195, s[20:23], s59 offen offset:2048 sc1
  v_mfma_f32_16x16x32_bf16 v[68:71], a[244:247], a[60:63], v[68:71]
  v_mfma_f32_16x16x32_bf16 v[72:75], a[248:251], a[60:63], v[72:75]
  buffer_load_dwordx4 a[172:175], v195, s[20:23], s59 offen offset:3072 sc1
  v_mfma_f32_16x16x32_bf16 v[76:79], a[252:255], a[60:63], v[76:79]
  s_waitcnt vmcnt(30) lgkmcnt(0)
  v_mfma_f32_16x16x32_bf16 v[0:3], a[96:99], a[64:67], v[0:3]
  ds_read_b128 a[112:115], v192 offset:25600
  v_mfma_f32_16x16x32_bf16 v[4:7], a[100:103], a[64:67], v[4:7]
  ds_read_b128 a[240:243], v192 offset:26624
  v_mfma_f32_16x16x32_bf16 v[8:11], a[104:107], a[64:67], v[8:11]
  v_mfma_f32_16x16x32_bf16 v[12:15], a[108:111], a[64:67], v[12:15]
  ds_read_b128 a[244:247], v192 offset:27648
  v_mfma_f32_16x16x32_bf16 v[16:19], a[116:119], a[64:67], v[16:19]
  v_mfma_f32_16x16x32_bf16 v[20:23], a[96:99], a[68:71], v[20:23]
  ds_read_b128 a[248:251], v192 offset:28672
  v_mfma_f32_16x16x32_bf16 v[24:27], a[100:103], a[68:71], v[24:27]
  v_mfma_f32_16x16x32_bf16 v[28:31], a[104:107], a[68:71], v[28:31]
  ds_read_b128 a[252:255], v192 offset:29696
  v_mfma_f32_16x16x32_bf16 v[32:35], a[108:111], a[68:71], v[32:35]
  v_mfma_f32_16x16x32_bf16 v[36:39], a[116:119], a[68:71], v[36:39]
  buffer_load_dwordx4 a[176:179], v199, s[20:23], s59 offen sc1
  v_mfma_f32_16x16x32_bf16 v[40:43], a[96:99], a[72:75], v[40:43]
  buffer_load_dwordx4 a[32:35], v165, s[20:23], s86 offen sc1
  v_mfma_f32_16x16x32_bf16 v[44:47], a[100:103], a[72:75], v[44:47]
  v_mfma_f32_16x16x32_bf16 v[48:51], a[104:107], a[72:75], v[48:51]
  buffer_load_dwordx4 a[36:39], v166, s[20:23], s86 offen sc1
  v_mfma_f32_16x16x32_bf16 v[52:55], a[108:111], a[72:75], v[52:55]
  v_mfma_f32_16x16x32_bf16 v[56:59], a[116:119], a[72:75], v[56:59]
  buffer_load_dwordx4 a[40:43], v167, s[20:23], s86 offen sc1
  v_mfma_f32_16x16x32_bf16 v[60:63], a[96:99], a[76:79], v[60:63]
  v_mfma_f32_16x16x32_bf16 v[64:67], a[100:103], a[76:79], v[64:67]
  buffer_load_dwordx4 a[44:47], v168, s[20:23], s86 offen sc1
  v_mfma_f32_16x16x32_bf16 v[68:71], a[104:107], a[76:79], v[68:71]
  v_mfma_f32_16x16x32_bf16 v[72:75], a[108:111], a[76:79], v[72:75]
  buffer_load_dwordx4 a[180:183], v195, s[20:23], s6 offen offset:0 sc1
  v_mfma_f32_16x16x32_bf16 v[76:79], a[116:119], a[76:79], v[76:79]
  s_waitcnt vmcnt(32) lgkmcnt(0)
  v_mfma_f32_16x16x32_bf16 v[0:3], a[112:115], a[80:83], v[0:3]
  buffer_load_dwordx4 a[184:187], v195, s[20:23], s6 offen offset:1024 sc1
  v_mfma_f32_16x16x32_bf16 v[4:7], a[240:243], a[80:83], v[4:7]
  v_mfma_f32_16x16x32_bf16 v[8:11], a[244:247], a[80:83], v[8:11]
  v_mfma_f32_16x16x32_bf16 v[12:15], a[248:251], a[80:83], v[12:15]
  buffer_load_dwordx4 a[188:191], v195, s[20:23], s6 offen offset:2048 sc1
  v_mfma_f32_16x16x32_bf16 v[16:19], a[252:255], a[80:83], v[16:19]
  v_mfma_f32_16x16x32_bf16 v[20:23], a[112:115], a[84:87], v[20:23]
  v_mfma_f32_16x16x32_bf16 v[24:27], a[240:243], a[84:87], v[24:27]
  buffer_load_dwordx4 a[192:195], v195, s[20:23], s6 offen offset:3072 sc1
  v_mfma_f32_16x16x32_bf16 v[28:31], a[244:247], a[84:87], v[28:31]
  v_mfma_f32_16x16x32_bf16 v[32:35], a[248:251], a[84:87], v[32:35]
  v_mfma_f32_16x16x32_bf16 v[36:39], a[252:255], a[84:87], v[36:39]
  v_mfma_f32_16x16x32_bf16 v[40:43], a[112:115], a[88:91], v[40:43]
  buffer_load_dwordx4 a[196:199], v199, s[20:23], s6 offen sc1
  v_mfma_f32_16x16x32_bf16 v[44:47], a[240:243], a[88:91], v[44:47]
  v_mfma_f32_16x16x32_bf16 v[48:51], a[244:247], a[88:91], v[48:51]
  v_mfma_f32_16x16x32_bf16 v[52:55], a[248:251], a[88:91], v[52:55]
  buffer_load_dwordx4 a[48:51], v165, s[20:23], s87 offen sc1
  v_mfma_f32_16x16x32_bf16 v[56:59], a[252:255], a[88:91], v[56:59]
  v_mfma_f32_16x16x32_bf16 v[60:63], a[112:115], a[92:95], v[60:63]
  v_mfma_f32_16x16x32_bf16 v[64:67], a[240:243], a[92:95], v[64:67]
  buffer_load_dwordx4 a[52:55], v166, s[20:23], s87 offen sc1
  v_mfma_f32_16x16x32_bf16 v[68:71], a[244:247], a[92:95], v[68:71]
  v_mfma_f32_16x16x32_bf16 v[72:75], a[248:251], a[92:95], v[72:75]
  v_mfma_f32_16x16x32_bf16 v[76:79], a[252:255], a[92:95], v[76:79]
  s_waitcnt vmcnt(34)
  v_sub_f32 v200, 1.0, v169
  v_sub_f32 v201, 1.0, v169
  v_sub_f32 v202, 1.0, v170
  v_sub_f32 v203, 1.0, v170
  v_sub_f32 v204, 1.0, v171
  v_sub_f32 v205, 1.0, v171
  v_sub_f32 v206, 1.0, v172
  v_sub_f32 v207, 1.0, v172
  v_pk_mul_f32 v[0:1], v[0:1], v[200:201]
  v_pk_mul_f32 v[2:3], v[2:3], v[200:201]
  v_pk_mul_f32 v[4:5], v[4:5], v[200:201]
  v_pk_mul_f32 v[6:7], v[6:7], v[200:201]
  v_pk_mul_f32 v[8:9], v[8:9], v[200:201]
  v_pk_mul_f32 v[10:11], v[10:11], v[200:201]
  v_pk_mul_f32 v[12:13], v[12:13], v[200:201]
  v_pk_mul_f32 v[14:15], v[14:15], v[200:201]
  v_pk_mul_f32 v[16:17], v[16:17], v[200:201]
  v_pk_mul_f32 v[18:19], v[18:19], v[200:201]
  v_pk_mul_f32 v[20:21], v[20:21], v[202:203]
  v_pk_mul_f32 v[22:23], v[22:23], v[202:203]
  v_pk_mul_f32 v[24:25], v[24:25], v[202:203]
  v_pk_mul_f32 v[26:27], v[26:27], v[202:203]
  s_waitcnt vmcnt(25)
  v_mfma_f32_16x16x32_bf16 v[0:3], a[120:123], a[0:3], v[0:3]
  buffer_load_dwordx4 a[56:59], v167, s[20:23], s87 offen sc1
  v_pk_mul_f32 v[28:29], v[28:29], v[202:203]
  v_pk_mul_f32 v[30:31], v[30:31], v[202:203]
  v_mfma_f32_16x16x32_bf16 v[4:7], a[124:127], a[0:3], v[4:7]
  v_pk_mul_f32 v[32:33], v[32:33], v[202:203]
  v_pk_mul_f32 v[34:35], v[34:35], v[202:203]
  v_mfma_f32_16x16x32_bf16 v[8:11], a[128:131], a[0:3], v[8:11]
  v_pk_mul_f32 v[36:37], v[36:37], v[202:203]
  v_pk_mul_f32 v[38:39], v[38:39], v[202:203]
  v_mfma_f32_16x16x32_bf16 v[12:15], a[132:135], a[0:3], v[12:15]
  buffer_load_dwordx4 a[60:63], v168, s[20:23], s87 offen sc1
  v_pk_mul_f32 v[40:41], v[40:41], v[204:205]
  v_pk_mul_f32 v[42:43], v[42:43], v[204:205]
  v_mfma_f32_16x16x32_bf16 v[16:19], a[136:139], a[0:3], v[16:19]
  v_pk_mul_f32 v[44:45], v[44:45], v[204:205]
  v_pk_mul_f32 v[46:47], v[46:47], v[204:205]
  v_mfma_f32_16x16x32_bf16 v[20:23], a[120:123], a[4:7], v[20:23]
  v_pk_mul_f32 v[48:49], v[48:49], v[204:205]
  v_pk_mul_f32 v[50:51], v[50:51], v[204:205]
  v_mfma_f32_16x16x32_bf16 v[24:27], a[124:127], a[4:7], v[24:27]
  buffer_load_dwordx4 a[200:203], v195, s[20:23], s7 offen offset:0 sc1
  v_pk_mul_f32 v[52:53], v[52:53], v[204:205]
  v_pk_mul_f32 v[54:55], v[54:55], v[204:205]
  v_mfma_f32_16x16x32_bf16 v[28:31], a[128:131], a[4:7], v[28:31]
  v_pk_mul_f32 v[56:57], v[56:57], v[204:205]
  v_pk_mul_f32 v[58:59], v[58:59], v[204:205]
  v_mfma_f32_16x16x32_bf16 v[32:35], a[132:135], a[4:7], v[32:35]
  v_pk_mul_f32 v[60:61], v[60:61], v[206:207]
  v_pk_mul_f32 v[62:63], v[62:63], v[206:207]
  v_mfma_f32_16x16x32_bf16 v[36:39], a[136:139], a[4:7], v[36:39]
  v_pk_mul_f32 v[64:65], v[64:65], v[206:207]
  v_pk_mul_f32 v[66:67], v[66:67], v[206:207]
  v_mfma_f32_16x16x32_bf16 v[40:43], a[120:123], a[8:11], v[40:43]
  buffer_load_dwordx4 a[204:207], v195, s[20:23], s7 offen offset:1024 sc1
  v_pk_mul_f32 v[68:69], v[68:69], v[206:207]
  v_pk_mul_f32 v[70:71], v[70:71], v[206:207]
  v_mfma_f32_16x16x32_bf16 v[44:47], a[124:127], a[8:11], v[44:47]
  v_pk_mul_f32 v[72:73], v[72:73], v[206:207]
  v_pk_mul_f32 v[74:75], v[74:75], v[206:207]
  v_mfma_f32_16x16x32_bf16 v[48:51], a[128:131], a[8:11], v[48:51]
  v_pk_mul_f32 v[76:77], v[76:77], v[206:207]
  v_pk_mul_f32 v[78:79], v[78:79], v[206:207]
  v_mfma_f32_16x16x32_bf16 v[52:55], a[132:135], a[8:11], v[52:55]
  buffer_load_dwordx4 a[208:211], v195, s[20:23], s7 offen offset:2048 sc1
  v_mfma_f32_16x16x32_bf16 v[56:59], a[136:139], a[8:11], v[56:59]
  v_mfma_f32_16x16x32_bf16 v[60:63], a[120:123], a[12:15], v[60:63]
  v_mfma_f32_16x16x32_bf16 v[64:67], a[124:127], a[12:15], v[64:67]
  buffer_load_dwordx4 a[212:215], v195, s[20:23], s7 offen offset:3072 sc1
  v_mfma_f32_16x16x32_bf16 v[68:71], a[128:131], a[12:15], v[68:71]
  v_mfma_f32_16x16x32_bf16 v[72:75], a[132:135], a[12:15], v[72:75]
  v_mfma_f32_16x16x32_bf16 v[76:79], a[136:139], a[12:15], v[76:79]
  s_waitcnt vmcnt(22)
  v_mfma_f32_16x16x32_bf16 v[0:3], a[140:143], a[16:19], v[0:3]
  buffer_load_dwordx4 a[216:219], v199, s[20:23], s7 offen sc1
  v_mfma_f32_16x16x32_bf16 v[4:7], a[144:147], a[16:19], v[4:7]
  v_mfma_f32_16x16x32_bf16 v[8:11], a[148:151], a[16:19], v[8:11]
  v_mfma_f32_16x16x32_bf16 v[12:15], a[152:155], a[16:19], v[12:15]
  v_mfma_f32_16x16x32_bf16 v[16:19], a[156:159], a[16:19], v[16:19]
  buffer_load_dwordx4 a[64:67], v165, s[20:23], s49 offen sc1
  v_mfma_f32_16x16x32_bf16 v[20:23], a[140:143], a[20:23], v[20:23]
  v_mfma_f32_16x16x32_bf16 v[24:27], a[144:147], a[20:23], v[24:27]
  v_mfma_f32_16x16x32_bf16 v[28:31], a[148:151], a[20:23], v[28:31]
  v_mfma_f32_16x16x32_bf16 v[32:35], a[152:155], a[20:23], v[32:35]
  buffer_load_dwordx4 a[68:71], v166, s[20:23], s49 offen sc1
  v_mfma_f32_16x16x32_bf16 v[36:39], a[156:159], a[20:23], v[36:39]
  v_mfma_f32_16x16x32_bf16 v[40:43], a[140:143], a[24:27], v[40:43]
  v_mfma_f32_16x16x32_bf16 v[44:47], a[144:147], a[24:27], v[44:47]
  v_mfma_f32_16x16x32_bf16 v[48:51], a[148:151], a[24:27], v[48:51]
  buffer_load_dwordx4 a[72:75], v167, s[20:23], s49 offen sc1
  v_mfma_f32_16x16x32_bf16 v[52:55], a[152:155], a[24:27], v[52:55]
  v_mfma_f32_16x16x32_bf16 v[56:59], a[156:159], a[24:27], v[56:59]
  v_mfma_f32_16x16x32_bf16 v[60:63], a[140:143], a[28:31], v[60:63]
  v_mfma_f32_16x16x32_bf16 v[64:67], a[144:147], a[28:31], v[64:67]
  buffer_load_dwordx4 a[76:79], v168, s[20:23], s49 offen sc1
  v_mfma_f32_16x16x32_bf16 v[68:71], a[148:151], a[28:31], v[68:71]
  v_mfma_f32_16x16x32_bf16 v[72:75], a[152:155], a[28:31], v[72:75]
  v_mfma_f32_16x16x32_bf16 v[76:79], a[156:159], a[28:31], v[76:79]
  s_waitcnt vmcnt(18)
  v_mfma_f32_16x16x32_bf16 v[0:3], a[160:163], a[32:35], v[0:3]
  v_mfma_f32_16x16x32_bf16 v[4:7], a[164:167], a[32:35], v[4:7]
  v_mfma_f32_16x16x32_bf16 v[8:11], a[168:171], a[32:35], v[8:11]
  v_mfma_f32_16x16x32_bf16 v[12:15], a[172:175], a[32:35], v[12:15]
  v_mfma_f32_16x16x32_bf16 v[16:19], a[176:179], a[32:35], v[16:19]
  v_mfma_f32_16x16x32_bf16 v[20:23], a[160:163], a[36:39], v[20:23]
  v_mfma_f32_16x16x32_bf16 v[24:27], a[164:167], a[36:39], v[24:27]
  v_mfma_f32_16x16x32_bf16 v[28:31], a[168:171], a[36:39], v[28:31]
  v_mfma_f32_16x16x32_bf16 v[32:35], a[172:175], a[36:39], v[32:35]
  v_mfma_f32_16x16x32_bf16 v[36:39], a[176:179], a[36:39], v[36:39]
  v_mfma_f32_16x16x32_bf16 v[40:43], a[160:163], a[40:43], v[40:43]
  v_mfma_f32_16x16x32_bf16 v[44:47], a[164:167], a[40:43], v[44:47]
  v_mfma_f32_16x16x32_bf16 v[48:51], a[168:171], a[40:43], v[48:51]
  v_mfma_f32_16x16x32_bf16 v[52:55], a[172:175], a[40:43], v[52:55]
  v_mfma_f32_16x16x32_bf16 v[56:59], a[176:179], a[40:43], v[56:59]
  v_mfma_f32_16x16x32_bf16 v[60:63], a[160:163], a[44:47], v[60:63]
  v_mfma_f32_16x16x32_bf16 v[64:67], a[164:167], a[44:47], v[64:67]
  v_mfma_f32_16x16x32_bf16 v[68:71], a[168:171], a[44:47], v[68:71]
  v_mfma_f32_16x16x32_bf16 v[72:75], a[172:175], a[44:47], v[72:75]
  v_mfma_f32_16x16x32_bf16 v[76:79], a[176:179], a[44:47], v[76:79]
  s_waitcnt vmcnt(9)
  v_mfma_f32_16x16x32_bf16 v[0:3], a[180:183], a[48:51], v[0:3]
  v_mfma_f32_16x16x32_bf16 v[4:7], a[184:187], a[48:51], v[4:7]
  v_mfma_f32_16x16x32_bf16 v[8:11], a[188:191], a[48:51], v[8:11]
  v_mfma_f32_16x16x32_bf16 v[12:15], a[192:195], a[48:51], v[12:15]
  v_mfma_f32_16x16x32_bf16 v[16:19], a[196:199], a[48:51], v[16:19]
  v_mfma_f32_16x16x32_bf16 v[20:23], a[180:183], a[52:55], v[20:23]
  v_mfma_f32_16x16x32_bf16 v[24:27], a[184:187], a[52:55], v[24:27]
  v_mfma_f32_16x16x32_bf16 v[28:31], a[188:191], a[52:55], v[28:31]
  v_mfma_f32_16x16x32_bf16 v[32:35], a[192:195], a[52:55], v[32:35]
  v_mfma_f32_16x16x32_bf16 v[36:39], a[196:199], a[52:55], v[36:39]
  v_mfma_f32_16x16x32_bf16 v[40:43], a[180:183], a[56:59], v[40:43]
  v_mfma_f32_16x16x32_bf16 v[44:47], a[184:187], a[56:59], v[44:47]
  v_mfma_f32_16x16x32_bf16 v[48:51], a[188:191], a[56:59], v[48:51]
  v_mfma_f32_16x16x32_bf16 v[52:55], a[192:195], a[56:59], v[52:55]
  v_mfma_f32_16x16x32_bf16 v[56:59], a[196:199], a[56:59], v[56:59]
  v_mfma_f32_16x16x32_bf16 v[60:63], a[180:183], a[60:63], v[60:63]
  v_mfma_f32_16x16x32_bf16 v[64:67], a[184:187], a[60:63], v[64:67]
  v_mfma_f32_16x16x32_bf16 v[68:71], a[188:191], a[60:63], v[68:71]
  v_mfma_f32_16x16x32_bf16 v[72:75], a[192:195], a[60:63], v[72:75]
  v_mfma_f32_16x16x32_bf16 v[76:79], a[196:199], a[60:63], v[76:79]
  s_waitcnt vmcnt(0)
  v_mfma_f32_16x16x32_bf16 v[20:23], a[200:203], a[68:71], v[20:23]
  v_mfma_f32_16x16x32_bf16 v[24:27], a[204:207], a[68:71], v[24:27]
  v_mfma_f32_16x16x32_bf16 v[28:31], a[208:211], a[68:71], v[28:31]
  v_mfma_f32_16x16x32_bf16 v[32:35], a[212:215], a[68:71], v[32:35]
  v_mfma_f32_16x16x32_bf16 v[36:39], a[216:219], a[68:71], v[36:39]
  v_mfma_f32_16x16x32_bf16 v[40:43], a[200:203], a[72:75], v[40:43]
  v_mfma_f32_16x16x32_bf16 v[44:47], a[204:207], a[72:75], v[44:47]
  v_mfma_f32_16x16x32_bf16 v[48:51], a[208:211], a[72:75], v[48:51]
  v_mfma_f32_16x16x32_bf16 v[52:55], a[212:215], a[72:75], v[52:55]
  ds_write_b128 v192, v[20:23] offset:0
  v_mfma_f32_16x16x32_bf16 v[56:59], a[216:219], a[72:75], v[56:59]
  ds_write_b128 v192, v[24:27] offset:1024
  v_mfma_f32_16x16x32_bf16 v[60:63], a[200:203], a[76:79], v[60:63]
  ds_write_b128 v192, v[28:31] offset:2048
  v_mfma_f32_16x16x32_bf16 v[64:67], a[204:207], a[76:79], v[64:67]
  ds_write_b128 v192, v[32:35] offset:3072
  v_mfma_f32_16x16x32_bf16 v[68:71], a[208:211], a[76:79], v[68:71]
  ds_write_b128 v192, v[36:39] offset:4096
  v_mfma_f32_16x16x32_bf16 v[72:75], a[212:215], a[76:79], v[72:75]
  ds_write_b128 v192, v[40:43] offset:5120
  v_mfma_f32_16x16x32_bf16 v[76:79], a[216:219], a[76:79], v[76:79]
  ds_write_b128 v192, v[44:47] offset:6144
  v_mfma_f32_16x16x32_bf16 v[0:3], a[200:203], a[64:67], v[0:3]
  ds_write_b128 v192, v[48:51] offset:7168
  v_mfma_f32_16x16x32_bf16 v[4:7], a[204:207], a[64:67], v[4:7]
  ds_write_b128 v192, v[52:55] offset:8192
  v_mfma_f32_16x16x32_bf16 v[8:11], a[208:211], a[64:67], v[8:11]
  ds_write_b128 v192, v[56:59] offset:9216
  v_mfma_f32_16x16x32_bf16 v[12:15], a[212:215], a[64:67], v[12:15]
  ds_write_b128 v192, v[60:63] offset:10240
  v_mfma_f32_16x16x32_bf16 v[16:19], a[216:219], a[64:67], v[16:19]
  ds_write_b128 v192, v[64:67] offset:11264
  ds_write_b128 v192, v[68:71] offset:12288
  ds_write_b128 v192, v[72:75] offset:13312
  ds_write_b128 v192, v[76:79] offset:14336
  s_waitcnt lgkmcnt(0)
  s_barrier
  ds_read_b128 v[80:83], v161 offset:0
  ds_read_b128 v[84:87], v161 offset:1024
  ds_read_b128 v[88:91], v161 offset:2048
  ds_read_b128 v[92:95], v161 offset:3072
  ds_read_b128 v[96:99], v161 offset:4096
  ds_read_b128 v[100:103], v162 offset:5120
  ds_read_b128 v[104:107], v162 offset:6144
  ds_read_b128 v[108:111], v162 offset:7168
  ds_read_b128 v[112:115], v162 offset:8192
  ds_read_b128 v[116:119], v162 offset:9216
  ds_read_b128 v[120:123], v163 offset:10240
  ds_read_b128 v[124:127], v163 offset:11264
  ds_read_b128 v[128:131], v163 offset:12288
  ds_read_b128 v[132:135], v163 offset:13312
  ds_read_b128 v[136:139], v163 offset:14336
  s_lshl_b32 s3, s80, 6
  s_lshl_b32 s4, s42, 4
  s_add_u32 s3, s3, s4
  s_mul_i32 s3, s3, 1280
  s_mul_i32 s4, s81, 160
  s_add_u32 s3, s3, s4
  v_and_b32 v220, 15, v164
  v_mul_u32_u24 v220, 1280, v220
  v_lshrrev_b32 v221, 4, v164
  v_lshl_add_u32 v222, v221, 4, v220
  v_lshl_add_u32 v223, v221, 3, v220
  s_waitcnt lgkmcnt(10)
  v_pk_add_f32 v[0:1], v[0:1], v[80:81]
  v_pk_add_f32 v[2:3], v[2:3], v[82:83]
  v_pk_add_f32 v[4:5], v[4:5], v[84:85]
  v_pk_add_f32 v[6:7], v[6:7], v[86:87]
  v_pk_add_f32 v[8:9], v[8:9], v[88:89]
  v_pk_add_f32 v[10:11], v[10:11], v[90:91]
  v_pk_add_f32 v[12:13], v[12:13], v[92:93]
  v_pk_add_f32 v[14:15], v[14:15], v[94:95]
  v_pk_add_f32 v[16:17], v[16:17], v[96:97]
  v_pk_add_f32 v[18:19], v[18:19], v[98:99]
  s_waitcnt lgkmcnt(5)
  v_pk_add_f32 v[0:1], v[0:1], v[100:101]
  v_pk_add_f32 v[2:3], v[2:3], v[102:103]
  v_pk_add_f32 v[4:5], v[4:5], v[104:105]
  v_pk_add_f32 v[6:7], v[6:7], v[106:107]
  v_pk_add_f32 v[8:9], v[8:9], v[108:109]
  v_pk_add_f32 v[10:11], v[10:11], v[110:111]
  v_pk_add_f32 v[12:13], v[12:13], v[112:113]
  v_pk_add_f32 v[14:15], v[14:15], v[114:115]
  v_pk_add_f32 v[16:17], v[16:17], v[116:117]
  v_pk_add_f32 v[18:19], v[18:19], v[118:119]
  s_waitcnt lgkmcnt(0)
  v_pk_add_f32 v[0:1], v[0:1], v[120:121]
  v_pk_add_f32 v[2:3], v[2:3], v[122:123]
  v_pk_add_f32 v[4:5], v[4:5], v[124:125]
  v_pk_add_f32 v[6:7], v[6:7], v[126:127]
  v_pk_add_f32 v[8:9], v[8:9], v[128:129]
  v_pk_add_f32 v[10:11], v[10:11], v[130:131]
  v_pk_add_f32 v[12:13], v[12:13], v[132:133]
  v_pk_add_f32 v[14:15], v[14:15], v[134:135]
  v_pk_add_f32 v[16:17], v[16:17], v[136:137]
  v_pk_add_f32 v[18:19], v[18:19], v[138:139]
  v_cvt_pk_bf16_f32 v228, v0, v1
  v_cvt_pk_bf16_f32 v229, v2, v3
  v_cvt_pk_bf16_f32 v230, v4, v5
  v_cvt_pk_bf16_f32 v231, v6, v7
  v_cvt_pk_bf16_f32 v232, v8, v9
  v_cvt_pk_bf16_f32 v233, v10, v11
  v_cvt_pk_bf16_f32 v234, v12, v13
  v_cvt_pk_bf16_f32 v235, v14, v15
  v_cvt_pk_bf16_f32 v236, v16, v17
  v_cvt_pk_bf16_f32 v237, v18, v19
  buffer_store_dwordx4 v[228:231], v222, s[8:11], s3 offen
  buffer_store_dwordx4 v[232:235], v222, s[8:11], s3 offen offset:64
  buffer_store_dwordx2 v[236:237], v223, s[8:11], s3 offen offset:128
L_end:
  s_endpgm
.section .rodata,"a"
.p2align 6
.amdhsa_kernel gated_mix__linear_attn_block__glu_gated_glu__prompt_kernel
  .amdhsa_next_free_vgpr 512
  .amdhsa_next_free_sgpr 102
  .amdhsa_accum_offset 256
  .amdhsa_group_segment_fixed_size 0
  .amdhsa_kernarg_size 88
  .amdhsa_user_sgpr_count 2
  .amdhsa_user_sgpr_kernarg_segment_ptr 1
  .amdhsa_system_sgpr_workgroup_id_x 1
  .amdhsa_float_denorm_mode_32 3
  .amdhsa_float_denorm_mode_16_64 3
.end_amdhsa_kernel
```
